```python
import torch

def _softmax(x, axis=-1):
    return torch.softmax(x, dim=axis)
def _gelu(x):
    return torch.nn.functional.gelu(x, approximate="tanh")
def _silu(x):
    return torch.nn.functional.silu(x)
def _sigmoid(x):
    return torch.sigmoid(x)
def _layernorm(x, axis=-1, eps=1e-5):
    m = x.mean(dim=axis, keepdim=True)
    v = x.var(dim=axis, keepdim=True, unbiased=False)
    return (x - m) / torch.sqrt(v + eps)
def _scatter_add(tgt, idx, src, axis=0):
    return tgt.clone().index_add_(axis, idx, src)
def _segment_sum(src, seg, n):
    out = torch.zeros((n,) + src.shape[1:], dtype=src.dtype)
    return out.index_add_(0, seg, src)
def _pad(x, pw):
    flat = tuple(v for pair in reversed(pw) for v in pair)
    return torch.nn.functional.pad(x, flat)

kernel_name = 'gated_mix__spectral_fnet__mha_block__prompt'

def setup_inputs():

    _w = (lambda a: (lambda t: t.to(torch.bfloat16) if t.is_floating_point() else t)(torch.as_tensor(a)))
    def _A_setup():
        B, S, D = 1, 2048, 640
        ns = torch.arange(S)[:, None] * torch.arange(S)[None, :]
        nd = torch.arange(D)[:, None] * torch.arange(D)[None, :]
        Ws_re = torch.cos(-2.0 * torch.pi * ns / S).to(float)
        Ws_im = torch.sin(-2.0 * torch.pi * ns / S).to(float)
        Wd_re = torch.cos(-2.0 * torch.pi * nd / D).to(float)
        Wd_im = torch.sin(-2.0 * torch.pi * nd / D).to(float)
        return {
            "x": _w((lambda *s: torch.randn(*s, dtype=torch.bfloat16) * 0.05)(B, S, D)),
            "dft_seq_re": _w(Ws_re),
            "dft_seq_im": _w(Ws_im),
            "dft_hid_re": _w(Wd_re),
            "dft_hid_im": _w(Wd_im),
        }
    _A_in = _A_setup()

    def _B_setup():
        B, S, D, H = 1, 2048, 640, 32
        return {
            "x": _w((lambda *s: torch.randn(*s, dtype=torch.bfloat16) * 0.05)(B, S, D)),
            "wqkv": _w((lambda *s: torch.randn(*s, dtype=torch.bfloat16) * 1.6)(D, 3 * D)),
            "wo": _w((lambda *s: torch.randn(*s, dtype=torch.bfloat16) * 1.6)(D, D)),
        }
    _B_in = _B_setup()

    return {
        "A_x": _A_in["x"],
        "A_dft_seq_re": _A_in["dft_seq_re"],
        "A_dft_seq_im": _A_in["dft_seq_im"],
        "A_dft_hid_re": _A_in["dft_hid_re"],
        "A_dft_hid_im": _A_in["dft_hid_im"],
        "B_x": _B_in["x"],
        "B_wqkv": _B_in["wqkv"],
        "B_wo": _B_in["wo"],
        "gate_w": _w((lambda *s: torch.randn(*s, dtype=torch.bfloat16) * 0.05)(640) * 16.0),
    }

def reference(A_x, A_dft_seq_re, A_dft_seq_im, A_dft_hid_re, A_dft_hid_im, B_x, B_wqkv, B_wo, gate_w):
    def _A_ref(x, dft_seq_re, dft_seq_im, dft_hid_re, dft_hid_im):
        a = torch.einsum("bsd,ed->bse", x, dft_hid_re)
        b = torch.einsum("bsd,ed->bse", x, dft_hid_im)
        y = torch.einsum("ts,bse->bte", dft_seq_re, a) - torch.einsum("ts,bse->bte", dft_seq_im, b)
        return y

    def _B_ref(x, wqkv, wo):
        B, S, D = x.shape
        H = 32
        Dh = D // H
        qkv = (lambda x, *d: x.permute(*d))((x @ wqkv).reshape(B, S, 3, H, Dh), 2, 0, 3, 1, 4)
        q, k, v = qkv[0], qkv[1], qkv[2]
        scores = torch.einsum("bhqd,bhkd->bhqk", q, k) * (Dh ** -0.5)
        p = _softmax(scores, axis=-1)
        o = torch.einsum("bhqk,bhkd->bhqd", p, v)
        return (lambda x, *d: x.permute(*d))(o, 0, 2, 1, 3).reshape(B, S, D) @ wo

    x = A_x
    g = _sigmoid((x * gate_w).sum(-1, keepdims=True))
    a = _A_ref(x, A_dft_seq_re, A_dft_seq_im, A_dft_hid_re, A_dft_hid_im)
    b = _B_ref(x, B_wqkv, B_wo)
    return g * a + (1 - g) * b
```

```asm
; @launch kernel=proj_kernel grid=(256,1,1) block=(512,1,1) lds=135168
; @launch kernel=attn_kernel grid=(256,1,1) block=(768,1,1) lds=155904
.amdgcn_target "amdgcn-amd-amdhsa--gfx950"
.text
.globl proj_kernel
.p2align 8
.type proj_kernel,@function
proj_kernel:
  s_load_dwordx16 s[4:19], s[0:1], 0
  s_load_dwordx8 s[20:27], s[0:1], 64
  s_cmp_ge_u32 s2, 256
  s_cbranch_scc1 proj_kernel_end
  v_lshrrev_b32 v1, 6, v0
  v_and_b32 v2, 63, v0
  v_readfirstlane_b32 s40, v1
  s_and_b32 s44, s2, 7
  s_lshr_b32 s45, s2, 3
  s_lshr_b32 s41, s44, 2
  s_lshl_b32 s41, s41, 3
  s_lshr_b32 s46, s45, 2
  s_add_u32 s41, s41, s46
  s_and_b32 s42, s44, 3
  s_lshl_b32 s42, s42, 2
  s_and_b32 s46, s45, 3
  s_add_u32 s42, s42, s46
  s_mov_b32 s70, s46
  s_lshr_b32 s69, s45, 2
  s_mul_i32 s58, s70, 1
  s_add_u32 s58, s58, s69
  s_and_b32 s58, s58, 15
  s_lshl_b32 s58, s58, 2
  s_mov_b32 s56, 0x20202020
  s_mov_b32 s57, 0x20202020
  s_lshr_b64 s[56:57], s[56:57], s58
  s_and_b32 s58, s56, 15
  s_mov_b32 s55, 0
  s_mov_b32 s48, 0
  s_cmp_lt_u32 s40, 4
  s_cbranch_scc1 proj_kernel_np
  s_setprio 3
proj_kernel_np:
  v_lshrrev_b32 v3, 3, v2
  v_and_b32 v4, 7, v2
  v_add_u32 v5, 0, v3
  v_lshrrev_b32 v6, 1, v5
  v_and_b32 v6, 7, v6
  v_xor_b32 v6, v6, v4
  v_mul_u32_u24 v7, 1280, v5
  v_lshl_add_u32 v16, v6, 4, v7
  v_add_u32 v5, 8, v3
  v_lshrrev_b32 v6, 1, v5
  v_and_b32 v6, 7, v6
  v_xor_b32 v6, v6, v4
  v_mul_u32_u24 v7, 1280, v5
  v_lshl_add_u32 v17, v6, 4, v7
  v_subrev_u32 v17, 1024, v17
  v_add_u32 v5, 16, v3
  v_lshrrev_b32 v6, 1, v5
  v_and_b32 v6, 7, v6
  v_xor_b32 v6, v6, v4
  v_mul_u32_u24 v7, 1280, v5
  v_lshl_add_u32 v18, v6, 4, v7
  v_subrev_u32 v18, 2048, v18
  v_add_u32 v5, 24, v3
  v_lshrrev_b32 v6, 1, v5
  v_and_b32 v6, 7, v6
  v_xor_b32 v6, v6, v4
  v_mul_u32_u24 v7, 1280, v5
  v_lshl_add_u32 v19, v6, 4, v7
  v_subrev_u32 v19, 3072, v19
  s_cmp_lt_u32 s40, 4
  s_cbranch_scc1 proj_kernel_nl
  s_sub_u32 s44, s40, 4
  s_lshl_b32 s45, s41, 2
  s_add_u32 s45, s45, s44
  s_mul_i32 s59, s45, 40960
  s_lshl_b32 s51, s58, 7
  s_add_u32 s51, s51, s59
  s_lshl_b32 s53, s44, 12
  s_mov_b32 m0, s53
  s_waitcnt lgkmcnt(0)
  s_mov_b32 s28, s4
  s_and_b32 s29, s5, 0xffff
  s_mov_b32 s30, 2621440
  s_mov_b32 s31, 0x20000
  buffer_load_dwordx4 v16, s[28:31], s51 offen offset:0  lds
  buffer_load_dwordx4 v17, s[28:31], s51 offen offset:1024  lds
  buffer_load_dwordx4 v18, s[28:31], s51 offen offset:2048  lds
  buffer_load_dwordx4 v19, s[28:31], s51 offen offset:3072  lds
  s_branch proj_kernel_nl2
proj_kernel_nl:
  s_waitcnt lgkmcnt(0)
proj_kernel_nl2:
  s_mov_b32 s28, s4
  s_and_b32 s29, s5, 0xffff
  s_mov_b32 s30, 2621440
  s_mov_b32 s31, 0x20000
  s_mov_b32 s36, s26
  s_and_b32 s37, s27, 0xffff
  s_mov_b32 s38, 19210240
  s_mov_b32 s39, 0x20000
  s_cmp_ge_u32 s42, 10
  s_cbranch_scc1 proj_kernel_ab
  s_mov_b32 s32, s16
  s_and_b32 s33, s17, 0xffff
  s_mov_b32 s34, 2457600
  s_mov_b32 s35, 0x20000
  s_cmp_ge_u32 s42, 6
  s_cbranch_scc1 proj_kernel_v
  s_mul_i32 s43, s42, 7
  s_cmp_eq_u32 s42, 5
  s_cbranch_scc1 proj_kernel_qk5
  s_cmp_ge_u32 s40, 4
  s_cbranch_scc1 proj_kernel_ld_tr7
  s_branch proj_kernel_c_qk7
proj_kernel_qk5:
  s_cmp_ge_u32 s40, 4
  s_cbranch_scc1 proj_kernel_ld_tr5
  s_branch proj_kernel_c_qk5
proj_kernel_v:
  s_mul_i32 s43, s42, 5
  s_add_u32 s43, s43, 10
  s_cmp_ge_u32 s40, 4
  s_cbranch_scc1 proj_kernel_ld_v5
  s_branch proj_kernel_c_v5
proj_kernel_ab:
  s_cmp_ge_u32 s42, 13
  s_cselect_b32 s55, 1, 0
  s_cselect_b32 s46, s12, s10
  s_cselect_b32 s47, s13, s11
  s_mov_b32 s32, s46
  s_and_b32 s33, s47, 0xffff
  s_mov_b32 s34, 819200
  s_mov_b32 s35, 0x20000
  s_mul_i32 s46, s55, 3
  s_sub_u32 s46, s42, s46
  s_sub_u32 s46, s46, 10
  s_mul_i32 s43, s46, 7
  s_cmp_eq_u32 s46, 2
  s_cbranch_scc1 proj_kernel_ab6
  s_cmp_ge_u32 s40, 4
  s_cbranch_scc1 proj_kernel_ld_row7
  s_branch proj_kernel_c_ab7
proj_kernel_ab6:
  s_cmp_ge_u32 s40, 4
  s_cbranch_scc1 proj_kernel_ld_row6
  s_branch proj_kernel_c_ab6
proj_kernel_ld_tr7:
  s_mul_i32 s46, s44, 7
  s_lshl_b32 s54, s46, 10
  s_add_u32 s54, s54, 16384
  s_lshl_b32 s47, s46, 6
  v_add_u32 v8, s47, v2
  v_add_u32 v5, 0, v8
  v_mul_u32_u24 v6, 2341, v5
  v_lshrrev_b32 v6, 16, v6
  v_mul_u32_u24 v7, 3392, v6
  v_lshl_add_u32 v24, v5, 4, v7
  v_add_u32 v5, 64, v8
  v_mul_u32_u24 v6, 2341, v5
  v_lshrrev_b32 v6, 16, v6
  v_mul_u32_u24 v7, 3392, v6
  v_lshl_add_u32 v25, v5, 4, v7
  v_subrev_u32 v25, 1024, v25
  v_add_u32 v5, 128, v8
  v_mul_u32_u24 v6, 2341, v5
  v_lshrrev_b32 v6, 16, v6
  v_mul_u32_u24 v7, 3392, v6
  v_lshl_add_u32 v26, v5, 4, v7
  v_subrev_u32 v26, 2048, v26
  v_add_u32 v5, 192, v8
  v_mul_u32_u24 v6, 2341, v5
  v_lshrrev_b32 v6, 16, v6
  v_mul_u32_u24 v7, 3392, v6
  v_lshl_add_u32 v27, v5, 4, v7
  v_subrev_u32 v27, 3072, v27
  v_add_u32 v5, 256, v8
  v_mul_u32_u24 v6, 2341, v5
  v_lshrrev_b32 v6, 16, v6
  v_mul_u32_u24 v7, 3392, v6
  v_lshl_add_u32 v28, v5, 4, v7
  v_add_u32 v5, 320, v8
  v_mul_u32_u24 v6, 2341, v5
  v_lshrrev_b32 v6, 16, v6
  v_mul_u32_u24 v7, 3392, v6
  v_lshl_add_u32 v29, v5, 4, v7
  v_subrev_u32 v29, 1024, v29
  v_add_u32 v5, 384, v8
  v_mul_u32_u24 v6, 2341, v5
  v_lshrrev_b32 v6, 16, v6
  v_mul_u32_u24 v7, 3392, v6
  v_lshl_add_u32 v30, v5, 4, v7
  v_subrev_u32 v30, 2048, v30
  s_lshl_b32 s68, s43, 6
  s_mul_i32 s52, s58, 245760
  s_add_u32 s52, s52, s68
  s_add_u32 m0, s54, s48
  s_nop 0
  buffer_load_dwordx4 v24, s[32:35], s52 offen offset:0  lds
  buffer_load_dwordx4 v25, s[32:35], s52 offen offset:1024  lds
  buffer_load_dwordx4 v26, s[32:35], s52 offen offset:2048  lds
  buffer_load_dwordx4 v27, s[32:35], s52 offen offset:3072  lds
  s_add_u32 m0, m0, 4096
  s_nop 0
  buffer_load_dwordx4 v28, s[32:35], s52 offen offset:0  lds
  buffer_load_dwordx4 v29, s[32:35], s52 offen offset:1024  lds
  buffer_load_dwordx4 v30, s[32:35], s52 offen offset:2048  lds
  s_add_u32 s58, s58, 1
  s_cmp_eq_u32 s58, 10
  s_cselect_b32 s58, 0, s58
  s_lshl_b32 s51, s58, 7
  s_add_u32 s51, s51, s59
  s_mul_i32 s52, s58, 245760
  s_add_u32 s52, s52, s68
  s_add_u32 s48, s48, 45056
  s_cmp_eq_u32 s48, 135168
  s_cselect_b32 s48, 0, s48
  s_add_u32 m0, s53, s48
  s_nop 0
  buffer_load_dwordx4 v16, s[28:31], s51 offen offset:0  lds
  buffer_load_dwordx4 v17, s[28:31], s51 offen offset:1024  lds
  buffer_load_dwordx4 v18, s[28:31], s51 offen offset:2048  lds
  buffer_load_dwordx4 v19, s[28:31], s51 offen offset:3072  lds
  s_add_u32 m0, s54, s48
  s_nop 0
  buffer_load_dwordx4 v24, s[32:35], s52 offen offset:0  lds
  buffer_load_dwordx4 v25, s[32:35], s52 offen offset:1024  lds
  buffer_load_dwordx4 v26, s[32:35], s52 offen offset:2048  lds
  buffer_load_dwordx4 v27, s[32:35], s52 offen offset:3072  lds
  s_add_u32 m0, m0, 4096
  s_nop 0
  buffer_load_dwordx4 v28, s[32:35], s52 offen offset:0  lds
  buffer_load_dwordx4 v29, s[32:35], s52 offen offset:1024  lds
  buffer_load_dwordx4 v30, s[32:35], s52 offen offset:2048  lds
  s_add_u32 s58, s58, 1
  s_cmp_eq_u32 s58, 10
  s_cselect_b32 s58, 0, s58
  s_lshl_b32 s51, s58, 7
  s_add_u32 s51, s51, s59
  s_mul_i32 s52, s58, 245760
  s_add_u32 s52, s52, s68
  s_add_u32 s48, s48, 45056
  s_cmp_eq_u32 s48, 135168
  s_cselect_b32 s48, 0, s48
  s_waitcnt vmcnt(11)
  s_barrier
  s_add_u32 m0, s53, s48
  s_nop 0
  buffer_load_dwordx4 v16, s[28:31], s51 offen offset:0  lds
  buffer_load_dwordx4 v17, s[28:31], s51 offen offset:1024  lds
  buffer_load_dwordx4 v18, s[28:31], s51 offen offset:2048  lds
  buffer_load_dwordx4 v19, s[28:31], s51 offen offset:3072  lds
  s_add_u32 m0, s54, s48
  s_nop 0
  buffer_load_dwordx4 v24, s[32:35], s52 offen offset:0  lds
  buffer_load_dwordx4 v25, s[32:35], s52 offen offset:1024  lds
  buffer_load_dwordx4 v26, s[32:35], s52 offen offset:2048  lds
  buffer_load_dwordx4 v27, s[32:35], s52 offen offset:3072  lds
  s_add_u32 m0, m0, 4096
  s_nop 0
  buffer_load_dwordx4 v28, s[32:35], s52 offen offset:0  lds
  buffer_load_dwordx4 v29, s[32:35], s52 offen offset:1024  lds
  buffer_load_dwordx4 v30, s[32:35], s52 offen offset:2048  lds
  s_add_u32 s58, s58, 1
  s_cmp_eq_u32 s58, 10
  s_cselect_b32 s58, 0, s58
  s_lshl_b32 s51, s58, 7
  s_add_u32 s51, s51, s59
  s_mul_i32 s52, s58, 245760
  s_add_u32 s52, s52, s68
  s_add_u32 s48, s48, 45056
  s_cmp_eq_u32 s48, 135168
  s_cselect_b32 s48, 0, s48
  s_mov_b32 s50, 7
proj_kernel_ld_tr7_loop_1:
  s_waitcnt vmcnt(11)
  s_barrier
  s_add_u32 m0, s53, s48
  s_nop 0
  buffer_load_dwordx4 v16, s[28:31], s51 offen offset:0  lds
  buffer_load_dwordx4 v17, s[28:31], s51 offen offset:1024  lds
  buffer_load_dwordx4 v18, s[28:31], s51 offen offset:2048  lds
  buffer_load_dwordx4 v19, s[28:31], s51 offen offset:3072  lds
  s_add_u32 m0, s54, s48
  s_nop 0
  buffer_load_dwordx4 v24, s[32:35], s52 offen offset:0  lds
  buffer_load_dwordx4 v25, s[32:35], s52 offen offset:1024  lds
  buffer_load_dwordx4 v26, s[32:35], s52 offen offset:2048  lds
  buffer_load_dwordx4 v27, s[32:35], s52 offen offset:3072  lds
  s_add_u32 m0, m0, 4096
  s_nop 0
  buffer_load_dwordx4 v28, s[32:35], s52 offen offset:0  lds
  buffer_load_dwordx4 v29, s[32:35], s52 offen offset:1024  lds
  buffer_load_dwordx4 v30, s[32:35], s52 offen offset:2048  lds
  s_add_u32 s58, s58, 1
  s_cmp_eq_u32 s58, 10
  s_cselect_b32 s58, 0, s58
  s_lshl_b32 s51, s58, 7
  s_add_u32 s51, s51, s59
  s_mul_i32 s52, s58, 245760
  s_add_u32 s52, s52, s68
  s_add_u32 s48, s48, 45056
  s_cmp_eq_u32 s48, 135168
  s_cselect_b32 s48, 0, s48
  s_sub_u32 s50, s50, 1
  s_cmp_lg_u32 s50, 0
  s_cbranch_scc1 proj_kernel_ld_tr7_loop_1
  s_waitcnt vmcnt(11)
  s_barrier
  s_waitcnt vmcnt(0)
  s_barrier
  s_branch proj_kernel_end
proj_kernel_ld_tr5:
  s_mul_i32 s46, s44, 5
  s_lshl_b32 s54, s46, 10
  s_add_u32 s54, s54, 16384
  s_lshl_b32 s47, s46, 6
  v_add_u32 v8, s47, v2
  v_add_u32 v5, 0, v8
  v_mul_u32_u24 v6, 3277, v5
  v_lshrrev_b32 v6, 16, v6
  v_mul_u32_u24 v7, 3520, v6
  v_lshl_add_u32 v24, v5, 4, v7
  v_add_u32 v5, 64, v8
  v_mul_u32_u24 v6, 3277, v5
  v_lshrrev_b32 v6, 16, v6
  v_mul_u32_u24 v7, 3520, v6
  v_lshl_add_u32 v25, v5, 4, v7
  v_subrev_u32 v25, 1024, v25
  v_add_u32 v5, 128, v8
  v_mul_u32_u24 v6, 3277, v5
  v_lshrrev_b32 v6, 16, v6
  v_mul_u32_u24 v7, 3520, v6
  v_lshl_add_u32 v26, v5, 4, v7
  v_subrev_u32 v26, 2048, v26
  v_add_u32 v5, 192, v8
  v_mul_u32_u24 v6, 3277, v5
  v_lshrrev_b32 v6, 16, v6
  v_mul_u32_u24 v7, 3520, v6
  v_lshl_add_u32 v27, v5, 4, v7
  v_subrev_u32 v27, 3072, v27
  v_add_u32 v5, 256, v8
  v_mul_u32_u24 v6, 3277, v5
  v_lshrrev_b32 v6, 16, v6
  v_mul_u32_u24 v7, 3520, v6
  v_lshl_add_u32 v28, v5, 4, v7
  s_lshl_b32 s68, s43, 6
  s_mul_i32 s52, s58, 245760
  s_add_u32 s52, s52, s68
  s_add_u32 m0, s54, s48
  s_nop 0
  buffer_load_dwordx4 v24, s[32:35], s52 offen offset:0  lds
  buffer_load_dwordx4 v25, s[32:35], s52 offen offset:1024  lds
  buffer_load_dwordx4 v26, s[32:35], s52 offen offset:2048  lds
  buffer_load_dwordx4 v27, s[32:35], s52 offen offset:3072  lds
  s_add_u32 m0, m0, 4096
  s_nop 0
  buffer_load_dwordx4 v28, s[32:35], s52 offen offset:0  lds
  s_add_u32 s58, s58, 1
  s_cmp_eq_u32 s58, 10
  s_cselect_b32 s58, 0, s58
  s_lshl_b32 s51, s58, 7
  s_add_u32 s51, s51, s59
  s_mul_i32 s52, s58, 245760
  s_add_u32 s52, s52, s68
  s_add_u32 s48, s48, 45056
  s_cmp_eq_u32 s48, 135168
  s_cselect_b32 s48, 0, s48
  s_add_u32 m0, s53, s48
  s_nop 0
  buffer_load_dwordx4 v16, s[28:31], s51 offen offset:0  lds
  buffer_load_dwordx4 v17, s[28:31], s51 offen offset:1024  lds
  buffer_load_dwordx4 v18, s[28:31], s51 offen offset:2048  lds
  buffer_load_dwordx4 v19, s[28:31], s51 offen offset:3072  lds
  s_add_u32 m0, s54, s48
  s_nop 0
  buffer_load_dwordx4 v24, s[32:35], s52 offen offset:0  lds
  buffer_load_dwordx4 v25, s[32:35], s52 offen offset:1024  lds
  buffer_load_dwordx4 v26, s[32:35], s52 offen offset:2048  lds
  buffer_load_dwordx4 v27, s[32:35], s52 offen offset:3072  lds
  s_add_u32 m0, m0, 4096
  s_nop 0
  buffer_load_dwordx4 v28, s[32:35], s52 offen offset:0  lds
  s_add_u32 s58, s58, 1
  s_cmp_eq_u32 s58, 10
  s_cselect_b32 s58, 0, s58
  s_lshl_b32 s51, s58, 7
  s_add_u32 s51, s51, s59
  s_mul_i32 s52, s58, 245760
  s_add_u32 s52, s52, s68
  s_add_u32 s48, s48, 45056
  s_cmp_eq_u32 s48, 135168
  s_cselect_b32 s48, 0, s48
  s_waitcnt vmcnt(9)
  s_barrier
  s_add_u32 m0, s53, s48
  s_nop 0
  buffer_load_dwordx4 v16, s[28:31], s51 offen offset:0  lds
  buffer_load_dwordx4 v17, s[28:31], s51 offen offset:1024  lds
  buffer_load_dwordx4 v18, s[28:31], s51 offen offset:2048  lds
  buffer_load_dwordx4 v19, s[28:31], s51 offen offset:3072  lds
  s_add_u32 m0, s54, s48
  s_nop 0
  buffer_load_dwordx4 v24, s[32:35], s52 offen offset:0  lds
  buffer_load_dwordx4 v25, s[32:35], s52 offen offset:1024  lds
  buffer_load_dwordx4 v26, s[32:35], s52 offen offset:2048  lds
  buffer_load_dwordx4 v27, s[32:35], s52 offen offset:3072  lds
  s_add_u32 m0, m0, 4096
  s_nop 0
  buffer_load_dwordx4 v28, s[32:35], s52 offen offset:0  lds
  s_add_u32 s58, s58, 1
  s_cmp_eq_u32 s58, 10
  s_cselect_b32 s58, 0, s58
  s_lshl_b32 s51, s58, 7
  s_add_u32 s51, s51, s59
  s_mul_i32 s52, s58, 245760
  s_add_u32 s52, s52, s68
  s_add_u32 s48, s48, 45056
  s_cmp_eq_u32 s48, 135168
  s_cselect_b32 s48, 0, s48
  s_mov_b32 s50, 7
proj_kernel_ld_tr5_loop_2:
  s_waitcnt vmcnt(9)
  s_barrier
  s_add_u32 m0, s53, s48
  s_nop 0
  buffer_load_dwordx4 v16, s[28:31], s51 offen offset:0  lds
  buffer_load_dwordx4 v17, s[28:31], s51 offen offset:1024  lds
  buffer_load_dwordx4 v18, s[28:31], s51 offen offset:2048  lds
  buffer_load_dwordx4 v19, s[28:31], s51 offen offset:3072  lds
  s_add_u32 m0, s54, s48
  s_nop 0
  buffer_load_dwordx4 v24, s[32:35], s52 offen offset:0  lds
  buffer_load_dwordx4 v25, s[32:35], s52 offen offset:1024  lds
  buffer_load_dwordx4 v26, s[32:35], s52 offen offset:2048  lds
  buffer_load_dwordx4 v27, s[32:35], s52 offen offset:3072  lds
  s_add_u32 m0, m0, 4096
  s_nop 0
  buffer_load_dwordx4 v28, s[32:35], s52 offen offset:0  lds
  s_add_u32 s58, s58, 1
  s_cmp_eq_u32 s58, 10
  s_cselect_b32 s58, 0, s58
  s_lshl_b32 s51, s58, 7
  s_add_u32 s51, s51, s59
  s_mul_i32 s52, s58, 245760
  s_add_u32 s52, s52, s68
  s_add_u32 s48, s48, 45056
  s_cmp_eq_u32 s48, 135168
  s_cselect_b32 s48, 0, s48
  s_sub_u32 s50, s50, 1
  s_cmp_lg_u32 s50, 0
  s_cbranch_scc1 proj_kernel_ld_tr5_loop_2
  s_waitcnt vmcnt(9)
  s_barrier
  s_waitcnt vmcnt(0)
  s_barrier
  s_branch proj_kernel_end
proj_kernel_ld_v5:
  s_mul_i32 s46, s44, 5
  s_lshl_b32 s54, s46, 10
  s_add_u32 s54, s54, 16384
  s_lshl_b32 s47, s46, 6
  v_add_u32 v8, s47, v2
  v_add_u32 v5, 0, v8
  v_mul_u32_u24 v6, 3277, v5
  v_lshrrev_b32 v6, 16, v6
  v_mul_u32_u24 v7, 3520, v6
  v_lshl_add_u32 v24, v5, 4, v7
  v_add_u32 v5, 64, v8
  v_mul_u32_u24 v6, 3277, v5
  v_lshrrev_b32 v6, 16, v6
  v_mul_u32_u24 v7, 3520, v6
  v_lshl_add_u32 v25, v5, 4, v7
  v_subrev_u32 v25, 1024, v25
  v_add_u32 v5, 128, v8
  v_mul_u32_u24 v6, 3277, v5
  v_lshrrev_b32 v6, 16, v6
  v_mul_u32_u24 v7, 3520, v6
  v_lshl_add_u32 v26, v5, 4, v7
  v_subrev_u32 v26, 2048, v26
  v_add_u32 v5, 192, v8
  v_mul_u32_u24 v6, 3277, v5
  v_lshrrev_b32 v6, 16, v6
  v_mul_u32_u24 v7, 3520, v6
  v_lshl_add_u32 v27, v5, 4, v7
  v_subrev_u32 v27, 3072, v27
  v_add_u32 v5, 256, v8
  v_mul_u32_u24 v6, 3277, v5
  v_lshrrev_b32 v6, 16, v6
  v_mul_u32_u24 v7, 3520, v6
  v_lshl_add_u32 v28, v5, 4, v7
  s_lshl_b32 s68, s43, 6
  s_mul_i32 s52, s58, 245760
  s_add_u32 s52, s52, s68
  s_add_u32 m0, s54, s48
  s_nop 0
  buffer_load_dwordx4 v24, s[32:35], s52 offen offset:0  lds
  buffer_load_dwordx4 v25, s[32:35], s52 offen offset:1024  lds
  buffer_load_dwordx4 v26, s[32:35], s52 offen offset:2048  lds
  buffer_load_dwordx4 v27, s[32:35], s52 offen offset:3072  lds
  s_add_u32 m0, m0, 4096
  s_nop 0
  buffer_load_dwordx4 v28, s[32:35], s52 offen offset:0  lds
  s_add_u32 s58, s58, 1
  s_cmp_eq_u32 s58, 10
  s_cselect_b32 s58, 0, s58
  s_lshl_b32 s51, s58, 7
  s_add_u32 s51, s51, s59
  s_mul_i32 s52, s58, 245760
  s_add_u32 s52, s52, s68
  s_add_u32 s48, s48, 45056
  s_cmp_eq_u32 s48, 135168
  s_cselect_b32 s48, 0, s48
  s_add_u32 m0, s53, s48
  s_nop 0
  buffer_load_dwordx4 v16, s[28:31], s51 offen offset:0  lds
  buffer_load_dwordx4 v17, s[28:31], s51 offen offset:1024  lds
  buffer_load_dwordx4 v18, s[28:31], s51 offen offset:2048  lds
  buffer_load_dwordx4 v19, s[28:31], s51 offen offset:3072  lds
  s_add_u32 m0, s54, s48
  s_nop 0
  buffer_load_dwordx4 v24, s[32:35], s52 offen offset:0  lds
  buffer_load_dwordx4 v25, s[32:35], s52 offen offset:1024  lds
  buffer_load_dwordx4 v26, s[32:35], s52 offen offset:2048  lds
  buffer_load_dwordx4 v27, s[32:35], s52 offen offset:3072  lds
  s_add_u32 m0, m0, 4096
  s_nop 0
  buffer_load_dwordx4 v28, s[32:35], s52 offen offset:0  lds
  s_add_u32 s58, s58, 1
  s_cmp_eq_u32 s58, 10
  s_cselect_b32 s58, 0, s58
  s_lshl_b32 s51, s58, 7
  s_add_u32 s51, s51, s59
  s_mul_i32 s52, s58, 245760
  s_add_u32 s52, s52, s68
  s_add_u32 s48, s48, 45056
  s_cmp_eq_u32 s48, 135168
  s_cselect_b32 s48, 0, s48
  s_waitcnt vmcnt(9)
  s_barrier
  s_add_u32 m0, s53, s48
  s_nop 0
  buffer_load_dwordx4 v16, s[28:31], s51 offen offset:0  lds
  buffer_load_dwordx4 v17, s[28:31], s51 offen offset:1024  lds
  buffer_load_dwordx4 v18, s[28:31], s51 offen offset:2048  lds
  buffer_load_dwordx4 v19, s[28:31], s51 offen offset:3072  lds
  s_add_u32 m0, s54, s48
  s_nop 0
  buffer_load_dwordx4 v24, s[32:35], s52 offen offset:0  lds
  buffer_load_dwordx4 v25, s[32:35], s52 offen offset:1024  lds
  buffer_load_dwordx4 v26, s[32:35], s52 offen offset:2048  lds
  buffer_load_dwordx4 v27, s[32:35], s52 offen offset:3072  lds
  s_add_u32 m0, m0, 4096
  s_nop 0
  buffer_load_dwordx4 v28, s[32:35], s52 offen offset:0  lds
  s_add_u32 s58, s58, 1
  s_cmp_eq_u32 s58, 10
  s_cselect_b32 s58, 0, s58
  s_lshl_b32 s51, s58, 7
  s_add_u32 s51, s51, s59
  s_mul_i32 s52, s58, 245760
  s_add_u32 s52, s52, s68
  s_add_u32 s48, s48, 45056
  s_cmp_eq_u32 s48, 135168
  s_cselect_b32 s48, 0, s48
  s_lshl_b32 s71, s41, 2
  s_add_u32 s71, s71, s42
  s_sub_u32 s71, s71, 6
  s_lshl_b32 s71, s71, 2
  s_add_u32 s71, s71, s44
  v_lshlrev_b32 v10, 4, v4
  v_mul_u32_u24 v11, 1280, v3
  v_add_u32 v11, v11, v10
  s_mul_i32 s45, s71, 10240
  s_mov_b32 s72, s20
  s_and_b32 s73, s21, 0xffff
  s_mov_b32 s74, 1280
  s_mov_b32 s75, 0x20000
  buffer_load_dwordx4 v[40:43], v11, s[28:31], s45 offen offset:0
  buffer_load_dwordx4 v[80:83], v10, s[72:75], 0 offen offset:0
  buffer_load_dwordx4 v[44:47], v11, s[28:31], s45 offen offset:128
  buffer_load_dwordx4 v[84:87], v10, s[72:75], 0 offen offset:128
  buffer_load_dwordx4 v[48:51], v11, s[28:31], s45 offen offset:256
  buffer_load_dwordx4 v[88:91], v10, s[72:75], 0 offen offset:256
  buffer_load_dwordx4 v[52:55], v11, s[28:31], s45 offen offset:384
  buffer_load_dwordx4 v[92:95], v10, s[72:75], 0 offen offset:384
  buffer_load_dwordx4 v[56:59], v11, s[28:31], s45 offen offset:512
  buffer_load_dwordx4 v[96:99], v10, s[72:75], 0 offen offset:512
  buffer_load_dwordx4 v[60:63], v11, s[28:31], s45 offen offset:640
  buffer_load_dwordx4 v[100:103], v10, s[72:75], 0 offen offset:640
  buffer_load_dwordx4 v[64:67], v11, s[28:31], s45 offen offset:768
  buffer_load_dwordx4 v[104:107], v10, s[72:75], 0 offen offset:768
  buffer_load_dwordx4 v[68:71], v11, s[28:31], s45 offen offset:896
  buffer_load_dwordx4 v[108:111], v10, s[72:75], 0 offen offset:896
  buffer_load_dwordx4 v[72:75], v11, s[28:31], s45 offen offset:1024
  buffer_load_dwordx4 v[112:115], v10, s[72:75], 0 offen offset:1024
  buffer_load_dwordx4 v[76:79], v11, s[28:31], s45 offen offset:1152
  buffer_load_dwordx4 v[116:119], v10, s[72:75], 0 offen offset:1152
  s_mov_b32 s72, s18
  s_and_b32 s73, s19, 0xffff
  s_mov_b32 s74, 819200
  s_mov_b32 s75, 0x20000
  v_lshlrev_b32 v9, 2, v2
  s_add_u32 s61, s71, 256
  s_min_u32 s45, s71, 399
  s_mul_i32 s63, s45, 205
  s_lshr_b32 s63, s63, 10
  s_mul_i32 s46, s63, 5
  s_sub_u32 s62, s45, s46
  s_lshr_b32 s46, s63, 1
  s_mul_i32 s46, s46, 20
  s_and_b32 s47, s63, 1
  s_lshl_b32 s47, s47, 2
  s_add_u32 s46, s46, s47
  s_sub_u32 s47, s63, 64
  s_mul_i32 s47, s47, 40
  s_add_u32 s47, s47, 16
  s_cmp_lt_u32 s63, 64
  s_cselect_b32 s46, s46, s47
  s_cselect_b32 s47, 8, 20
  s_add_u32 s47, s47, s46
  s_mul_i32 s46, s46, 1280
  s_mul_i32 s47, s47, 1280
  s_lshl_b32 s45, s62, 8
  s_add_u32 s46, s46, s45
  s_add_u32 s47, s47, s45
  buffer_load_dword v120, v9, s[72:75], s46 offen offset:0
  buffer_load_dword v121, v9, s[72:75], s46 offen offset:1280
  buffer_load_dword v122, v9, s[72:75], s46 offen offset:2560
  buffer_load_dword v123, v9, s[72:75], s46 offen offset:3840
  buffer_load_dword v124, v9, s[72:75], s47 offen offset:0
  buffer_load_dword v125, v9, s[72:75], s47 offen offset:1280
  buffer_load_dword v126, v9, s[72:75], s47 offen offset:2560
  buffer_load_dword v127, v9, s[72:75], s47 offen offset:3840
  s_min_u32 s45, s61, 399
  s_mul_i32 s65, s45, 205
  s_lshr_b32 s65, s65, 10
  s_mul_i32 s46, s65, 5
  s_sub_u32 s64, s45, s46
  s_lshr_b32 s46, s65, 1
  s_mul_i32 s46, s46, 20
  s_and_b32 s47, s65, 1
  s_lshl_b32 s47, s47, 2
  s_add_u32 s46, s46, s47
  s_sub_u32 s47, s65, 64
  s_mul_i32 s47, s47, 40
  s_add_u32 s47, s47, 16
  s_cmp_lt_u32 s65, 64
  s_cselect_b32 s46, s46, s47
  s_cselect_b32 s47, 8, 20
  s_add_u32 s47, s47, s46
  s_mul_i32 s46, s46, 1280
  s_mul_i32 s47, s47, 1280
  s_lshl_b32 s45, s64, 8
  s_add_u32 s46, s46, s45
  s_add_u32 s47, s47, s45
  buffer_load_dword v128, v9, s[72:75], s46 offen offset:0
  buffer_load_dword v129, v9, s[72:75], s46 offen offset:1280
  buffer_load_dword v130, v9, s[72:75], s46 offen offset:2560
  buffer_load_dword v131, v9, s[72:75], s46 offen offset:3840
  buffer_load_dword v132, v9, s[72:75], s47 offen offset:0
  buffer_load_dword v133, v9, s[72:75], s47 offen offset:1280
  buffer_load_dword v134, v9, s[72:75], s47 offen offset:2560
  buffer_load_dword v135, v9, s[72:75], s47 offen offset:3840
  s_mov_b32 s50, 7
proj_kernel_ld_v5_loop_3:
  s_waitcnt vmcnt(9)
  s_barrier
  s_add_u32 m0, s53, s48
  s_nop 0
  buffer_load_dwordx4 v16, s[28:31], s51 offen offset:0  lds
  buffer_load_dwordx4 v17, s[28:31], s51 offen offset:1024  lds
  buffer_load_dwordx4 v18, s[28:31], s51 offen offset:2048  lds
  buffer_load_dwordx4 v19, s[28:31], s51 offen offset:3072  lds
  s_add_u32 m0, s54, s48
  s_nop 0
  buffer_load_dwordx4 v24, s[32:35], s52 offen offset:0  lds
  buffer_load_dwordx4 v25, s[32:35], s52 offen offset:1024  lds
  buffer_load_dwordx4 v26, s[32:35], s52 offen offset:2048  lds
  buffer_load_dwordx4 v27, s[32:35], s52 offen offset:3072  lds
  s_add_u32 m0, m0, 4096
  s_nop 0
  buffer_load_dwordx4 v28, s[32:35], s52 offen offset:0  lds
  s_add_u32 s58, s58, 1
  s_cmp_eq_u32 s58, 10
  s_cselect_b32 s58, 0, s58
  s_lshl_b32 s51, s58, 7
  s_add_u32 s51, s51, s59
  s_mul_i32 s52, s58, 245760
  s_add_u32 s52, s52, s68
  s_add_u32 s48, s48, 45056
  s_cmp_eq_u32 s48, 135168
  s_cselect_b32 s48, 0, s48
  s_sub_u32 s50, s50, 1
  s_cmp_lg_u32 s50, 0
  s_cbranch_scc1 proj_kernel_ld_v5_loop_3
  s_waitcnt vmcnt(9)
  s_barrier
  s_waitcnt vmcnt(0)
  s_barrier
  v_mov_b32 v12, 0
  v_dot2c_f32_bf16 v12, v40, v80
  v_dot2c_f32_bf16 v12, v41, v81
  v_dot2c_f32_bf16 v12, v42, v82
  v_dot2c_f32_bf16 v12, v43, v83
  v_dot2c_f32_bf16 v12, v44, v84
  v_dot2c_f32_bf16 v12, v45, v85
  v_dot2c_f32_bf16 v12, v46, v86
  v_dot2c_f32_bf16 v12, v47, v87
  v_dot2c_f32_bf16 v12, v48, v88
  v_dot2c_f32_bf16 v12, v49, v89
  v_dot2c_f32_bf16 v12, v50, v90
  v_dot2c_f32_bf16 v12, v51, v91
  v_dot2c_f32_bf16 v12, v52, v92
  v_dot2c_f32_bf16 v12, v53, v93
  v_dot2c_f32_bf16 v12, v54, v94
  v_dot2c_f32_bf16 v12, v55, v95
  v_dot2c_f32_bf16 v12, v56, v96
  v_dot2c_f32_bf16 v12, v57, v97
  v_dot2c_f32_bf16 v12, v58, v98
  v_dot2c_f32_bf16 v12, v59, v99
  v_dot2c_f32_bf16 v12, v60, v100
  v_dot2c_f32_bf16 v12, v61, v101
  v_dot2c_f32_bf16 v12, v62, v102
  v_dot2c_f32_bf16 v12, v63, v103
  v_dot2c_f32_bf16 v12, v64, v104
  v_dot2c_f32_bf16 v12, v65, v105
  v_dot2c_f32_bf16 v12, v66, v106
  v_dot2c_f32_bf16 v12, v67, v107
  v_dot2c_f32_bf16 v12, v68, v108
  v_dot2c_f32_bf16 v12, v69, v109
  v_dot2c_f32_bf16 v12, v70, v110
  v_dot2c_f32_bf16 v12, v71, v111
  v_dot2c_f32_bf16 v12, v72, v112
  v_dot2c_f32_bf16 v12, v73, v113
  v_dot2c_f32_bf16 v12, v74, v114
  v_dot2c_f32_bf16 v12, v75, v115
  v_dot2c_f32_bf16 v12, v76, v116
  v_dot2c_f32_bf16 v12, v77, v117
  v_dot2c_f32_bf16 v12, v78, v118
  v_dot2c_f32_bf16 v12, v79, v119
  s_nop 3
  ds_swizzle_b32 v13, v12 offset:0x41f
  s_waitcnt lgkmcnt(0)
  v_add_f32 v12, v12, v13
  ds_swizzle_b32 v13, v12 offset:0x81f
  s_waitcnt lgkmcnt(0)
  v_add_f32 v12, v12, v13
  ds_swizzle_b32 v13, v12 offset:0x101f
  s_waitcnt lgkmcnt(0)
  v_add_f32 v12, v12, v13
  v_mul_f32 v12, 0xbfb8aa3b, v12
  v_exp_f32 v12, v12
  s_nop 0
  v_add_f32 v12, 1.0, v12
  v_rcp_f32 v12, v12
  s_lshl_b32 s45, s71, 5
  s_add_u32 s45, s45, 19169280
  v_lshlrev_b32 v13, 2, v3
  v_cmp_eq_u32 vcc, 0, v4
  s_and_saveexec_b64 s[56:57], vcc
  buffer_store_dword v12, v13, s[36:39], s45 offen
  s_mov_b64 exec, 1
  v_mov_b32 v14, 0
  s_lshl_b32 s45, s71, 7
  s_add_u32 s45, s45, 19177472
  buffer_store_dword v14, v14, s[36:39], s45 offen
  s_mov_b64 exec, -1
  s_mov_b32 s56, 0x05040100
  s_mov_b32 s57, 0x07060302
  v_mul_u32_u24 v15, 20480, v3
  v_lshl_add_u32 v15, v4, 5, v15
  v_perm_b32 v140, v121, v120, s56
  v_perm_b32 v144, v121, v120, s57
  v_perm_b32 v141, v123, v122, s56
  v_perm_b32 v145, v123, v122, s57
  v_perm_b32 v142, v125, v124, s56
  v_perm_b32 v146, v125, v124, s57
  v_perm_b32 v143, v127, v126, s56
  v_perm_b32 v147, v127, v126, s57
  s_mul_i32 s45, s62, 163840
  s_lshl_b32 s46, s63, 8
  s_add_u32 s45, s45, s46
  s_add_u32 s45, s45, 18350080
  buffer_store_dwordx4 v[140:143], v15, s[36:39], s45 offen
  buffer_store_dwordx4 v[144:147], v15, s[36:39], s45 offen offset:16
  s_cmp_ge_u32 s61, 400
  s_cbranch_scc1 skipwo_5
  v_perm_b32 v148, v129, v128, s56
  v_perm_b32 v152, v129, v128, s57
  v_perm_b32 v149, v131, v130, s56
  v_perm_b32 v153, v131, v130, s57
  v_perm_b32 v150, v133, v132, s56
  v_perm_b32 v154, v133, v132, s57
  v_perm_b32 v151, v135, v134, s56
  v_perm_b32 v155, v135, v134, s57
  s_mul_i32 s45, s64, 163840
  s_lshl_b32 s46, s65, 8
  s_add_u32 s45, s45, s46
  s_add_u32 s45, s45, 18350080
  buffer_store_dwordx4 v[148:151], v15, s[36:39], s45 offen
  buffer_store_dwordx4 v[152:155], v15, s[36:39], s45 offen offset:16
skipwo_5:
  s_branch proj_kernel_end
proj_kernel_ld_row7:
  s_mul_i32 s46, s44, 7
  s_lshl_b32 s54, s46, 10
  s_add_u32 s54, s54, 16384
  s_lshl_b32 s47, s46, 3
  v_add_u32 v8, s47, v3
  v_add_u32 v5, 0, v8
  v_lshrrev_b32 v6, 1, v5
  v_and_b32 v6, 7, v6
  v_xor_b32 v6, v6, v4
  v_mul_u32_u24 v7, 1280, v5
  v_lshl_add_u32 v24, v6, 4, v7
  v_add_u32 v5, 8, v8
  v_lshrrev_b32 v6, 1, v5
  v_and_b32 v6, 7, v6
  v_xor_b32 v6, v6, v4
  v_mul_u32_u24 v7, 1280, v5
  v_lshl_add_u32 v25, v6, 4, v7
  v_subrev_u32 v25, 1024, v25
  v_add_u32 v5, 16, v8
  v_lshrrev_b32 v6, 1, v5
  v_and_b32 v6, 7, v6
  v_xor_b32 v6, v6, v4
  v_mul_u32_u24 v7, 1280, v5
  v_lshl_add_u32 v26, v6, 4, v7
  v_subrev_u32 v26, 2048, v26
  v_add_u32 v5, 24, v8
  v_lshrrev_b32 v6, 1, v5
  v_and_b32 v6, 7, v6
  v_xor_b32 v6, v6, v4
  v_mul_u32_u24 v7, 1280, v5
  v_lshl_add_u32 v27, v6, 4, v7
  v_subrev_u32 v27, 3072, v27
  v_add_u32 v5, 32, v8
  v_lshrrev_b32 v6, 1, v5
  v_and_b32 v6, 7, v6
  v_xor_b32 v6, v6, v4
  v_mul_u32_u24 v7, 1280, v5
  v_lshl_add_u32 v28, v6, 4, v7
  v_add_u32 v5, 40, v8
  v_lshrrev_b32 v6, 1, v5
  v_and_b32 v6, 7, v6
  v_xor_b32 v6, v6, v4
  v_mul_u32_u24 v7, 1280, v5
  v_lshl_add_u32 v29, v6, 4, v7
  v_subrev_u32 v29, 1024, v29
  v_add_u32 v5, 48, v8
  v_lshrrev_b32 v6, 1, v5
  v_and_b32 v6, 7, v6
  v_xor_b32 v6, v6, v4
  v_mul_u32_u24 v7, 1280, v5
  v_lshl_add_u32 v30, v6, 4, v7
  v_subrev_u32 v30, 2048, v30
  s_mul_i32 s68, s43, 40960
  s_mul_i32 s52, s58, 128
  s_add_u32 s52, s52, s68
  s_add_u32 m0, s54, s48
  s_nop 0
  buffer_load_dwordx4 v24, s[32:35], s52 offen offset:0  lds
  buffer_load_dwordx4 v25, s[32:35], s52 offen offset:1024  lds
  buffer_load_dwordx4 v26, s[32:35], s52 offen offset:2048  lds
  buffer_load_dwordx4 v27, s[32:35], s52 offen offset:3072  lds
  s_add_u32 m0, m0, 4096
  s_nop 0
  buffer_load_dwordx4 v28, s[32:35], s52 offen offset:0  lds
  buffer_load_dwordx4 v29, s[32:35], s52 offen offset:1024  lds
  buffer_load_dwordx4 v30, s[32:35], s52 offen offset:2048  lds
  s_add_u32 s58, s58, 1
  s_cmp_eq_u32 s58, 10
  s_cselect_b32 s58, 0, s58
  s_lshl_b32 s51, s58, 7
  s_add_u32 s51, s51, s59
  s_mul_i32 s52, s58, 128
  s_add_u32 s52, s52, s68
  s_add_u32 s48, s48, 45056
  s_cmp_eq_u32 s48, 135168
  s_cselect_b32 s48, 0, s48
  s_add_u32 m0, s53, s48
  s_nop 0
  buffer_load_dwordx4 v16, s[28:31], s51 offen offset:0  lds
  buffer_load_dwordx4 v17, s[28:31], s51 offen offset:1024  lds
  buffer_load_dwordx4 v18, s[28:31], s51 offen offset:2048  lds
  buffer_load_dwordx4 v19, s[28:31], s51 offen offset:3072  lds
  s_add_u32 m0, s54, s48
  s_nop 0
  buffer_load_dwordx4 v24, s[32:35], s52 offen offset:0  lds
  buffer_load_dwordx4 v25, s[32:35], s52 offen offset:1024  lds
  buffer_load_dwordx4 v26, s[32:35], s52 offen offset:2048  lds
  buffer_load_dwordx4 v27, s[32:35], s52 offen offset:3072  lds
  s_add_u32 m0, m0, 4096
  s_nop 0
  buffer_load_dwordx4 v28, s[32:35], s52 offen offset:0  lds
  buffer_load_dwordx4 v29, s[32:35], s52 offen offset:1024  lds
  buffer_load_dwordx4 v30, s[32:35], s52 offen offset:2048  lds
  s_add_u32 s58, s58, 1
  s_cmp_eq_u32 s58, 10
  s_cselect_b32 s58, 0, s58
  s_lshl_b32 s51, s58, 7
  s_add_u32 s51, s51, s59
  s_mul_i32 s52, s58, 128
  s_add_u32 s52, s52, s68
  s_add_u32 s48, s48, 45056
  s_cmp_eq_u32 s48, 135168
  s_cselect_b32 s48, 0, s48
  s_waitcnt vmcnt(11)
  s_barrier
  s_add_u32 m0, s53, s48
  s_nop 0
  buffer_load_dwordx4 v16, s[28:31], s51 offen offset:0  lds
  buffer_load_dwordx4 v17, s[28:31], s51 offen offset:1024  lds
  buffer_load_dwordx4 v18, s[28:31], s51 offen offset:2048  lds
  buffer_load_dwordx4 v19, s[28:31], s51 offen offset:3072  lds
  s_add_u32 m0, s54, s48
  s_nop 0
  buffer_load_dwordx4 v24, s[32:35], s52 offen offset:0  lds
  buffer_load_dwordx4 v25, s[32:35], s52 offen offset:1024  lds
  buffer_load_dwordx4 v26, s[32:35], s52 offen offset:2048  lds
  buffer_load_dwordx4 v27, s[32:35], s52 offen offset:3072  lds
  s_add_u32 m0, m0, 4096
  s_nop 0
  buffer_load_dwordx4 v28, s[32:35], s52 offen offset:0  lds
  buffer_load_dwordx4 v29, s[32:35], s52 offen offset:1024  lds
  buffer_load_dwordx4 v30, s[32:35], s52 offen offset:2048  lds
  s_add_u32 s58, s58, 1
  s_cmp_eq_u32 s58, 10
  s_cselect_b32 s58, 0, s58
  s_lshl_b32 s51, s58, 7
  s_add_u32 s51, s51, s59
  s_mul_i32 s52, s58, 128
  s_add_u32 s52, s52, s68
  s_add_u32 s48, s48, 45056
  s_cmp_eq_u32 s48, 135168
  s_cselect_b32 s48, 0, s48
  s_mov_b32 s50, 7
proj_kernel_ld_row7_loop_6:
  s_waitcnt vmcnt(11)
  s_barrier
  s_add_u32 m0, s53, s48
  s_nop 0
  buffer_load_dwordx4 v16, s[28:31], s51 offen offset:0  lds
  buffer_load_dwordx4 v17, s[28:31], s51 offen offset:1024  lds
  buffer_load_dwordx4 v18, s[28:31], s51 offen offset:2048  lds
  buffer_load_dwordx4 v19, s[28:31], s51 offen offset:3072  lds
  s_add_u32 m0, s54, s48
  s_nop 0
  buffer_load_dwordx4 v24, s[32:35], s52 offen offset:0  lds
  buffer_load_dwordx4 v25, s[32:35], s52 offen offset:1024  lds
  buffer_load_dwordx4 v26, s[32:35], s52 offen offset:2048  lds
  buffer_load_dwordx4 v27, s[32:35], s52 offen offset:3072  lds
  s_add_u32 m0, m0, 4096
  s_nop 0
  buffer_load_dwordx4 v28, s[32:35], s52 offen offset:0  lds
  buffer_load_dwordx4 v29, s[32:35], s52 offen offset:1024  lds
  buffer_load_dwordx4 v30, s[32:35], s52 offen offset:2048  lds
  s_add_u32 s58, s58, 1
  s_cmp_eq_u32 s58, 10
  s_cselect_b32 s58, 0, s58
  s_lshl_b32 s51, s58, 7
  s_add_u32 s51, s51, s59
  s_mul_i32 s52, s58, 128
  s_add_u32 s52, s52, s68
  s_add_u32 s48, s48, 45056
  s_cmp_eq_u32 s48, 135168
  s_cselect_b32 s48, 0, s48
  s_sub_u32 s50, s50, 1
  s_cmp_lg_u32 s50, 0
  s_cbranch_scc1 proj_kernel_ld_row7_loop_6
  s_waitcnt vmcnt(11)
  s_barrier
  s_waitcnt vmcnt(0)
  s_barrier
  s_branch proj_kernel_end
proj_kernel_ld_row6:
  s_mul_i32 s46, s44, 6
  s_lshl_b32 s54, s46, 10
  s_add_u32 s54, s54, 16384
  s_lshl_b32 s47, s46, 3
  v_add_u32 v8, s47, v3
  v_add_u32 v5, 0, v8
  v_lshrrev_b32 v6, 1, v5
  v_and_b32 v6, 7, v6
  v_xor_b32 v6, v6, v4
  v_mul_u32_u24 v7, 1280, v5
  v_lshl_add_u32 v24, v6, 4, v7
  v_add_u32 v5, 8, v8
  v_lshrrev_b32 v6, 1, v5
  v_and_b32 v6, 7, v6
  v_xor_b32 v6, v6, v4
  v_mul_u32_u24 v7, 1280, v5
  v_lshl_add_u32 v25, v6, 4, v7
  v_subrev_u32 v25, 1024, v25
  v_add_u32 v5, 16, v8
  v_lshrrev_b32 v6, 1, v5
  v_and_b32 v6, 7, v6
  v_xor_b32 v6, v6, v4
  v_mul_u32_u24 v7, 1280, v5
  v_lshl_add_u32 v26, v6, 4, v7
  v_subrev_u32 v26, 2048, v26
  v_add_u32 v5, 24, v8
  v_lshrrev_b32 v6, 1, v5
  v_and_b32 v6, 7, v6
  v_xor_b32 v6, v6, v4
  v_mul_u32_u24 v7, 1280, v5
  v_lshl_add_u32 v27, v6, 4, v7
  v_subrev_u32 v27, 3072, v27
  v_add_u32 v5, 32, v8
  v_lshrrev_b32 v6, 1, v5
  v_and_b32 v6, 7, v6
  v_xor_b32 v6, v6, v4
  v_mul_u32_u24 v7, 1280, v5
  v_lshl_add_u32 v28, v6, 4, v7
  v_add_u32 v5, 40, v8
  v_lshrrev_b32 v6, 1, v5
  v_and_b32 v6, 7, v6
  v_xor_b32 v6, v6, v4
  v_mul_u32_u24 v7, 1280, v5
  v_lshl_add_u32 v29, v6, 4, v7
  v_subrev_u32 v29, 1024, v29
  s_mul_i32 s68, s43, 40960
  s_mul_i32 s52, s58, 128
  s_add_u32 s52, s52, s68
  s_add_u32 m0, s54, s48
  s_nop 0
  buffer_load_dwordx4 v24, s[32:35], s52 offen offset:0  lds
  buffer_load_dwordx4 v25, s[32:35], s52 offen offset:1024  lds
  buffer_load_dwordx4 v26, s[32:35], s52 offen offset:2048  lds
  buffer_load_dwordx4 v27, s[32:35], s52 offen offset:3072  lds
  s_add_u32 m0, m0, 4096
  s_nop 0
  buffer_load_dwordx4 v28, s[32:35], s52 offen offset:0  lds
  buffer_load_dwordx4 v29, s[32:35], s52 offen offset:1024  lds
  s_add_u32 s58, s58, 1
  s_cmp_eq_u32 s58, 10
  s_cselect_b32 s58, 0, s58
  s_lshl_b32 s51, s58, 7
  s_add_u32 s51, s51, s59
  s_mul_i32 s52, s58, 128
  s_add_u32 s52, s52, s68
  s_add_u32 s48, s48, 45056
  s_cmp_eq_u32 s48, 135168
  s_cselect_b32 s48, 0, s48
  s_add_u32 m0, s53, s48
  s_nop 0
  buffer_load_dwordx4 v16, s[28:31], s51 offen offset:0  lds
  buffer_load_dwordx4 v17, s[28:31], s51 offen offset:1024  lds
  buffer_load_dwordx4 v18, s[28:31], s51 offen offset:2048  lds
  buffer_load_dwordx4 v19, s[28:31], s51 offen offset:3072  lds
  s_add_u32 m0, s54, s48
  s_nop 0
  buffer_load_dwordx4 v24, s[32:35], s52 offen offset:0  lds
  buffer_load_dwordx4 v25, s[32:35], s52 offen offset:1024  lds
  buffer_load_dwordx4 v26, s[32:35], s52 offen offset:2048  lds
  buffer_load_dwordx4 v27, s[32:35], s52 offen offset:3072  lds
  s_add_u32 m0, m0, 4096
  s_nop 0
  buffer_load_dwordx4 v28, s[32:35], s52 offen offset:0  lds
  buffer_load_dwordx4 v29, s[32:35], s52 offen offset:1024  lds
  s_add_u32 s58, s58, 1
  s_cmp_eq_u32 s58, 10
  s_cselect_b32 s58, 0, s58
  s_lshl_b32 s51, s58, 7
  s_add_u32 s51, s51, s59
  s_mul_i32 s52, s58, 128
  s_add_u32 s52, s52, s68
  s_add_u32 s48, s48, 45056
  s_cmp_eq_u32 s48, 135168
  s_cselect_b32 s48, 0, s48
  s_waitcnt vmcnt(10)
  s_barrier
  s_add_u32 m0, s53, s48
  s_nop 0
  buffer_load_dwordx4 v16, s[28:31], s51 offen offset:0  lds
  buffer_load_dwordx4 v17, s[28:31], s51 offen offset:1024  lds
  buffer_load_dwordx4 v18, s[28:31], s51 offen offset:2048  lds
  buffer_load_dwordx4 v19, s[28:31], s51 offen offset:3072  lds
  s_add_u32 m0, s54, s48
  s_nop 0
  buffer_load_dwordx4 v24, s[32:35], s52 offen offset:0  lds
  buffer_load_dwordx4 v25, s[32:35], s52 offen offset:1024  lds
  buffer_load_dwordx4 v26, s[32:35], s52 offen offset:2048  lds
  buffer_load_dwordx4 v27, s[32:35], s52 offen offset:3072  lds
  s_add_u32 m0, m0, 4096
  s_nop 0
  buffer_load_dwordx4 v28, s[32:35], s52 offen offset:0  lds
  buffer_load_dwordx4 v29, s[32:35], s52 offen offset:1024  lds
  s_add_u32 s58, s58, 1
  s_cmp_eq_u32 s58, 10
  s_cselect_b32 s58, 0, s58
  s_lshl_b32 s51, s58, 7
  s_add_u32 s51, s51, s59
  s_mul_i32 s52, s58, 128
  s_add_u32 s52, s52, s68
  s_add_u32 s48, s48, 45056
  s_cmp_eq_u32 s48, 135168
  s_cselect_b32 s48, 0, s48
  s_mov_b32 s50, 7
proj_kernel_ld_row6_loop_7:
  s_waitcnt vmcnt(10)
  s_barrier
  s_add_u32 m0, s53, s48
  s_nop 0
  buffer_load_dwordx4 v16, s[28:31], s51 offen offset:0  lds
  buffer_load_dwordx4 v17, s[28:31], s51 offen offset:1024  lds
  buffer_load_dwordx4 v18, s[28:31], s51 offen offset:2048  lds
  buffer_load_dwordx4 v19, s[28:31], s51 offen offset:3072  lds
  s_add_u32 m0, s54, s48
  s_nop 0
  buffer_load_dwordx4 v24, s[32:35], s52 offen offset:0  lds
  buffer_load_dwordx4 v25, s[32:35], s52 offen offset:1024  lds
  buffer_load_dwordx4 v26, s[32:35], s52 offen offset:2048  lds
  buffer_load_dwordx4 v27, s[32:35], s52 offen offset:3072  lds
  s_add_u32 m0, m0, 4096
  s_nop 0
  buffer_load_dwordx4 v28, s[32:35], s52 offen offset:0  lds
  buffer_load_dwordx4 v29, s[32:35], s52 offen offset:1024  lds
  s_add_u32 s58, s58, 1
  s_cmp_eq_u32 s58, 10
  s_cselect_b32 s58, 0, s58
  s_lshl_b32 s51, s58, 7
  s_add_u32 s51, s51, s59
  s_mul_i32 s52, s58, 128
  s_add_u32 s52, s52, s68
  s_add_u32 s48, s48, 45056
  s_cmp_eq_u32 s48, 135168
  s_cselect_b32 s48, 0, s48
  s_sub_u32 s50, s50, 1
  s_cmp_lg_u32 s50, 0
  s_cbranch_scc1 proj_kernel_ld_row6_loop_7
  s_waitcnt vmcnt(10)
  s_barrier
  s_waitcnt vmcnt(0)
  s_barrier
  s_branch proj_kernel_end
proj_kernel_c_qk7:
  v_and_b32 v12, 31, v2
  v_lshrrev_b32 v13, 5, v2
  v_lshrrev_b32 v14, 1, v12
  v_and_b32 v14, 7, v14
  s_lshl_b32 s44, s40, 12
  v_add_u32 v15, 0, v13
  v_xor_b32 v15, v15, v14
  v_lshlrev_b32 v15, 4, v15
  v_lshl_add_u32 v15, v12, 7, v15
  v_add_u32 v4, s44, v15
  v_add_u32 v15, 2, v13
  v_xor_b32 v15, v15, v14
  v_lshlrev_b32 v15, 4, v15
  v_lshl_add_u32 v15, v12, 7, v15
  v_add_u32 v5, s44, v15
  v_add_u32 v15, 4, v13
  v_xor_b32 v15, v15, v14
  v_lshlrev_b32 v15, 4, v15
  v_lshl_add_u32 v15, v12, 7, v15
  v_add_u32 v6, s44, v15
  v_add_u32 v15, 6, v13
  v_xor_b32 v15, v15, v14
  v_lshlrev_b32 v15, 4, v15
  v_lshl_add_u32 v15, v12, 7, v15
  v_add_u32 v7, s44, v15
  v_lshlrev_b32 v15, 3, v13
  v_bfe_u32 v3, v2, 2, 2
  v_add_u32 v15, v15, v3
  v_mul_u32_u24 v15, 448, v15
  v_bfe_u32 v3, v2, 4, 1
  v_lshl_add_u32 v15, v3, 5, v15
  v_and_b32 v3, 3, v2
  v_lshl_add_u32 v15, v3, 3, v15
  v_add_u32 v8, 16384, v15
  s_lshl_b32 s45, s41, 2
  s_add_u32 s45, s45, s40
  s_mul_i32 s60, s45, 2560
  v_lshlrev_b32 v16, 4, v2
  v_mul_u32_u24 v17, 163840, v13
  v_lshl_add_u32 v17, v12, 3, v17
  s_mov_b32 s56, 0x3ea52b5c
  s_mov_b32 s57, s56
  s_mov_b32 s48, 0
  s_barrier
  ds_read_b128 v[24:27], v4
  ds_read_b64_tr_b16 v[28:29], v8 offset:0
  ds_read_b64_tr_b16 v[30:31], v8 offset:1792
  ds_read_b64_tr_b16 v[32:33], v8 offset:64
  ds_read_b64_tr_b16 v[34:35], v8 offset:1856
  ds_read_b64_tr_b16 v[36:37], v8 offset:128
  ds_read_b64_tr_b16 v[38:39], v8 offset:1920
  ds_read_b64_tr_b16 v[40:41], v8 offset:192
  ds_read_b64_tr_b16 v[42:43], v8 offset:1984
  ds_read_b64_tr_b16 v[44:45], v8 offset:256
  ds_read_b64_tr_b16 v[46:47], v8 offset:2048
  ds_read_b64_tr_b16 v[48:49], v8 offset:320
  ds_read_b64_tr_b16 v[50:51], v8 offset:2112
  ds_read_b64_tr_b16 v[52:53], v8 offset:384
  ds_read_b64_tr_b16 v[54:55], v8 offset:2176
  s_waitcnt lgkmcnt(12)
  v_mfma_f32_32x32x16_bf16 v[88:103], v[28:31], v[24:27], 0
  ds_read_b128 v[56:59], v5
  ds_read_b64_tr_b16 v[60:61], v8 offset:7168
  ds_read_b64_tr_b16 v[62:63], v8 offset:8960
  s_waitcnt lgkmcnt(13)
  v_mfma_f32_32x32x16_bf16 v[104:119], v[32:35], v[24:27], 0
  ds_read_b64_tr_b16 v[64:65], v8 offset:7232
  ds_read_b64_tr_b16 v[66:67], v8 offset:9024
  s_waitcnt lgkmcnt(13)
  v_mfma_f32_32x32x16_bf16 v[120:135], v[36:39], v[24:27], 0
  ds_read_b64_tr_b16 v[68:69], v8 offset:7296
  ds_read_b64_tr_b16 v[70:71], v8 offset:9088
  s_waitcnt lgkmcnt(13)
  v_mfma_f32_32x32x16_bf16 v[136:151], v[40:43], v[24:27], 0
  ds_read_b64_tr_b16 v[72:73], v8 offset:7360
  ds_read_b64_tr_b16 v[74:75], v8 offset:9152
  s_waitcnt lgkmcnt(13)
  v_mfma_f32_32x32x16_bf16 v[152:167], v[44:47], v[24:27], 0
  ds_read_b64_tr_b16 v[76:77], v8 offset:7424
  ds_read_b64_tr_b16 v[78:79], v8 offset:9216
  s_waitcnt lgkmcnt(13)
  v_mfma_f32_32x32x16_bf16 v[168:183], v[48:51], v[24:27], 0
  ds_read_b64_tr_b16 v[80:81], v8 offset:7488
  ds_read_b64_tr_b16 v[82:83], v8 offset:9280
  s_waitcnt lgkmcnt(13)
  v_mfma_f32_32x32x16_bf16 v[184:199], v[52:55], v[24:27], 0
  ds_read_b64_tr_b16 v[84:85], v8 offset:7552
  ds_read_b64_tr_b16 v[86:87], v8 offset:9344
  s_waitcnt lgkmcnt(12)
  v_mfma_f32_32x32x16_bf16 v[88:103], v[60:63], v[56:59], v[88:103]
  ds_read_b128 v[24:27], v6
  ds_read_b64_tr_b16 v[28:29], v8 offset:14336
  ds_read_b64_tr_b16 v[30:31], v8 offset:16128
  s_waitcnt lgkmcnt(13)
  v_mfma_f32_32x32x16_bf16 v[104:119], v[64:67], v[56:59], v[104:119]
  ds_read_b64_tr_b16 v[32:33], v8 offset:14400
  ds_read_b64_tr_b16 v[34:35], v8 offset:16192
  s_waitcnt lgkmcnt(13)
  v_mfma_f32_32x32x16_bf16 v[120:135], v[68:71], v[56:59], v[120:135]
  ds_read_b64_tr_b16 v[36:37], v8 offset:14464
  ds_read_b64_tr_b16 v[38:39], v8 offset:16256
  s_waitcnt lgkmcnt(13)
  v_mfma_f32_32x32x16_bf16 v[136:151], v[72:75], v[56:59], v[136:151]
  ds_read_b64_tr_b16 v[40:41], v8 offset:14528
  ds_read_b64_tr_b16 v[42:43], v8 offset:16320
  s_waitcnt lgkmcnt(13)
  v_mfma_f32_32x32x16_bf16 v[152:167], v[76:79], v[56:59], v[152:167]
  ds_read_b64_tr_b16 v[44:45], v8 offset:14592
  ds_read_b64_tr_b16 v[46:47], v8 offset:16384
  s_waitcnt lgkmcnt(13)
  v_mfma_f32_32x32x16_bf16 v[168:183], v[80:83], v[56:59], v[168:183]
  ds_read_b64_tr_b16 v[48:49], v8 offset:14656
  ds_read_b64_tr_b16 v[50:51], v8 offset:16448
  s_waitcnt lgkmcnt(13)
  v_mfma_f32_32x32x16_bf16 v[184:199], v[84:87], v[56:59], v[184:199]
  ds_read_b64_tr_b16 v[52:53], v8 offset:14720
  ds_read_b64_tr_b16 v[54:55], v8 offset:16512
  s_waitcnt lgkmcnt(12)
  v_mfma_f32_32x32x16_bf16 v[88:103], v[28:31], v[24:27], v[88:103]
  ds_read_b128 v[56:59], v7
  ds_read_b64_tr_b16 v[60:61], v8 offset:21504
  ds_read_b64_tr_b16 v[62:63], v8 offset:23296
  s_waitcnt lgkmcnt(13)
  v_mfma_f32_32x32x16_bf16 v[104:119], v[32:35], v[24:27], v[104:119]
  ds_read_b64_tr_b16 v[64:65], v8 offset:21568
  ds_read_b64_tr_b16 v[66:67], v8 offset:23360
  s_waitcnt lgkmcnt(13)
  v_mfma_f32_32x32x16_bf16 v[120:135], v[36:39], v[24:27], v[120:135]
  ds_read_b64_tr_b16 v[68:69], v8 offset:21632
  ds_read_b64_tr_b16 v[70:71], v8 offset:23424
  s_waitcnt lgkmcnt(13)
  v_mfma_f32_32x32x16_bf16 v[136:151], v[40:43], v[24:27], v[136:151]
  ds_read_b64_tr_b16 v[72:73], v8 offset:21696
  ds_read_b64_tr_b16 v[74:75], v8 offset:23488
  s_waitcnt lgkmcnt(13)
  v_mfma_f32_32x32x16_bf16 v[152:167], v[44:47], v[24:27], v[152:167]
  ds_read_b64_tr_b16 v[76:77], v8 offset:21760
  ds_read_b64_tr_b16 v[78:79], v8 offset:23552
  s_waitcnt lgkmcnt(13)
  v_mfma_f32_32x32x16_bf16 v[168:183], v[48:51], v[24:27], v[168:183]
  ds_read_b64_tr_b16 v[80:81], v8 offset:21824
  ds_read_b64_tr_b16 v[82:83], v8 offset:23616
  s_waitcnt lgkmcnt(13)
  v_mfma_f32_32x32x16_bf16 v[184:199], v[52:55], v[24:27], v[184:199]
  ds_read_b64_tr_b16 v[84:85], v8 offset:21888
  ds_read_b64_tr_b16 v[86:87], v8 offset:23680
  s_waitcnt lgkmcnt(12)
  v_mfma_f32_32x32x16_bf16 v[88:103], v[60:63], v[56:59], v[88:103]
  s_mov_b32 s49, s48
  s_add_u32 s48, s48, 45056
  s_cmp_eq_u32 s48, 135168
  s_cselect_b32 s48, 0, s48
  s_sub_u32 s49, s48, s49
  v_add_u32 v4, s49, v4
  v_add_u32 v5, s49, v5
  v_add_u32 v6, s49, v6
  v_add_u32 v7, s49, v7
  v_add_u32 v8, s49, v8
  s_waitcnt lgkmcnt(10)
  v_mfma_f32_32x32x16_bf16 v[104:119], v[64:67], v[56:59], v[104:119]
  s_waitcnt lgkmcnt(0)
  s_mov_b32 s50, 8
proj_kernel_c_qk7_loop_8:
  s_barrier
  ds_read_b128 v[24:27], v4
  ds_read_b64_tr_b16 v[28:29], v8 offset:0
  ds_read_b64_tr_b16 v[30:31], v8 offset:1792
  ds_read_b64_tr_b16 v[32:33], v8 offset:64
  ds_read_b64_tr_b16 v[34:35], v8 offset:1856
  v_mfma_f32_32x32x16_bf16 v[120:135], v[68:71], v[56:59], v[120:135]
  ds_read_b64_tr_b16 v[36:37], v8 offset:128
  ds_read_b64_tr_b16 v[38:39], v8 offset:1920
  v_mfma_f32_32x32x16_bf16 v[136:151], v[72:75], v[56:59], v[136:151]
  ds_read_b64_tr_b16 v[40:41], v8 offset:192
  ds_read_b64_tr_b16 v[42:43], v8 offset:1984
  v_mfma_f32_32x32x16_bf16 v[152:167], v[76:79], v[56:59], v[152:167]
  ds_read_b64_tr_b16 v[44:45], v8 offset:256
  ds_read_b64_tr_b16 v[46:47], v8 offset:2048
  v_mfma_f32_32x32x16_bf16 v[168:183], v[80:83], v[56:59], v[168:183]
  ds_read_b64_tr_b16 v[48:49], v8 offset:320
  ds_read_b64_tr_b16 v[50:51], v8 offset:2112
  v_mfma_f32_32x32x16_bf16 v[184:199], v[84:87], v[56:59], v[184:199]
  ds_read_b64_tr_b16 v[52:53], v8 offset:384
  ds_read_b64_tr_b16 v[54:55], v8 offset:2176
  s_waitcnt lgkmcnt(12)
  v_mfma_f32_32x32x16_bf16 v[88:103], v[28:31], v[24:27], v[88:103]
  ds_read_b128 v[56:59], v5
  ds_read_b64_tr_b16 v[60:61], v8 offset:7168
  ds_read_b64_tr_b16 v[62:63], v8 offset:8960
  s_waitcnt lgkmcnt(13)
  v_mfma_f32_32x32x16_bf16 v[104:119], v[32:35], v[24:27], v[104:119]
  ds_read_b64_tr_b16 v[64:65], v8 offset:7232
  ds_read_b64_tr_b16 v[66:67], v8 offset:9024
  s_waitcnt lgkmcnt(13)
  v_mfma_f32_32x32x16_bf16 v[120:135], v[36:39], v[24:27], v[120:135]
  ds_read_b64_tr_b16 v[68:69], v8 offset:7296
  ds_read_b64_tr_b16 v[70:71], v8 offset:9088
  s_waitcnt lgkmcnt(13)
  v_mfma_f32_32x32x16_bf16 v[136:151], v[40:43], v[24:27], v[136:151]
  ds_read_b64_tr_b16 v[72:73], v8 offset:7360
  ds_read_b64_tr_b16 v[74:75], v8 offset:9152
  s_waitcnt lgkmcnt(13)
  v_mfma_f32_32x32x16_bf16 v[152:167], v[44:47], v[24:27], v[152:167]
  ds_read_b64_tr_b16 v[76:77], v8 offset:7424
  ds_read_b64_tr_b16 v[78:79], v8 offset:9216
  s_waitcnt lgkmcnt(13)
  v_mfma_f32_32x32x16_bf16 v[168:183], v[48:51], v[24:27], v[168:183]
  ds_read_b64_tr_b16 v[80:81], v8 offset:7488
  ds_read_b64_tr_b16 v[82:83], v8 offset:9280
  s_waitcnt lgkmcnt(13)
  v_mfma_f32_32x32x16_bf16 v[184:199], v[52:55], v[24:27], v[184:199]
  ds_read_b64_tr_b16 v[84:85], v8 offset:7552
  ds_read_b64_tr_b16 v[86:87], v8 offset:9344
  s_waitcnt lgkmcnt(12)
  v_mfma_f32_32x32x16_bf16 v[88:103], v[60:63], v[56:59], v[88:103]
  ds_read_b128 v[24:27], v6
  ds_read_b64_tr_b16 v[28:29], v8 offset:14336
  ds_read_b64_tr_b16 v[30:31], v8 offset:16128
  s_waitcnt lgkmcnt(13)
  v_mfma_f32_32x32x16_bf16 v[104:119], v[64:67], v[56:59], v[104:119]
  ds_read_b64_tr_b16 v[32:33], v8 offset:14400
  ds_read_b64_tr_b16 v[34:35], v8 offset:16192
  s_waitcnt lgkmcnt(13)
  v_mfma_f32_32x32x16_bf16 v[120:135], v[68:71], v[56:59], v[120:135]
  ds_read_b64_tr_b16 v[36:37], v8 offset:14464
  ds_read_b64_tr_b16 v[38:39], v8 offset:16256
  s_waitcnt lgkmcnt(13)
  v_mfma_f32_32x32x16_bf16 v[136:151], v[72:75], v[56:59], v[136:151]
  ds_read_b64_tr_b16 v[40:41], v8 offset:14528
  ds_read_b64_tr_b16 v[42:43], v8 offset:16320
  s_waitcnt lgkmcnt(13)
  v_mfma_f32_32x32x16_bf16 v[152:167], v[76:79], v[56:59], v[152:167]
  ds_read_b64_tr_b16 v[44:45], v8 offset:14592
  ds_read_b64_tr_b16 v[46:47], v8 offset:16384
  s_waitcnt lgkmcnt(13)
  v_mfma_f32_32x32x16_bf16 v[168:183], v[80:83], v[56:59], v[168:183]
  ds_read_b64_tr_b16 v[48:49], v8 offset:14656
  ds_read_b64_tr_b16 v[50:51], v8 offset:16448
  s_waitcnt lgkmcnt(13)
  v_mfma_f32_32x32x16_bf16 v[184:199], v[84:87], v[56:59], v[184:199]
  ds_read_b64_tr_b16 v[52:53], v8 offset:14720
  ds_read_b64_tr_b16 v[54:55], v8 offset:16512
  s_waitcnt lgkmcnt(12)
  v_mfma_f32_32x32x16_bf16 v[88:103], v[28:31], v[24:27], v[88:103]
  ds_read_b128 v[56:59], v7
  ds_read_b64_tr_b16 v[60:61], v8 offset:21504
  ds_read_b64_tr_b16 v[62:63], v8 offset:23296
  s_waitcnt lgkmcnt(13)
  v_mfma_f32_32x32x16_bf16 v[104:119], v[32:35], v[24:27], v[104:119]
  ds_read_b64_tr_b16 v[64:65], v8 offset:21568
  ds_read_b64_tr_b16 v[66:67], v8 offset:23360
  s_waitcnt lgkmcnt(13)
  v_mfma_f32_32x32x16_bf16 v[120:135], v[36:39], v[24:27], v[120:135]
  ds_read_b64_tr_b16 v[68:69], v8 offset:21632
  ds_read_b64_tr_b16 v[70:71], v8 offset:23424
  s_waitcnt lgkmcnt(13)
  v_mfma_f32_32x32x16_bf16 v[136:151], v[40:43], v[24:27], v[136:151]
  ds_read_b64_tr_b16 v[72:73], v8 offset:21696
  ds_read_b64_tr_b16 v[74:75], v8 offset:23488
  s_waitcnt lgkmcnt(13)
  v_mfma_f32_32x32x16_bf16 v[152:167], v[44:47], v[24:27], v[152:167]
  ds_read_b64_tr_b16 v[76:77], v8 offset:21760
  ds_read_b64_tr_b16 v[78:79], v8 offset:23552
  s_waitcnt lgkmcnt(13)
  v_mfma_f32_32x32x16_bf16 v[168:183], v[48:51], v[24:27], v[168:183]
  ds_read_b64_tr_b16 v[80:81], v8 offset:21824
  ds_read_b64_tr_b16 v[82:83], v8 offset:23616
  s_waitcnt lgkmcnt(13)
  v_mfma_f32_32x32x16_bf16 v[184:199], v[52:55], v[24:27], v[184:199]
  ds_read_b64_tr_b16 v[84:85], v8 offset:21888
  ds_read_b64_tr_b16 v[86:87], v8 offset:23680
  s_waitcnt lgkmcnt(12)
  v_mfma_f32_32x32x16_bf16 v[88:103], v[60:63], v[56:59], v[88:103]
  s_mov_b32 s49, s48
  s_add_u32 s48, s48, 45056
  s_cmp_eq_u32 s48, 135168
  s_cselect_b32 s48, 0, s48
  s_sub_u32 s49, s48, s49
  v_add_u32 v4, s49, v4
  v_add_u32 v5, s49, v5
  v_add_u32 v6, s49, v6
  v_add_u32 v7, s49, v7
  v_add_u32 v8, s49, v8
  s_waitcnt lgkmcnt(10)
  v_mfma_f32_32x32x16_bf16 v[104:119], v[64:67], v[56:59], v[104:119]
  s_waitcnt lgkmcnt(0)
  s_sub_u32 s50, s50, 1
  s_cmp_lg_u32 s50, 0
  s_cbranch_scc1 proj_kernel_c_qk7_loop_8
  s_cmp_eq_u32 s42, 1
  s_cbranch_scc1 proj_kernel_c_qk7_e1
  s_cmp_eq_u32 s42, 2
  s_cbranch_scc1 proj_kernel_c_qk7_e2
  s_cmp_eq_u32 s42, 3
  s_cbranch_scc1 proj_kernel_c_qk7_e3
  s_cmp_eq_u32 s42, 4
  s_cbranch_scc1 proj_kernel_c_qk7_e4
proj_kernel_c_qk7_e0:
  s_barrier
  ds_read_b128 v[24:27], v4
  ds_read_b128 v[28:31], v5
  ds_read_b128 v[32:35], v6
  ds_read_b128 v[36:39], v7
  v_mfma_f32_32x32x16_bf16 v[120:135], v[68:71], v[56:59], v[120:135]
  ds_read_b64_tr_b16 v[40:41], v8 offset:0
  ds_read_b64_tr_b16 v[42:43], v8 offset:1792
  ds_read_b64_tr_b16 v[44:45], v8 offset:7168
  ds_read_b64_tr_b16 v[46:47], v8 offset:8960
  v_mfma_f32_32x32x16_bf16 v[136:151], v[72:75], v[56:59], v[136:151]
  ds_read_b64_tr_b16 v[48:49], v8 offset:14336
  ds_read_b64_tr_b16 v[50:51], v8 offset:16128
  ds_read_b64_tr_b16 v[52:53], v8 offset:21504
  ds_read_b64_tr_b16 v[54:55], v8 offset:23296
  v_mfma_f32_32x32x16_bf16 v[152:167], v[76:79], v[56:59], v[152:167]
  ds_read_b64_tr_b16 v[204:205], v8 offset:64
  ds_read_b64_tr_b16 v[206:207], v8 offset:1856
  ds_read_b64_tr_b16 v[208:209], v8 offset:7232
  ds_read_b64_tr_b16 v[210:211], v8 offset:9024
  v_mfma_f32_32x32x16_bf16 v[168:183], v[80:83], v[56:59], v[168:183]
  ds_read_b64_tr_b16 v[212:213], v8 offset:14400
  ds_read_b64_tr_b16 v[214:215], v8 offset:16192
  ds_read_b64_tr_b16 v[216:217], v8 offset:21568
  ds_read_b64_tr_b16 v[218:219], v8 offset:23360
  v_mfma_f32_32x32x16_bf16 v[184:199], v[84:87], v[56:59], v[184:199]
  s_waitcnt lgkmcnt(8)
  v_mfma_f32_32x32x16_bf16 v[88:103], v[40:43], v[24:27], v[88:103]
  v_mfma_f32_32x32x16_bf16 v[88:103], v[44:47], v[28:31], v[88:103]
  ds_read_b64_tr_b16 v[220:221], v8 offset:128
  ds_read_b64_tr_b16 v[222:223], v8 offset:1920
  ds_read_b64_tr_b16 v[224:225], v8 offset:7296
  v_mfma_f32_32x32x16_bf16 v[88:103], v[48:51], v[32:35], v[88:103]
  ds_read_b64_tr_b16 v[226:227], v8 offset:9088
  ds_read_b64_tr_b16 v[228:229], v8 offset:14464
  ds_read_b64_tr_b16 v[230:231], v8 offset:16256
  v_mfma_f32_32x32x16_bf16 v[88:103], v[52:55], v[36:39], v[88:103]
  ds_read_b64_tr_b16 v[232:233], v8 offset:21632
  ds_read_b64_tr_b16 v[234:235], v8 offset:23424
  s_waitcnt lgkmcnt(8)
  v_mfma_f32_32x32x16_bf16 v[104:119], v[204:207], v[24:27], v[104:119]
  v_mfma_f32_32x32x16_bf16 v[104:119], v[208:211], v[28:31], v[104:119]
  ds_read_b64_tr_b16 v[40:41], v8 offset:192
  ds_read_b64_tr_b16 v[42:43], v8 offset:1984
  ds_read_b64_tr_b16 v[44:45], v8 offset:7360
  v_mfma_f32_32x32x16_bf16 v[104:119], v[212:215], v[32:35], v[104:119]
  ds_read_b64_tr_b16 v[46:47], v8 offset:9152
  ds_read_b64_tr_b16 v[48:49], v8 offset:14528
  ds_read_b64_tr_b16 v[50:51], v8 offset:16320
  v_mfma_f32_32x32x16_bf16 v[104:119], v[216:219], v[36:39], v[104:119]
  ds_read_b64_tr_b16 v[52:53], v8 offset:21696
  ds_read_b64_tr_b16 v[54:55], v8 offset:23488
  v_pk_mul_f32 v[88:89], v[88:89], s[56:57]
  v_pk_mul_f32 v[90:91], v[90:91], s[56:57]
  v_cvt_pk_bf16_f32 v88, v88, v89
  v_cvt_pk_bf16_f32 v89, v90, v91
  v_pk_mul_f32 v[92:93], v[92:93], s[56:57]
  v_pk_mul_f32 v[94:95], v[94:95], s[56:57]
  v_cvt_pk_bf16_f32 v90, v92, v93
  v_cvt_pk_bf16_f32 v91, v94, v95
  s_add_u32 s44, s60, 0
  buffer_store_dwordx4 v[88:91], v16, s[36:39], s44 offen sc1
  v_pk_mul_f32 v[96:97], v[96:97], s[56:57]
  v_pk_mul_f32 v[98:99], v[98:99], s[56:57]
  v_cvt_pk_bf16_f32 v92, v96, v97
  v_cvt_pk_bf16_f32 v93, v98, v99
  s_add_u32 s44, s60, 0
  buffer_store_dwordx2 v[92:93], v17, s[36:39], s44 offen offset:1024 sc1
  v_pk_mul_f32 v[100:101], v[100:101], s[56:57]
  v_pk_mul_f32 v[102:103], v[102:103], s[56:57]
  v_cvt_pk_bf16_f32 v94, v100, v101
  v_cvt_pk_bf16_f32 v95, v102, v103
  s_waitcnt lgkmcnt(8)
  v_mfma_f32_32x32x16_bf16 v[120:135], v[220:223], v[24:27], v[120:135]
  v_mfma_f32_32x32x16_bf16 v[120:135], v[224:227], v[28:31], v[120:135]
  ds_read_b64_tr_b16 v[204:205], v8 offset:256
  ds_read_b64_tr_b16 v[206:207], v8 offset:2048
  ds_read_b64_tr_b16 v[208:209], v8 offset:7424
  v_mfma_f32_32x32x16_bf16 v[120:135], v[228:231], v[32:35], v[120:135]
  ds_read_b64_tr_b16 v[210:211], v8 offset:9216
  ds_read_b64_tr_b16 v[212:213], v8 offset:14592
  ds_read_b64_tr_b16 v[214:215], v8 offset:16384
  v_mfma_f32_32x32x16_bf16 v[120:135], v[232:235], v[36:39], v[120:135]
  ds_read_b64_tr_b16 v[216:217], v8 offset:21760
  ds_read_b64_tr_b16 v[218:219], v8 offset:23552
  v_pk_mul_f32 v[104:105], v[104:105], s[56:57]
  v_pk_mul_f32 v[106:107], v[106:107], s[56:57]
  v_cvt_pk_bf16_f32 v96, v104, v105
  v_cvt_pk_bf16_f32 v97, v106, v107
  s_add_u32 s44, s60, 163840
  buffer_store_dwordx4 v[94:97], v16, s[36:39], s44 offen sc1
  v_pk_mul_f32 v[108:109], v[108:109], s[56:57]
  v_pk_mul_f32 v[110:111], v[110:111], s[56:57]
  v_cvt_pk_bf16_f32 v98, v108, v109
  v_cvt_pk_bf16_f32 v99, v110, v111
  v_pk_mul_f32 v[112:113], v[112:113], s[56:57]
  v_pk_mul_f32 v[114:115], v[114:115], s[56:57]
  v_cvt_pk_bf16_f32 v100, v112, v113
  v_cvt_pk_bf16_f32 v101, v114, v115
  s_add_u32 s44, s60, 327680
  buffer_store_dwordx4 v[98:101], v16, s[36:39], s44 offen sc1
  v_pk_mul_f32 v[116:117], v[116:117], s[56:57]
  v_pk_mul_f32 v[118:119], v[118:119], s[56:57]
  v_cvt_pk_bf16_f32 v102, v116, v117
  v_cvt_pk_bf16_f32 v103, v118, v119
  s_add_u32 s44, s60, 327680
  buffer_store_dwordx2 v[102:103], v17, s[36:39], s44 offen offset:1024 sc1
  s_waitcnt lgkmcnt(8)
  v_mfma_f32_32x32x16_bf16 v[136:151], v[40:43], v[24:27], v[136:151]
  v_mfma_f32_32x32x16_bf16 v[136:151], v[44:47], v[28:31], v[136:151]
  ds_read_b64_tr_b16 v[220:221], v8 offset:320
  ds_read_b64_tr_b16 v[222:223], v8 offset:2112
  ds_read_b64_tr_b16 v[224:225], v8 offset:7488
  v_mfma_f32_32x32x16_bf16 v[136:151], v[48:51], v[32:35], v[136:151]
  ds_read_b64_tr_b16 v[226:227], v8 offset:9280
  ds_read_b64_tr_b16 v[228:229], v8 offset:14656
  ds_read_b64_tr_b16 v[230:231], v8 offset:16448
  v_mfma_f32_32x32x16_bf16 v[136:151], v[52:55], v[36:39], v[136:151]
  ds_read_b64_tr_b16 v[232:233], v8 offset:21824
  ds_read_b64_tr_b16 v[234:235], v8 offset:23616
  v_pk_mul_f32 v[120:121], v[120:121], s[56:57]
  v_pk_mul_f32 v[122:123], v[122:123], s[56:57]
  v_cvt_pk_bf16_f32 v104, v120, v121
  v_cvt_pk_bf16_f32 v105, v122, v123
  v_pk_mul_f32 v[124:125], v[124:125], s[56:57]
  v_pk_mul_f32 v[126:127], v[126:127], s[56:57]
  v_cvt_pk_bf16_f32 v106, v124, v125
  v_cvt_pk_bf16_f32 v107, v126, v127
  s_add_u32 s44, s60, 491520
  buffer_store_dwordx4 v[104:107], v16, s[36:39], s44 offen sc1
  v_pk_mul_f32 v[128:129], v[128:129], s[56:57]
  v_pk_mul_f32 v[130:131], v[130:131], s[56:57]
  v_cvt_pk_bf16_f32 v108, v128, v129
  v_cvt_pk_bf16_f32 v109, v130, v131
  v_pk_mul_f32 v[132:133], v[132:133], s[56:57]
  v_pk_mul_f32 v[134:135], v[134:135], s[56:57]
  v_cvt_pk_bf16_f32 v110, v132, v133
  v_cvt_pk_bf16_f32 v111, v134, v135
  s_add_u32 s44, s60, 655360
  buffer_store_dwordx4 v[108:111], v16, s[36:39], s44 offen sc1
  s_waitcnt lgkmcnt(8)
  v_mfma_f32_32x32x16_bf16 v[152:167], v[204:207], v[24:27], v[152:167]
  v_mfma_f32_32x32x16_bf16 v[152:167], v[208:211], v[28:31], v[152:167]
  ds_read_b64_tr_b16 v[40:41], v8 offset:384
  ds_read_b64_tr_b16 v[42:43], v8 offset:2176
  ds_read_b64_tr_b16 v[44:45], v8 offset:7552
  v_mfma_f32_32x32x16_bf16 v[152:167], v[212:215], v[32:35], v[152:167]
  ds_read_b64_tr_b16 v[46:47], v8 offset:9344
  ds_read_b64_tr_b16 v[48:49], v8 offset:14720
  ds_read_b64_tr_b16 v[50:51], v8 offset:16512
  v_mfma_f32_32x32x16_bf16 v[152:167], v[216:219], v[36:39], v[152:167]
  ds_read_b64_tr_b16 v[52:53], v8 offset:21888
  ds_read_b64_tr_b16 v[54:55], v8 offset:23680
  v_pk_mul_f32 v[136:137], v[136:137], s[56:57]
  v_pk_mul_f32 v[138:139], v[138:139], s[56:57]
  v_cvt_pk_bf16_f32 v112, v136, v137
  v_cvt_pk_bf16_f32 v113, v138, v139
  s_add_u32 s44, s60, 655360
  buffer_store_dwordx2 v[112:113], v17, s[36:39], s44 offen offset:1024 sc1
  v_pk_mul_f32 v[140:141], v[140:141], s[56:57]
  v_pk_mul_f32 v[142:143], v[142:143], s[56:57]
  v_cvt_pk_bf16_f32 v114, v140, v141
  v_cvt_pk_bf16_f32 v115, v142, v143
  v_pk_mul_f32 v[144:145], v[144:145], s[56:57]
  v_pk_mul_f32 v[146:147], v[146:147], s[56:57]
  v_cvt_pk_bf16_f32 v116, v144, v145
  v_cvt_pk_bf16_f32 v117, v146, v147
  s_add_u32 s44, s60, 819200
  buffer_store_dwordx4 v[114:117], v16, s[36:39], s44 offen sc1
  v_pk_mul_f32 v[148:149], v[148:149], s[56:57]
  v_pk_mul_f32 v[150:151], v[150:151], s[56:57]
  v_cvt_pk_bf16_f32 v118, v148, v149
  v_cvt_pk_bf16_f32 v119, v150, v151
  s_waitcnt lgkmcnt(8)
  v_mfma_f32_32x32x16_bf16 v[168:183], v[220:223], v[24:27], v[168:183]
  v_mfma_f32_32x32x16_bf16 v[168:183], v[224:227], v[28:31], v[168:183]
  v_mfma_f32_32x32x16_bf16 v[168:183], v[228:231], v[32:35], v[168:183]
  v_mfma_f32_32x32x16_bf16 v[168:183], v[232:235], v[36:39], v[168:183]
  s_nop 7
  v_pk_mul_f32 v[152:153], v[152:153], s[56:57]
  v_pk_mul_f32 v[154:155], v[154:155], s[56:57]
  v_cvt_pk_bf16_f32 v120, v152, v153
  v_cvt_pk_bf16_f32 v121, v154, v155
  s_add_u32 s44, s60, 983040
  buffer_store_dwordx4 v[118:121], v16, s[36:39], s44 offen sc1
  v_pk_mul_f32 v[156:157], v[156:157], s[56:57]
  v_pk_mul_f32 v[158:159], v[158:159], s[56:57]
  v_cvt_pk_bf16_f32 v122, v156, v157
  v_cvt_pk_bf16_f32 v123, v158, v159
  s_add_u32 s44, s60, 983040
  buffer_store_dwordx2 v[122:123], v17, s[36:39], s44 offen offset:1024 sc1
  v_pk_mul_f32 v[160:161], v[160:161], s[56:57]
  v_pk_mul_f32 v[162:163], v[162:163], s[56:57]
  v_cvt_pk_bf16_f32 v124, v160, v161
  v_cvt_pk_bf16_f32 v125, v162, v163
  v_pk_mul_f32 v[164:165], v[164:165], s[56:57]
  v_pk_mul_f32 v[166:167], v[166:167], s[56:57]
  v_cvt_pk_bf16_f32 v126, v164, v165
  v_cvt_pk_bf16_f32 v127, v166, v167
  s_add_u32 s44, s60, 1146880
  buffer_store_dwordx4 v[124:127], v16, s[36:39], s44 offen sc1
  s_waitcnt lgkmcnt(0)
  v_mfma_f32_32x32x16_bf16 v[184:199], v[40:43], v[24:27], v[184:199]
  v_mfma_f32_32x32x16_bf16 v[184:199], v[44:47], v[28:31], v[184:199]
  v_mfma_f32_32x32x16_bf16 v[184:199], v[48:51], v[32:35], v[184:199]
  v_mfma_f32_32x32x16_bf16 v[184:199], v[52:55], v[36:39], v[184:199]
  s_nop 7
  v_pk_mul_f32 v[168:169], v[168:169], s[56:57]
  v_pk_mul_f32 v[170:171], v[170:171], s[56:57]
  v_cvt_pk_bf16_f32 v128, v168, v169
  v_cvt_pk_bf16_f32 v129, v170, v171
  v_pk_mul_f32 v[172:173], v[172:173], s[56:57]
  v_pk_mul_f32 v[174:175], v[174:175], s[56:57]
  v_cvt_pk_bf16_f32 v130, v172, v173
  v_cvt_pk_bf16_f32 v131, v174, v175
  s_add_u32 s44, s60, 1310720
  buffer_store_dwordx4 v[128:131], v16, s[36:39], s44 offen sc1
  v_pk_mul_f32 v[176:177], v[176:177], s[56:57]
  v_pk_mul_f32 v[178:179], v[178:179], s[56:57]
  v_cvt_pk_bf16_f32 v132, v176, v177
  v_cvt_pk_bf16_f32 v133, v178, v179
  s_add_u32 s44, s60, 1310720
  buffer_store_dwordx2 v[132:133], v17, s[36:39], s44 offen offset:1024 sc1
  v_pk_mul_f32 v[180:181], v[180:181], s[56:57]
  v_pk_mul_f32 v[182:183], v[182:183], s[56:57]
  v_cvt_pk_bf16_f32 v134, v180, v181
  v_cvt_pk_bf16_f32 v135, v182, v183
  s_nop 3
  v_pk_mul_f32 v[184:185], v[184:185], s[56:57]
  v_pk_mul_f32 v[186:187], v[186:187], s[56:57]
  v_cvt_pk_bf16_f32 v136, v184, v185
  v_cvt_pk_bf16_f32 v137, v186, v187
  s_add_u32 s44, s60, 1474560
  buffer_store_dwordx4 v[134:137], v16, s[36:39], s44 offen sc1
  v_pk_mul_f32 v[188:189], v[188:189], s[56:57]
  v_pk_mul_f32 v[190:191], v[190:191], s[56:57]
  v_cvt_pk_bf16_f32 v138, v188, v189
  v_cvt_pk_bf16_f32 v139, v190, v191
  v_pk_mul_f32 v[192:193], v[192:193], s[56:57]
  v_pk_mul_f32 v[194:195], v[194:195], s[56:57]
  v_cvt_pk_bf16_f32 v140, v192, v193
  v_cvt_pk_bf16_f32 v141, v194, v195
  s_add_u32 s44, s60, 1638400
  buffer_store_dwordx4 v[138:141], v16, s[36:39], s44 offen sc1
  v_pk_mul_f32 v[196:197], v[196:197], s[56:57]
  v_pk_mul_f32 v[198:199], v[198:199], s[56:57]
  v_cvt_pk_bf16_f32 v142, v196, v197
  v_cvt_pk_bf16_f32 v143, v198, v199
  s_add_u32 s44, s60, 1638400
  buffer_store_dwordx2 v[142:143], v17, s[36:39], s44 offen offset:1024 sc1
  s_branch proj_kernel_end
proj_kernel_c_qk7_e1:
  s_barrier
  ds_read_b128 v[24:27], v4
  ds_read_b128 v[28:31], v5
  ds_read_b128 v[32:35], v6
  ds_read_b128 v[36:39], v7
  v_mfma_f32_32x32x16_bf16 v[120:135], v[68:71], v[56:59], v[120:135]
  ds_read_b64_tr_b16 v[40:41], v8 offset:0
  ds_read_b64_tr_b16 v[42:43], v8 offset:1792
  ds_read_b64_tr_b16 v[44:45], v8 offset:7168
  ds_read_b64_tr_b16 v[46:47], v8 offset:8960
  v_mfma_f32_32x32x16_bf16 v[136:151], v[72:75], v[56:59], v[136:151]
  ds_read_b64_tr_b16 v[48:49], v8 offset:14336
  ds_read_b64_tr_b16 v[50:51], v8 offset:16128
  ds_read_b64_tr_b16 v[52:53], v8 offset:21504
  ds_read_b64_tr_b16 v[54:55], v8 offset:23296
  v_mfma_f32_32x32x16_bf16 v[152:167], v[76:79], v[56:59], v[152:167]
  ds_read_b64_tr_b16 v[204:205], v8 offset:64
  ds_read_b64_tr_b16 v[206:207], v8 offset:1856
  ds_read_b64_tr_b16 v[208:209], v8 offset:7232
  ds_read_b64_tr_b16 v[210:211], v8 offset:9024
  v_mfma_f32_32x32x16_bf16 v[168:183], v[80:83], v[56:59], v[168:183]
  ds_read_b64_tr_b16 v[212:213], v8 offset:14400
  ds_read_b64_tr_b16 v[214:215], v8 offset:16192
  ds_read_b64_tr_b16 v[216:217], v8 offset:21568
  ds_read_b64_tr_b16 v[218:219], v8 offset:23360
  v_mfma_f32_32x32x16_bf16 v[184:199], v[84:87], v[56:59], v[184:199]
  s_waitcnt lgkmcnt(8)
  v_mfma_f32_32x32x16_bf16 v[88:103], v[40:43], v[24:27], v[88:103]
  v_mfma_f32_32x32x16_bf16 v[88:103], v[44:47], v[28:31], v[88:103]
  ds_read_b64_tr_b16 v[220:221], v8 offset:128
  ds_read_b64_tr_b16 v[222:223], v8 offset:1920
  ds_read_b64_tr_b16 v[224:225], v8 offset:7296
  v_mfma_f32_32x32x16_bf16 v[88:103], v[48:51], v[32:35], v[88:103]
  ds_read_b64_tr_b16 v[226:227], v8 offset:9088
  ds_read_b64_tr_b16 v[228:229], v8 offset:14464
  ds_read_b64_tr_b16 v[230:231], v8 offset:16256
  v_mfma_f32_32x32x16_bf16 v[88:103], v[52:55], v[36:39], v[88:103]
  ds_read_b64_tr_b16 v[232:233], v8 offset:21632
  ds_read_b64_tr_b16 v[234:235], v8 offset:23424
  s_waitcnt lgkmcnt(8)
  v_mfma_f32_32x32x16_bf16 v[104:119], v[204:207], v[24:27], v[104:119]
  v_mfma_f32_32x32x16_bf16 v[104:119], v[208:211], v[28:31], v[104:119]
  ds_read_b64_tr_b16 v[40:41], v8 offset:192
  ds_read_b64_tr_b16 v[42:43], v8 offset:1984
  ds_read_b64_tr_b16 v[44:45], v8 offset:7360
  v_mfma_f32_32x32x16_bf16 v[104:119], v[212:215], v[32:35], v[104:119]
  ds_read_b64_tr_b16 v[46:47], v8 offset:9152
  ds_read_b64_tr_b16 v[48:49], v8 offset:14528
  ds_read_b64_tr_b16 v[50:51], v8 offset:16320
  v_mfma_f32_32x32x16_bf16 v[104:119], v[216:219], v[36:39], v[104:119]
  ds_read_b64_tr_b16 v[52:53], v8 offset:21696
  ds_read_b64_tr_b16 v[54:55], v8 offset:23488
  v_pk_mul_f32 v[88:89], v[88:89], s[56:57]
  v_pk_mul_f32 v[90:91], v[90:91], s[56:57]
  v_cvt_pk_bf16_f32 v88, v88, v89
  v_cvt_pk_bf16_f32 v89, v90, v91
  v_pk_mul_f32 v[92:93], v[92:93], s[56:57]
  v_pk_mul_f32 v[94:95], v[94:95], s[56:57]
  v_cvt_pk_bf16_f32 v90, v92, v93
  v_cvt_pk_bf16_f32 v91, v94, v95
  s_add_u32 s44, s60, 1802240
  buffer_store_dwordx4 v[88:91], v16, s[36:39], s44 offen sc1
  v_pk_mul_f32 v[96:97], v[96:97], s[56:57]
  v_pk_mul_f32 v[98:99], v[98:99], s[56:57]
  v_cvt_pk_bf16_f32 v92, v96, v97
  v_cvt_pk_bf16_f32 v93, v98, v99
  v_pk_mul_f32 v[100:101], v[100:101], s[56:57]
  v_pk_mul_f32 v[102:103], v[102:103], s[56:57]
  v_cvt_pk_bf16_f32 v94, v100, v101
  v_cvt_pk_bf16_f32 v95, v102, v103
  s_add_u32 s44, s60, 1966080
  buffer_store_dwordx4 v[92:95], v16, s[36:39], s44 offen sc1
  s_waitcnt lgkmcnt(8)
  v_mfma_f32_32x32x16_bf16 v[120:135], v[220:223], v[24:27], v[120:135]
  v_mfma_f32_32x32x16_bf16 v[120:135], v[224:227], v[28:31], v[120:135]
  ds_read_b64_tr_b16 v[204:205], v8 offset:256
  ds_read_b64_tr_b16 v[206:207], v8 offset:2048
  ds_read_b64_tr_b16 v[208:209], v8 offset:7424
  v_mfma_f32_32x32x16_bf16 v[120:135], v[228:231], v[32:35], v[120:135]
  ds_read_b64_tr_b16 v[210:211], v8 offset:9216
  ds_read_b64_tr_b16 v[212:213], v8 offset:14592
  ds_read_b64_tr_b16 v[214:215], v8 offset:16384
  v_mfma_f32_32x32x16_bf16 v[120:135], v[232:235], v[36:39], v[120:135]
  ds_read_b64_tr_b16 v[216:217], v8 offset:21760
  ds_read_b64_tr_b16 v[218:219], v8 offset:23552
  v_pk_mul_f32 v[104:105], v[104:105], s[56:57]
  v_pk_mul_f32 v[106:107], v[106:107], s[56:57]
  v_cvt_pk_bf16_f32 v96, v104, v105
  v_cvt_pk_bf16_f32 v97, v106, v107
  s_add_u32 s44, s60, 1966080
  buffer_store_dwordx2 v[96:97], v17, s[36:39], s44 offen offset:1024 sc1
  v_pk_mul_f32 v[108:109], v[108:109], s[56:57]
  v_pk_mul_f32 v[110:111], v[110:111], s[56:57]
  v_cvt_pk_bf16_f32 v98, v108, v109
  v_cvt_pk_bf16_f32 v99, v110, v111
  v_pk_mul_f32 v[112:113], v[112:113], s[56:57]
  v_pk_mul_f32 v[114:115], v[114:115], s[56:57]
  v_cvt_pk_bf16_f32 v100, v112, v113
  v_cvt_pk_bf16_f32 v101, v114, v115
  s_add_u32 s44, s60, 2129920
  buffer_store_dwordx4 v[98:101], v16, s[36:39], s44 offen sc1
  v_pk_mul_f32 v[116:117], v[116:117], s[56:57]
  v_pk_mul_f32 v[118:119], v[118:119], s[56:57]
  v_cvt_pk_bf16_f32 v102, v116, v117
  v_cvt_pk_bf16_f32 v103, v118, v119
  s_waitcnt lgkmcnt(8)
  v_mfma_f32_32x32x16_bf16 v[136:151], v[40:43], v[24:27], v[136:151]
  v_mfma_f32_32x32x16_bf16 v[136:151], v[44:47], v[28:31], v[136:151]
  ds_read_b64_tr_b16 v[220:221], v8 offset:320
  ds_read_b64_tr_b16 v[222:223], v8 offset:2112
  ds_read_b64_tr_b16 v[224:225], v8 offset:7488
  v_mfma_f32_32x32x16_bf16 v[136:151], v[48:51], v[32:35], v[136:151]
  ds_read_b64_tr_b16 v[226:227], v8 offset:9280
  ds_read_b64_tr_b16 v[228:229], v8 offset:14656
  ds_read_b64_tr_b16 v[230:231], v8 offset:16448
  v_mfma_f32_32x32x16_bf16 v[136:151], v[52:55], v[36:39], v[136:151]
  ds_read_b64_tr_b16 v[232:233], v8 offset:21824
  ds_read_b64_tr_b16 v[234:235], v8 offset:23616
  v_pk_mul_f32 v[120:121], v[120:121], s[56:57]
  v_pk_mul_f32 v[122:123], v[122:123], s[56:57]
  v_cvt_pk_bf16_f32 v104, v120, v121
  v_cvt_pk_bf16_f32 v105, v122, v123
  s_add_u32 s44, s60, 2293760
  buffer_store_dwordx4 v[102:105], v16, s[36:39], s44 offen sc1
  v_pk_mul_f32 v[124:125], v[124:125], s[56:57]
  v_pk_mul_f32 v[126:127], v[126:127], s[56:57]
  v_cvt_pk_bf16_f32 v106, v124, v125
  v_cvt_pk_bf16_f32 v107, v126, v127
  s_add_u32 s44, s60, 2293760
  buffer_store_dwordx2 v[106:107], v17, s[36:39], s44 offen offset:1024 sc1
  v_pk_mul_f32 v[128:129], v[128:129], s[56:57]
  v_pk_mul_f32 v[130:131], v[130:131], s[56:57]
  v_cvt_pk_bf16_f32 v108, v128, v129
  v_cvt_pk_bf16_f32 v109, v130, v131
  v_pk_mul_f32 v[132:133], v[132:133], s[56:57]
  v_pk_mul_f32 v[134:135], v[134:135], s[56:57]
  v_cvt_pk_bf16_f32 v110, v132, v133
  v_cvt_pk_bf16_f32 v111, v134, v135
  s_add_u32 s44, s60, 2457600
  buffer_store_dwordx4 v[108:111], v16, s[36:39], s44 offen sc1
  s_waitcnt lgkmcnt(8)
  v_mfma_f32_32x32x16_bf16 v[152:167], v[204:207], v[24:27], v[152:167]
  v_mfma_f32_32x32x16_bf16 v[152:167], v[208:211], v[28:31], v[152:167]
  ds_read_b64_tr_b16 v[40:41], v8 offset:384
  ds_read_b64_tr_b16 v[42:43], v8 offset:2176
  ds_read_b64_tr_b16 v[44:45], v8 offset:7552
  v_mfma_f32_32x32x16_bf16 v[152:167], v[212:215], v[32:35], v[152:167]
  ds_read_b64_tr_b16 v[46:47], v8 offset:9344
  ds_read_b64_tr_b16 v[48:49], v8 offset:14720
  ds_read_b64_tr_b16 v[50:51], v8 offset:16512
  v_mfma_f32_32x32x16_bf16 v[152:167], v[216:219], v[36:39], v[152:167]
  ds_read_b64_tr_b16 v[52:53], v8 offset:21888
  ds_read_b64_tr_b16 v[54:55], v8 offset:23680
  v_pk_mul_f32 v[136:137], v[136:137], s[56:57]
  v_pk_mul_f32 v[138:139], v[138:139], s[56:57]
  v_cvt_pk_bf16_f32 v112, v136, v137
  v_cvt_pk_bf16_f32 v113, v138, v139
  v_pk_mul_f32 v[140:141], v[140:141], s[56:57]
  v_pk_mul_f32 v[142:143], v[142:143], s[56:57]
  v_cvt_pk_bf16_f32 v114, v140, v141
  v_cvt_pk_bf16_f32 v115, v142, v143
  s_add_u32 s44, s60, 2621440
  buffer_store_dwordx4 v[112:115], v16, s[36:39], s44 offen sc1
  v_pk_mul_f32 v[144:145], v[144:145], s[56:57]
  v_pk_mul_f32 v[146:147], v[146:147], s[56:57]
  v_cvt_pk_bf16_f32 v116, v144, v145
  v_cvt_pk_bf16_f32 v117, v146, v147
  s_add_u32 s44, s60, 2621440
  buffer_store_dwordx2 v[116:117], v17, s[36:39], s44 offen offset:1024 sc1
  v_pk_mul_f32 v[148:149], v[148:149], s[56:57]
  v_pk_mul_f32 v[150:151], v[150:151], s[56:57]
  v_cvt_pk_bf16_f32 v118, v148, v149
  v_cvt_pk_bf16_f32 v119, v150, v151
  s_waitcnt lgkmcnt(8)
  v_mfma_f32_32x32x16_bf16 v[168:183], v[220:223], v[24:27], v[168:183]
  v_mfma_f32_32x32x16_bf16 v[168:183], v[224:227], v[28:31], v[168:183]
  v_mfma_f32_32x32x16_bf16 v[168:183], v[228:231], v[32:35], v[168:183]
  v_mfma_f32_32x32x16_bf16 v[168:183], v[232:235], v[36:39], v[168:183]
  s_nop 7
  v_pk_mul_f32 v[152:153], v[152:153], s[56:57]
  v_pk_mul_f32 v[154:155], v[154:155], s[56:57]
  v_cvt_pk_bf16_f32 v120, v152, v153
  v_cvt_pk_bf16_f32 v121, v154, v155
  s_add_u32 s44, s60, 2785280
  buffer_store_dwordx4 v[118:121], v16, s[36:39], s44 offen sc1
  v_pk_mul_f32 v[156:157], v[156:157], s[56:57]
  v_pk_mul_f32 v[158:159], v[158:159], s[56:57]
  v_cvt_pk_bf16_f32 v122, v156, v157
  v_cvt_pk_bf16_f32 v123, v158, v159
  v_pk_mul_f32 v[160:161], v[160:161], s[56:57]
  v_pk_mul_f32 v[162:163], v[162:163], s[56:57]
  v_cvt_pk_bf16_f32 v124, v160, v161
  v_cvt_pk_bf16_f32 v125, v162, v163
  s_add_u32 s44, s60, 2949120
  buffer_store_dwordx4 v[122:125], v16, s[36:39], s44 offen sc1
  v_pk_mul_f32 v[164:165], v[164:165], s[56:57]
  v_pk_mul_f32 v[166:167], v[166:167], s[56:57]
  v_cvt_pk_bf16_f32 v126, v164, v165
  v_cvt_pk_bf16_f32 v127, v166, v167
  s_add_u32 s44, s60, 2949120
  buffer_store_dwordx2 v[126:127], v17, s[36:39], s44 offen offset:1024 sc1
  s_waitcnt lgkmcnt(0)
  v_mfma_f32_32x32x16_bf16 v[184:199], v[40:43], v[24:27], v[184:199]
  v_mfma_f32_32x32x16_bf16 v[184:199], v[44:47], v[28:31], v[184:199]
  v_mfma_f32_32x32x16_bf16 v[184:199], v[48:51], v[32:35], v[184:199]
  v_mfma_f32_32x32x16_bf16 v[184:199], v[52:55], v[36:39], v[184:199]
  s_nop 7
  v_pk_mul_f32 v[168:169], v[168:169], s[56:57]
  v_pk_mul_f32 v[170:171], v[170:171], s[56:57]
  v_cvt_pk_bf16_f32 v128, v168, v169
  v_cvt_pk_bf16_f32 v129, v170, v171
  v_pk_mul_f32 v[172:173], v[172:173], s[56:57]
  v_pk_mul_f32 v[174:175], v[174:175], s[56:57]
  v_cvt_pk_bf16_f32 v130, v172, v173
  v_cvt_pk_bf16_f32 v131, v174, v175
  s_add_u32 s44, s60, 3112960
  buffer_store_dwordx4 v[128:131], v16, s[36:39], s44 offen sc1
  v_pk_mul_f32 v[176:177], v[176:177], s[56:57]
  v_pk_mul_f32 v[178:179], v[178:179], s[56:57]
  v_cvt_pk_bf16_f32 v132, v176, v177
  v_cvt_pk_bf16_f32 v133, v178, v179
  v_pk_mul_f32 v[180:181], v[180:181], s[56:57]
  v_pk_mul_f32 v[182:183], v[182:183], s[56:57]
  v_cvt_pk_bf16_f32 v134, v180, v181
  v_cvt_pk_bf16_f32 v135, v182, v183
  s_add_u32 s44, s60, 3276800
  buffer_store_dwordx4 v[132:135], v16, s[36:39], s44 offen sc1
  s_nop 3
  v_pk_mul_f32 v[184:185], v[184:185], s[56:57]
  v_pk_mul_f32 v[186:187], v[186:187], s[56:57]
  v_cvt_pk_bf16_f32 v136, v184, v185
  v_cvt_pk_bf16_f32 v137, v186, v187
  s_add_u32 s44, s60, 3276800
  buffer_store_dwordx2 v[136:137], v17, s[36:39], s44 offen offset:1024 sc1
  v_pk_mul_f32 v[188:189], v[188:189], s[56:57]
  v_pk_mul_f32 v[190:191], v[190:191], s[56:57]
  v_cvt_pk_bf16_f32 v138, v188, v189
  v_cvt_pk_bf16_f32 v139, v190, v191
  v_pk_mul_f32 v[192:193], v[192:193], s[56:57]
  v_pk_mul_f32 v[194:195], v[194:195], s[56:57]
  v_cvt_pk_bf16_f32 v140, v192, v193
  v_cvt_pk_bf16_f32 v141, v194, v195
  s_add_u32 s44, s60, 3440640
  buffer_store_dwordx4 v[138:141], v16, s[36:39], s44 offen sc1
  v_pk_mul_f32 v[196:197], v[196:197], s[56:57]
  v_pk_mul_f32 v[198:199], v[198:199], s[56:57]
  v_cvt_pk_bf16_f32 v142, v196, v197
  v_cvt_pk_bf16_f32 v143, v198, v199
  s_add_u32 s44, s60, 3604480
  buffer_store_dwordx2 v[142:143], v16, s[36:39], s44 offen offset:0 sc1
  s_branch proj_kernel_end
proj_kernel_c_qk7_e2:
  s_barrier
  ds_read_b128 v[24:27], v4
  ds_read_b128 v[28:31], v5
  ds_read_b128 v[32:35], v6
  ds_read_b128 v[36:39], v7
  v_mfma_f32_32x32x16_bf16 v[120:135], v[68:71], v[56:59], v[120:135]
  ds_read_b64_tr_b16 v[40:41], v8 offset:0
  ds_read_b64_tr_b16 v[42:43], v8 offset:1792
  ds_read_b64_tr_b16 v[44:45], v8 offset:7168
  ds_read_b64_tr_b16 v[46:47], v8 offset:8960
  v_mfma_f32_32x32x16_bf16 v[136:151], v[72:75], v[56:59], v[136:151]
  ds_read_b64_tr_b16 v[48:49], v8 offset:14336
  ds_read_b64_tr_b16 v[50:51], v8 offset:16128
  ds_read_b64_tr_b16 v[52:53], v8 offset:21504
  ds_read_b64_tr_b16 v[54:55], v8 offset:23296
  v_mfma_f32_32x32x16_bf16 v[152:167], v[76:79], v[56:59], v[152:167]
  ds_read_b64_tr_b16 v[204:205], v8 offset:64
  ds_read_b64_tr_b16 v[206:207], v8 offset:1856
  ds_read_b64_tr_b16 v[208:209], v8 offset:7232
  ds_read_b64_tr_b16 v[210:211], v8 offset:9024
  v_mfma_f32_32x32x16_bf16 v[168:183], v[80:83], v[56:59], v[168:183]
  ds_read_b64_tr_b16 v[212:213], v8 offset:14400
  ds_read_b64_tr_b16 v[214:215], v8 offset:16192
  ds_read_b64_tr_b16 v[216:217], v8 offset:21568
  ds_read_b64_tr_b16 v[218:219], v8 offset:23360
  v_mfma_f32_32x32x16_bf16 v[184:199], v[84:87], v[56:59], v[184:199]
  s_waitcnt lgkmcnt(8)
  v_mfma_f32_32x32x16_bf16 v[88:103], v[40:43], v[24:27], v[88:103]
  v_mfma_f32_32x32x16_bf16 v[88:103], v[44:47], v[28:31], v[88:103]
  ds_read_b64_tr_b16 v[220:221], v8 offset:128
  ds_read_b64_tr_b16 v[222:223], v8 offset:1920
  ds_read_b64_tr_b16 v[224:225], v8 offset:7296
  v_mfma_f32_32x32x16_bf16 v[88:103], v[48:51], v[32:35], v[88:103]
  ds_read_b64_tr_b16 v[226:227], v8 offset:9088
  ds_read_b64_tr_b16 v[228:229], v8 offset:14464
  ds_read_b64_tr_b16 v[230:231], v8 offset:16256
  v_mfma_f32_32x32x16_bf16 v[88:103], v[52:55], v[36:39], v[88:103]
  ds_read_b64_tr_b16 v[232:233], v8 offset:21632
  ds_read_b64_tr_b16 v[234:235], v8 offset:23424
  s_waitcnt lgkmcnt(8)
  v_mfma_f32_32x32x16_bf16 v[104:119], v[204:207], v[24:27], v[104:119]
  v_mfma_f32_32x32x16_bf16 v[104:119], v[208:211], v[28:31], v[104:119]
  ds_read_b64_tr_b16 v[40:41], v8 offset:192
  ds_read_b64_tr_b16 v[42:43], v8 offset:1984
  ds_read_b64_tr_b16 v[44:45], v8 offset:7360
  v_mfma_f32_32x32x16_bf16 v[104:119], v[212:215], v[32:35], v[104:119]
  ds_read_b64_tr_b16 v[46:47], v8 offset:9152
  ds_read_b64_tr_b16 v[48:49], v8 offset:14528
  ds_read_b64_tr_b16 v[50:51], v8 offset:16320
  v_mfma_f32_32x32x16_bf16 v[104:119], v[216:219], v[36:39], v[104:119]
  ds_read_b64_tr_b16 v[52:53], v8 offset:21696
  ds_read_b64_tr_b16 v[54:55], v8 offset:23488
  v_pk_mul_f32 v[88:89], v[88:89], s[56:57]
  v_pk_mul_f32 v[90:91], v[90:91], s[56:57]
  v_cvt_pk_bf16_f32 v88, v88, v89
  v_cvt_pk_bf16_f32 v89, v90, v91
  s_add_u32 s44, s60, 3604480
  buffer_store_dwordx2 v[88:89], v16, s[36:39], s44 offen offset:8 sc1
  v_pk_mul_f32 v[92:93], v[92:93], s[56:57]
  v_pk_mul_f32 v[94:95], v[94:95], s[56:57]
  v_cvt_pk_bf16_f32 v90, v92, v93
  v_cvt_pk_bf16_f32 v91, v94, v95
  s_add_u32 s44, s60, 3604480
  buffer_store_dwordx2 v[90:91], v17, s[36:39], s44 offen offset:1024 sc1
  v_pk_mul_f32 v[96:97], v[96:97], s[56:57]
  v_pk_mul_f32 v[98:99], v[98:99], s[56:57]
  v_cvt_pk_bf16_f32 v92, v96, v97
  v_cvt_pk_bf16_f32 v93, v98, v99
  v_pk_mul_f32 v[100:101], v[100:101], s[56:57]
  v_pk_mul_f32 v[102:103], v[102:103], s[56:57]
  v_cvt_pk_bf16_f32 v94, v100, v101
  v_cvt_pk_bf16_f32 v95, v102, v103
  s_add_u32 s44, s60, 3768320
  buffer_store_dwordx4 v[92:95], v16, s[36:39], s44 offen sc1
  s_waitcnt lgkmcnt(8)
  v_mfma_f32_32x32x16_bf16 v[120:135], v[220:223], v[24:27], v[120:135]
  v_mfma_f32_32x32x16_bf16 v[120:135], v[224:227], v[28:31], v[120:135]
  ds_read_b64_tr_b16 v[204:205], v8 offset:256
  ds_read_b64_tr_b16 v[206:207], v8 offset:2048
  ds_read_b64_tr_b16 v[208:209], v8 offset:7424
  v_mfma_f32_32x32x16_bf16 v[120:135], v[228:231], v[32:35], v[120:135]
  ds_read_b64_tr_b16 v[210:211], v8 offset:9216
  ds_read_b64_tr_b16 v[212:213], v8 offset:14592
  ds_read_b64_tr_b16 v[214:215], v8 offset:16384
  v_mfma_f32_32x32x16_bf16 v[120:135], v[232:235], v[36:39], v[120:135]
  ds_read_b64_tr_b16 v[216:217], v8 offset:21760
  ds_read_b64_tr_b16 v[218:219], v8 offset:23552
  v_pk_mul_f32 v[104:105], v[104:105], s[56:57]
  v_pk_mul_f32 v[106:107], v[106:107], s[56:57]
  v_cvt_pk_bf16_f32 v96, v104, v105
  v_cvt_pk_bf16_f32 v97, v106, v107
  v_pk_mul_f32 v[108:109], v[108:109], s[56:57]
  v_pk_mul_f32 v[110:111], v[110:111], s[56:57]
  v_cvt_pk_bf16_f32 v98, v108, v109
  v_cvt_pk_bf16_f32 v99, v110, v111
  s_add_u32 s44, s60, 3932160
  buffer_store_dwordx4 v[96:99], v16, s[36:39], s44 offen sc1
  v_pk_mul_f32 v[112:113], v[112:113], s[56:57]
  v_pk_mul_f32 v[114:115], v[114:115], s[56:57]
  v_cvt_pk_bf16_f32 v100, v112, v113
  v_cvt_pk_bf16_f32 v101, v114, v115
  s_add_u32 s44, s60, 3932160
  buffer_store_dwordx2 v[100:101], v17, s[36:39], s44 offen offset:1024 sc1
  v_pk_mul_f32 v[116:117], v[116:117], s[56:57]
  v_pk_mul_f32 v[118:119], v[118:119], s[56:57]
  v_cvt_pk_bf16_f32 v102, v116, v117
  v_cvt_pk_bf16_f32 v103, v118, v119
  s_waitcnt lgkmcnt(8)
  v_mfma_f32_32x32x16_bf16 v[136:151], v[40:43], v[24:27], v[136:151]
  v_mfma_f32_32x32x16_bf16 v[136:151], v[44:47], v[28:31], v[136:151]
  ds_read_b64_tr_b16 v[220:221], v8 offset:320
  ds_read_b64_tr_b16 v[222:223], v8 offset:2112
  ds_read_b64_tr_b16 v[224:225], v8 offset:7488
  v_mfma_f32_32x32x16_bf16 v[136:151], v[48:51], v[32:35], v[136:151]
  ds_read_b64_tr_b16 v[226:227], v8 offset:9280
  ds_read_b64_tr_b16 v[228:229], v8 offset:14656
  ds_read_b64_tr_b16 v[230:231], v8 offset:16448
  v_mfma_f32_32x32x16_bf16 v[136:151], v[52:55], v[36:39], v[136:151]
  ds_read_b64_tr_b16 v[232:233], v8 offset:21824
  ds_read_b64_tr_b16 v[234:235], v8 offset:23616
  v_pk_mul_f32 v[120:121], v[120:121], s[56:57]
  v_pk_mul_f32 v[122:123], v[122:123], s[56:57]
  v_cvt_pk_bf16_f32 v104, v120, v121
  v_cvt_pk_bf16_f32 v105, v122, v123
  s_add_u32 s44, s60, 4096000
  buffer_store_dwordx4 v[102:105], v16, s[36:39], s44 offen sc1
  v_pk_mul_f32 v[124:125], v[124:125], s[56:57]
  v_pk_mul_f32 v[126:127], v[126:127], s[56:57]
  v_cvt_pk_bf16_f32 v106, v124, v125
  v_cvt_pk_bf16_f32 v107, v126, v127
  v_pk_mul_f32 v[128:129], v[128:129], s[56:57]
  v_pk_mul_f32 v[130:131], v[130:131], s[56:57]
  v_cvt_pk_bf16_f32 v108, v128, v129
  v_cvt_pk_bf16_f32 v109, v130, v131
  s_add_u32 s44, s60, 4259840
  buffer_store_dwordx4 v[106:109], v16, s[36:39], s44 offen sc1
  v_pk_mul_f32 v[132:133], v[132:133], s[56:57]
  v_pk_mul_f32 v[134:135], v[134:135], s[56:57]
  v_cvt_pk_bf16_f32 v110, v132, v133
  v_cvt_pk_bf16_f32 v111, v134, v135
  s_add_u32 s44, s60, 4259840
  buffer_store_dwordx2 v[110:111], v17, s[36:39], s44 offen offset:1024 sc1
  s_waitcnt lgkmcnt(8)
  v_mfma_f32_32x32x16_bf16 v[152:167], v[204:207], v[24:27], v[152:167]
  v_mfma_f32_32x32x16_bf16 v[152:167], v[208:211], v[28:31], v[152:167]
  ds_read_b64_tr_b16 v[40:41], v8 offset:384
  ds_read_b64_tr_b16 v[42:43], v8 offset:2176
  ds_read_b64_tr_b16 v[44:45], v8 offset:7552
  v_mfma_f32_32x32x16_bf16 v[152:167], v[212:215], v[32:35], v[152:167]
  ds_read_b64_tr_b16 v[46:47], v8 offset:9344
  ds_read_b64_tr_b16 v[48:49], v8 offset:14720
  ds_read_b64_tr_b16 v[50:51], v8 offset:16512
  v_mfma_f32_32x32x16_bf16 v[152:167], v[216:219], v[36:39], v[152:167]
  ds_read_b64_tr_b16 v[52:53], v8 offset:21888
  ds_read_b64_tr_b16 v[54:55], v8 offset:23680
  v_pk_mul_f32 v[136:137], v[136:137], s[56:57]
  v_pk_mul_f32 v[138:139], v[138:139], s[56:57]
  v_cvt_pk_bf16_f32 v112, v136, v137
  v_cvt_pk_bf16_f32 v113, v138, v139
  v_pk_mul_f32 v[140:141], v[140:141], s[56:57]
  v_pk_mul_f32 v[142:143], v[142:143], s[56:57]
  v_cvt_pk_bf16_f32 v114, v140, v141
  v_cvt_pk_bf16_f32 v115, v142, v143
  s_add_u32 s44, s60, 4423680
  buffer_store_dwordx4 v[112:115], v16, s[36:39], s44 offen sc1
  v_pk_mul_f32 v[144:145], v[144:145], s[56:57]
  v_pk_mul_f32 v[146:147], v[146:147], s[56:57]
  v_cvt_pk_bf16_f32 v116, v144, v145
  v_cvt_pk_bf16_f32 v117, v146, v147
  v_pk_mul_f32 v[148:149], v[148:149], s[56:57]
  v_pk_mul_f32 v[150:151], v[150:151], s[56:57]
  v_cvt_pk_bf16_f32 v118, v148, v149
  v_cvt_pk_bf16_f32 v119, v150, v151
  s_add_u32 s44, s60, 4587520
  buffer_store_dwordx4 v[116:119], v16, s[36:39], s44 offen sc1
  s_waitcnt lgkmcnt(8)
  v_mfma_f32_32x32x16_bf16 v[168:183], v[220:223], v[24:27], v[168:183]
  v_mfma_f32_32x32x16_bf16 v[168:183], v[224:227], v[28:31], v[168:183]
  v_mfma_f32_32x32x16_bf16 v[168:183], v[228:231], v[32:35], v[168:183]
  v_mfma_f32_32x32x16_bf16 v[168:183], v[232:235], v[36:39], v[168:183]
  s_nop 7
  v_pk_mul_f32 v[152:153], v[152:153], s[56:57]
  v_pk_mul_f32 v[154:155], v[154:155], s[56:57]
  v_cvt_pk_bf16_f32 v120, v152, v153
  v_cvt_pk_bf16_f32 v121, v154, v155
  s_add_u32 s44, s60, 4587520
  buffer_store_dwordx2 v[120:121], v17, s[36:39], s44 offen offset:1024 sc1
  v_pk_mul_f32 v[156:157], v[156:157], s[56:57]
  v_pk_mul_f32 v[158:159], v[158:159], s[56:57]
  v_cvt_pk_bf16_f32 v122, v156, v157
  v_cvt_pk_bf16_f32 v123, v158, v159
  v_pk_mul_f32 v[160:161], v[160:161], s[56:57]
  v_pk_mul_f32 v[162:163], v[162:163], s[56:57]
  v_cvt_pk_bf16_f32 v124, v160, v161
  v_cvt_pk_bf16_f32 v125, v162, v163
  s_add_u32 s44, s60, 4751360
  buffer_store_dwordx4 v[122:125], v16, s[36:39], s44 offen sc1
  v_pk_mul_f32 v[164:165], v[164:165], s[56:57]
  v_pk_mul_f32 v[166:167], v[166:167], s[56:57]
  v_cvt_pk_bf16_f32 v126, v164, v165
  v_cvt_pk_bf16_f32 v127, v166, v167
  s_waitcnt lgkmcnt(0)
  v_mfma_f32_32x32x16_bf16 v[184:199], v[40:43], v[24:27], v[184:199]
  v_mfma_f32_32x32x16_bf16 v[184:199], v[44:47], v[28:31], v[184:199]
  v_mfma_f32_32x32x16_bf16 v[184:199], v[48:51], v[32:35], v[184:199]
  v_mfma_f32_32x32x16_bf16 v[184:199], v[52:55], v[36:39], v[184:199]
  s_nop 7
  v_pk_mul_f32 v[168:169], v[168:169], s[56:57]
  v_pk_mul_f32 v[170:171], v[170:171], s[56:57]
  v_cvt_pk_bf16_f32 v128, v168, v169
  v_cvt_pk_bf16_f32 v129, v170, v171
  s_add_u32 s44, s60, 4915200
  buffer_store_dwordx4 v[126:129], v16, s[36:39], s44 offen sc1
  v_pk_mul_f32 v[172:173], v[172:173], s[56:57]
  v_pk_mul_f32 v[174:175], v[174:175], s[56:57]
  v_cvt_pk_bf16_f32 v130, v172, v173
  v_cvt_pk_bf16_f32 v131, v174, v175
  s_add_u32 s44, s60, 4915200
  buffer_store_dwordx2 v[130:131], v17, s[36:39], s44 offen offset:1024 sc1
  v_pk_mul_f32 v[176:177], v[176:177], s[56:57]
  v_pk_mul_f32 v[178:179], v[178:179], s[56:57]
  v_cvt_pk_bf16_f32 v132, v176, v177
  v_cvt_pk_bf16_f32 v133, v178, v179
  v_pk_mul_f32 v[180:181], v[180:181], s[56:57]
  v_pk_mul_f32 v[182:183], v[182:183], s[56:57]
  v_cvt_pk_bf16_f32 v134, v180, v181
  v_cvt_pk_bf16_f32 v135, v182, v183
  s_add_u32 s44, s60, 5079040
  buffer_store_dwordx4 v[132:135], v16, s[36:39], s44 offen sc1
  s_nop 3
  v_cvt_pk_bf16_f32 v136, v184, v185
  v_cvt_pk_bf16_f32 v137, v186, v187
  v_cvt_pk_bf16_f32 v138, v188, v189
  v_cvt_pk_bf16_f32 v139, v190, v191
  s_add_u32 s44, s60, 5242880
  buffer_store_dwordx4 v[136:139], v16, s[36:39], s44 offen sc1
  v_cvt_pk_bf16_f32 v140, v192, v193
  v_cvt_pk_bf16_f32 v141, v194, v195
  s_add_u32 s44, s60, 5242880
  buffer_store_dwordx2 v[140:141], v17, s[36:39], s44 offen offset:1024 sc1
  v_cvt_pk_bf16_f32 v142, v196, v197
  v_cvt_pk_bf16_f32 v143, v198, v199
  s_add_u32 s44, s60, 5406720
  buffer_store_dwordx2 v[142:143], v16, s[36:39], s44 offen offset:0 sc1
  s_branch proj_kernel_end
proj_kernel_c_qk7_e3:
  s_barrier
  ds_read_b128 v[24:27], v4
  ds_read_b128 v[28:31], v5
  ds_read_b128 v[32:35], v6
  ds_read_b128 v[36:39], v7
  v_mfma_f32_32x32x16_bf16 v[120:135], v[68:71], v[56:59], v[120:135]
  ds_read_b64_tr_b16 v[40:41], v8 offset:0
  ds_read_b64_tr_b16 v[42:43], v8 offset:1792
  ds_read_b64_tr_b16 v[44:45], v8 offset:7168
  ds_read_b64_tr_b16 v[46:47], v8 offset:8960
  v_mfma_f32_32x32x16_bf16 v[136:151], v[72:75], v[56:59], v[136:151]
  ds_read_b64_tr_b16 v[48:49], v8 offset:14336
  ds_read_b64_tr_b16 v[50:51], v8 offset:16128
  ds_read_b64_tr_b16 v[52:53], v8 offset:21504
  ds_read_b64_tr_b16 v[54:55], v8 offset:23296
  v_mfma_f32_32x32x16_bf16 v[152:167], v[76:79], v[56:59], v[152:167]
  ds_read_b64_tr_b16 v[204:205], v8 offset:64
  ds_read_b64_tr_b16 v[206:207], v8 offset:1856
  ds_read_b64_tr_b16 v[208:209], v8 offset:7232
  ds_read_b64_tr_b16 v[210:211], v8 offset:9024
  v_mfma_f32_32x32x16_bf16 v[168:183], v[80:83], v[56:59], v[168:183]
  ds_read_b64_tr_b16 v[212:213], v8 offset:14400
  ds_read_b64_tr_b16 v[214:215], v8 offset:16192
  ds_read_b64_tr_b16 v[216:217], v8 offset:21568
  ds_read_b64_tr_b16 v[218:219], v8 offset:23360
  v_mfma_f32_32x32x16_bf16 v[184:199], v[84:87], v[56:59], v[184:199]
  s_waitcnt lgkmcnt(8)
  v_mfma_f32_32x32x16_bf16 v[88:103], v[40:43], v[24:27], v[88:103]
  v_mfma_f32_32x32x16_bf16 v[88:103], v[44:47], v[28:31], v[88:103]
  ds_read_b64_tr_b16 v[220:221], v8 offset:128
  ds_read_b64_tr_b16 v[222:223], v8 offset:1920
  ds_read_b64_tr_b16 v[224:225], v8 offset:7296
  v_mfma_f32_32x32x16_bf16 v[88:103], v[48:51], v[32:35], v[88:103]
  ds_read_b64_tr_b16 v[226:227], v8 offset:9088
  ds_read_b64_tr_b16 v[228:229], v8 offset:14464
  ds_read_b64_tr_b16 v[230:231], v8 offset:16256
  v_mfma_f32_32x32x16_bf16 v[88:103], v[52:55], v[36:39], v[88:103]
  ds_read_b64_tr_b16 v[232:233], v8 offset:21632
  ds_read_b64_tr_b16 v[234:235], v8 offset:23424
  s_waitcnt lgkmcnt(8)
  v_mfma_f32_32x32x16_bf16 v[104:119], v[204:207], v[24:27], v[104:119]
  v_mfma_f32_32x32x16_bf16 v[104:119], v[208:211], v[28:31], v[104:119]
  ds_read_b64_tr_b16 v[40:41], v8 offset:192
  ds_read_b64_tr_b16 v[42:43], v8 offset:1984
  ds_read_b64_tr_b16 v[44:45], v8 offset:7360
  v_mfma_f32_32x32x16_bf16 v[104:119], v[212:215], v[32:35], v[104:119]
  ds_read_b64_tr_b16 v[46:47], v8 offset:9152
  ds_read_b64_tr_b16 v[48:49], v8 offset:14528
  ds_read_b64_tr_b16 v[50:51], v8 offset:16320
  v_mfma_f32_32x32x16_bf16 v[104:119], v[216:219], v[36:39], v[104:119]
  ds_read_b64_tr_b16 v[52:53], v8 offset:21696
  ds_read_b64_tr_b16 v[54:55], v8 offset:23488
  v_cvt_pk_bf16_f32 v88, v88, v89
  v_cvt_pk_bf16_f32 v89, v90, v91
  s_add_u32 s44, s60, 5406720
  buffer_store_dwordx2 v[88:89], v16, s[36:39], s44 offen offset:8 sc1
  v_cvt_pk_bf16_f32 v90, v92, v93
  v_cvt_pk_bf16_f32 v91, v94, v95
  v_cvt_pk_bf16_f32 v92, v96, v97
  v_cvt_pk_bf16_f32 v93, v98, v99
  s_add_u32 s44, s60, 5570560
  buffer_store_dwordx4 v[90:93], v16, s[36:39], s44 offen sc1
  v_cvt_pk_bf16_f32 v94, v100, v101
  v_cvt_pk_bf16_f32 v95, v102, v103
  s_add_u32 s44, s60, 5570560
  buffer_store_dwordx2 v[94:95], v17, s[36:39], s44 offen offset:1024 sc1
  s_waitcnt lgkmcnt(8)
  v_mfma_f32_32x32x16_bf16 v[120:135], v[220:223], v[24:27], v[120:135]
  v_mfma_f32_32x32x16_bf16 v[120:135], v[224:227], v[28:31], v[120:135]
  ds_read_b64_tr_b16 v[204:205], v8 offset:256
  ds_read_b64_tr_b16 v[206:207], v8 offset:2048
  ds_read_b64_tr_b16 v[208:209], v8 offset:7424
  v_mfma_f32_32x32x16_bf16 v[120:135], v[228:231], v[32:35], v[120:135]
  ds_read_b64_tr_b16 v[210:211], v8 offset:9216
  ds_read_b64_tr_b16 v[212:213], v8 offset:14592
  ds_read_b64_tr_b16 v[214:215], v8 offset:16384
  v_mfma_f32_32x32x16_bf16 v[120:135], v[232:235], v[36:39], v[120:135]
  ds_read_b64_tr_b16 v[216:217], v8 offset:21760
  ds_read_b64_tr_b16 v[218:219], v8 offset:23552
  v_cvt_pk_bf16_f32 v96, v104, v105
  v_cvt_pk_bf16_f32 v97, v106, v107
  v_cvt_pk_bf16_f32 v98, v108, v109
  v_cvt_pk_bf16_f32 v99, v110, v111
  s_add_u32 s44, s60, 5734400
  buffer_store_dwordx4 v[96:99], v16, s[36:39], s44 offen sc1
  v_cvt_pk_bf16_f32 v100, v112, v113
  v_cvt_pk_bf16_f32 v101, v114, v115
  v_cvt_pk_bf16_f32 v102, v116, v117
  v_cvt_pk_bf16_f32 v103, v118, v119
  s_add_u32 s44, s60, 5898240
  buffer_store_dwordx4 v[100:103], v16, s[36:39], s44 offen sc1
  s_waitcnt lgkmcnt(8)
  v_mfma_f32_32x32x16_bf16 v[136:151], v[40:43], v[24:27], v[136:151]
  v_mfma_f32_32x32x16_bf16 v[136:151], v[44:47], v[28:31], v[136:151]
  ds_read_b64_tr_b16 v[220:221], v8 offset:320
  ds_read_b64_tr_b16 v[222:223], v8 offset:2112
  ds_read_b64_tr_b16 v[224:225], v8 offset:7488
  v_mfma_f32_32x32x16_bf16 v[136:151], v[48:51], v[32:35], v[136:151]
  ds_read_b64_tr_b16 v[226:227], v8 offset:9280
  ds_read_b64_tr_b16 v[228:229], v8 offset:14656
  ds_read_b64_tr_b16 v[230:231], v8 offset:16448
  v_mfma_f32_32x32x16_bf16 v[136:151], v[52:55], v[36:39], v[136:151]
  ds_read_b64_tr_b16 v[232:233], v8 offset:21824
  ds_read_b64_tr_b16 v[234:235], v8 offset:23616
  v_cvt_pk_bf16_f32 v104, v120, v121
  v_cvt_pk_bf16_f32 v105, v122, v123
  s_add_u32 s44, s60, 5898240
  buffer_store_dwordx2 v[104:105], v17, s[36:39], s44 offen offset:1024 sc1
  v_cvt_pk_bf16_f32 v106, v124, v125
  v_cvt_pk_bf16_f32 v107, v126, v127
  v_cvt_pk_bf16_f32 v108, v128, v129
  v_cvt_pk_bf16_f32 v109, v130, v131
  s_add_u32 s44, s60, 6062080
  buffer_store_dwordx4 v[106:109], v16, s[36:39], s44 offen sc1
  v_cvt_pk_bf16_f32 v110, v132, v133
  v_cvt_pk_bf16_f32 v111, v134, v135
  s_waitcnt lgkmcnt(8)
  v_mfma_f32_32x32x16_bf16 v[152:167], v[204:207], v[24:27], v[152:167]
  v_mfma_f32_32x32x16_bf16 v[152:167], v[208:211], v[28:31], v[152:167]
  ds_read_b64_tr_b16 v[40:41], v8 offset:384
  ds_read_b64_tr_b16 v[42:43], v8 offset:2176
  ds_read_b64_tr_b16 v[44:45], v8 offset:7552
  v_mfma_f32_32x32x16_bf16 v[152:167], v[212:215], v[32:35], v[152:167]
  ds_read_b64_tr_b16 v[46:47], v8 offset:9344
  ds_read_b64_tr_b16 v[48:49], v8 offset:14720
  ds_read_b64_tr_b16 v[50:51], v8 offset:16512
  v_mfma_f32_32x32x16_bf16 v[152:167], v[216:219], v[36:39], v[152:167]
  ds_read_b64_tr_b16 v[52:53], v8 offset:21888
  ds_read_b64_tr_b16 v[54:55], v8 offset:23680
  v_cvt_pk_bf16_f32 v112, v136, v137
  v_cvt_pk_bf16_f32 v113, v138, v139
  s_add_u32 s44, s60, 6225920
  buffer_store_dwordx4 v[110:113], v16, s[36:39], s44 offen sc1
  v_cvt_pk_bf16_f32 v114, v140, v141
  v_cvt_pk_bf16_f32 v115, v142, v143
  s_add_u32 s44, s60, 6225920
  buffer_store_dwordx2 v[114:115], v17, s[36:39], s44 offen offset:1024 sc1
  v_cvt_pk_bf16_f32 v116, v144, v145
  v_cvt_pk_bf16_f32 v117, v146, v147
  v_cvt_pk_bf16_f32 v118, v148, v149
  v_cvt_pk_bf16_f32 v119, v150, v151
  s_add_u32 s44, s60, 6389760
  buffer_store_dwordx4 v[116:119], v16, s[36:39], s44 offen sc1
  s_waitcnt lgkmcnt(8)
  v_mfma_f32_32x32x16_bf16 v[168:183], v[220:223], v[24:27], v[168:183]
  v_mfma_f32_32x32x16_bf16 v[168:183], v[224:227], v[28:31], v[168:183]
  v_mfma_f32_32x32x16_bf16 v[168:183], v[228:231], v[32:35], v[168:183]
  v_mfma_f32_32x32x16_bf16 v[168:183], v[232:235], v[36:39], v[168:183]
  s_nop 7
  v_cvt_pk_bf16_f32 v120, v152, v153
  v_cvt_pk_bf16_f32 v121, v154, v155
  v_cvt_pk_bf16_f32 v122, v156, v157
  v_cvt_pk_bf16_f32 v123, v158, v159
  s_add_u32 s44, s60, 6553600
  buffer_store_dwordx4 v[120:123], v16, s[36:39], s44 offen sc1
  v_cvt_pk_bf16_f32 v124, v160, v161
  v_cvt_pk_bf16_f32 v125, v162, v163
  s_add_u32 s44, s60, 6553600
  buffer_store_dwordx2 v[124:125], v17, s[36:39], s44 offen offset:1024 sc1
  v_cvt_pk_bf16_f32 v126, v164, v165
  v_cvt_pk_bf16_f32 v127, v166, v167
  s_waitcnt lgkmcnt(0)
  v_mfma_f32_32x32x16_bf16 v[184:199], v[40:43], v[24:27], v[184:199]
  v_mfma_f32_32x32x16_bf16 v[184:199], v[44:47], v[28:31], v[184:199]
  v_mfma_f32_32x32x16_bf16 v[184:199], v[48:51], v[32:35], v[184:199]
  v_mfma_f32_32x32x16_bf16 v[184:199], v[52:55], v[36:39], v[184:199]
  s_nop 7
  v_cvt_pk_bf16_f32 v128, v168, v169
  v_cvt_pk_bf16_f32 v129, v170, v171
  s_add_u32 s44, s60, 6717440
  buffer_store_dwordx4 v[126:129], v16, s[36:39], s44 offen sc1
  v_cvt_pk_bf16_f32 v130, v172, v173
  v_cvt_pk_bf16_f32 v131, v174, v175
  v_cvt_pk_bf16_f32 v132, v176, v177
  v_cvt_pk_bf16_f32 v133, v178, v179
  s_add_u32 s44, s60, 6881280
  buffer_store_dwordx4 v[130:133], v16, s[36:39], s44 offen sc1
  v_cvt_pk_bf16_f32 v134, v180, v181
  v_cvt_pk_bf16_f32 v135, v182, v183
  s_add_u32 s44, s60, 6881280
  buffer_store_dwordx2 v[134:135], v17, s[36:39], s44 offen offset:1024 sc1
  s_nop 3
  v_cvt_pk_bf16_f32 v136, v184, v185
  v_cvt_pk_bf16_f32 v137, v186, v187
  v_cvt_pk_bf16_f32 v138, v188, v189
  v_cvt_pk_bf16_f32 v139, v190, v191
  s_add_u32 s44, s60, 7045120
  buffer_store_dwordx4 v[136:139], v16, s[36:39], s44 offen sc1
  v_cvt_pk_bf16_f32 v140, v192, v193
  v_cvt_pk_bf16_f32 v141, v194, v195
  v_cvt_pk_bf16_f32 v142, v196, v197
  v_cvt_pk_bf16_f32 v143, v198, v199
  s_add_u32 s44, s60, 7208960
  buffer_store_dwordx4 v[140:143], v16, s[36:39], s44 offen sc1
  s_branch proj_kernel_end
proj_kernel_c_qk7_e4:
  s_barrier
  ds_read_b128 v[24:27], v4
  ds_read_b128 v[28:31], v5
  ds_read_b128 v[32:35], v6
  ds_read_b128 v[36:39], v7
  v_mfma_f32_32x32x16_bf16 v[120:135], v[68:71], v[56:59], v[120:135]
  ds_read_b64_tr_b16 v[40:41], v8 offset:0
  ds_read_b64_tr_b16 v[42:43], v8 offset:1792
  ds_read_b64_tr_b16 v[44:45], v8 offset:7168
  ds_read_b64_tr_b16 v[46:47], v8 offset:8960
  v_mfma_f32_32x32x16_bf16 v[136:151], v[72:75], v[56:59], v[136:151]
  ds_read_b64_tr_b16 v[48:49], v8 offset:14336
  ds_read_b64_tr_b16 v[50:51], v8 offset:16128
  ds_read_b64_tr_b16 v[52:53], v8 offset:21504
  ds_read_b64_tr_b16 v[54:55], v8 offset:23296
  v_mfma_f32_32x32x16_bf16 v[152:167], v[76:79], v[56:59], v[152:167]
  ds_read_b64_tr_b16 v[204:205], v8 offset:64
  ds_read_b64_tr_b16 v[206:207], v8 offset:1856
  ds_read_b64_tr_b16 v[208:209], v8 offset:7232
  ds_read_b64_tr_b16 v[210:211], v8 offset:9024
  v_mfma_f32_32x32x16_bf16 v[168:183], v[80:83], v[56:59], v[168:183]
  ds_read_b64_tr_b16 v[212:213], v8 offset:14400
  ds_read_b64_tr_b16 v[214:215], v8 offset:16192
  ds_read_b64_tr_b16 v[216:217], v8 offset:21568
  ds_read_b64_tr_b16 v[218:219], v8 offset:23360
  v_mfma_f32_32x32x16_bf16 v[184:199], v[84:87], v[56:59], v[184:199]
  s_waitcnt lgkmcnt(8)
  v_mfma_f32_32x32x16_bf16 v[88:103], v[40:43], v[24:27], v[88:103]
  v_mfma_f32_32x32x16_bf16 v[88:103], v[44:47], v[28:31], v[88:103]
  ds_read_b64_tr_b16 v[220:221], v8 offset:128
  ds_read_b64_tr_b16 v[222:223], v8 offset:1920
  ds_read_b64_tr_b16 v[224:225], v8 offset:7296
  v_mfma_f32_32x32x16_bf16 v[88:103], v[48:51], v[32:35], v[88:103]
  ds_read_b64_tr_b16 v[226:227], v8 offset:9088
  ds_read_b64_tr_b16 v[228:229], v8 offset:14464
  ds_read_b64_tr_b16 v[230:231], v8 offset:16256
  v_mfma_f32_32x32x16_bf16 v[88:103], v[52:55], v[36:39], v[88:103]
  ds_read_b64_tr_b16 v[232:233], v8 offset:21632
  ds_read_b64_tr_b16 v[234:235], v8 offset:23424
  s_waitcnt lgkmcnt(8)
  v_mfma_f32_32x32x16_bf16 v[104:119], v[204:207], v[24:27], v[104:119]
  v_mfma_f32_32x32x16_bf16 v[104:119], v[208:211], v[28:31], v[104:119]
  ds_read_b64_tr_b16 v[40:41], v8 offset:192
  ds_read_b64_tr_b16 v[42:43], v8 offset:1984
  ds_read_b64_tr_b16 v[44:45], v8 offset:7360
  v_mfma_f32_32x32x16_bf16 v[104:119], v[212:215], v[32:35], v[104:119]
  ds_read_b64_tr_b16 v[46:47], v8 offset:9152
  ds_read_b64_tr_b16 v[48:49], v8 offset:14528
  ds_read_b64_tr_b16 v[50:51], v8 offset:16320
  v_mfma_f32_32x32x16_bf16 v[104:119], v[216:219], v[36:39], v[104:119]
  ds_read_b64_tr_b16 v[52:53], v8 offset:21696
  ds_read_b64_tr_b16 v[54:55], v8 offset:23488
  v_cvt_pk_bf16_f32 v88, v88, v89
  v_cvt_pk_bf16_f32 v89, v90, v91
  s_add_u32 s44, s60, 7208960
  buffer_store_dwordx2 v[88:89], v17, s[36:39], s44 offen offset:1024 sc1
  v_cvt_pk_bf16_f32 v90, v92, v93
  v_cvt_pk_bf16_f32 v91, v94, v95
  v_cvt_pk_bf16_f32 v92, v96, v97
  v_cvt_pk_bf16_f32 v93, v98, v99
  s_add_u32 s44, s60, 7372800
  buffer_store_dwordx4 v[90:93], v16, s[36:39], s44 offen sc1
  v_cvt_pk_bf16_f32 v94, v100, v101
  v_cvt_pk_bf16_f32 v95, v102, v103
  s_waitcnt lgkmcnt(8)
  v_mfma_f32_32x32x16_bf16 v[120:135], v[220:223], v[24:27], v[120:135]
  v_mfma_f32_32x32x16_bf16 v[120:135], v[224:227], v[28:31], v[120:135]
  ds_read_b64_tr_b16 v[204:205], v8 offset:256
  ds_read_b64_tr_b16 v[206:207], v8 offset:2048
  ds_read_b64_tr_b16 v[208:209], v8 offset:7424
  v_mfma_f32_32x32x16_bf16 v[120:135], v[228:231], v[32:35], v[120:135]
  ds_read_b64_tr_b16 v[210:211], v8 offset:9216
  ds_read_b64_tr_b16 v[212:213], v8 offset:14592
  ds_read_b64_tr_b16 v[214:215], v8 offset:16384
  v_mfma_f32_32x32x16_bf16 v[120:135], v[232:235], v[36:39], v[120:135]
  ds_read_b64_tr_b16 v[216:217], v8 offset:21760
  ds_read_b64_tr_b16 v[218:219], v8 offset:23552
  v_cvt_pk_bf16_f32 v96, v104, v105
  v_cvt_pk_bf16_f32 v97, v106, v107
  s_add_u32 s44, s60, 7536640
  buffer_store_dwordx4 v[94:97], v16, s[36:39], s44 offen sc1
  v_cvt_pk_bf16_f32 v98, v108, v109
  v_cvt_pk_bf16_f32 v99, v110, v111
  s_add_u32 s44, s60, 7536640
  buffer_store_dwordx2 v[98:99], v17, s[36:39], s44 offen offset:1024 sc1
  v_cvt_pk_bf16_f32 v100, v112, v113
  v_cvt_pk_bf16_f32 v101, v114, v115
  v_cvt_pk_bf16_f32 v102, v116, v117
  v_cvt_pk_bf16_f32 v103, v118, v119
  s_add_u32 s44, s60, 7700480
  buffer_store_dwordx4 v[100:103], v16, s[36:39], s44 offen sc1
  s_waitcnt lgkmcnt(8)
  v_mfma_f32_32x32x16_bf16 v[136:151], v[40:43], v[24:27], v[136:151]
  v_mfma_f32_32x32x16_bf16 v[136:151], v[44:47], v[28:31], v[136:151]
  ds_read_b64_tr_b16 v[220:221], v8 offset:320
  ds_read_b64_tr_b16 v[222:223], v8 offset:2112
  ds_read_b64_tr_b16 v[224:225], v8 offset:7488
  v_mfma_f32_32x32x16_bf16 v[136:151], v[48:51], v[32:35], v[136:151]
  ds_read_b64_tr_b16 v[226:227], v8 offset:9280
  ds_read_b64_tr_b16 v[228:229], v8 offset:14656
  ds_read_b64_tr_b16 v[230:231], v8 offset:16448
  v_mfma_f32_32x32x16_bf16 v[136:151], v[52:55], v[36:39], v[136:151]
  ds_read_b64_tr_b16 v[232:233], v8 offset:21824
  ds_read_b64_tr_b16 v[234:235], v8 offset:23616
  v_cvt_pk_bf16_f32 v104, v120, v121
  v_cvt_pk_bf16_f32 v105, v122, v123
  v_cvt_pk_bf16_f32 v106, v124, v125
  v_cvt_pk_bf16_f32 v107, v126, v127
  s_add_u32 s44, s60, 7864320
  buffer_store_dwordx4 v[104:107], v16, s[36:39], s44 offen sc1
  v_cvt_pk_bf16_f32 v108, v128, v129
  v_cvt_pk_bf16_f32 v109, v130, v131
  s_add_u32 s44, s60, 7864320
  buffer_store_dwordx2 v[108:109], v17, s[36:39], s44 offen offset:1024 sc1
  v_cvt_pk_bf16_f32 v110, v132, v133
  v_cvt_pk_bf16_f32 v111, v134, v135
  s_waitcnt lgkmcnt(8)
  v_mfma_f32_32x32x16_bf16 v[152:167], v[204:207], v[24:27], v[152:167]
  v_mfma_f32_32x32x16_bf16 v[152:167], v[208:211], v[28:31], v[152:167]
  ds_read_b64_tr_b16 v[40:41], v8 offset:384
  ds_read_b64_tr_b16 v[42:43], v8 offset:2176
  ds_read_b64_tr_b16 v[44:45], v8 offset:7552
  v_mfma_f32_32x32x16_bf16 v[152:167], v[212:215], v[32:35], v[152:167]
  ds_read_b64_tr_b16 v[46:47], v8 offset:9344
  ds_read_b64_tr_b16 v[48:49], v8 offset:14720
  ds_read_b64_tr_b16 v[50:51], v8 offset:16512
  v_mfma_f32_32x32x16_bf16 v[152:167], v[216:219], v[36:39], v[152:167]
  ds_read_b64_tr_b16 v[52:53], v8 offset:21888
  ds_read_b64_tr_b16 v[54:55], v8 offset:23680
  v_cvt_pk_bf16_f32 v112, v136, v137
  v_cvt_pk_bf16_f32 v113, v138, v139
  s_add_u32 s44, s60, 8028160
  buffer_store_dwordx4 v[110:113], v16, s[36:39], s44 offen sc1
  v_cvt_pk_bf16_f32 v114, v140, v141
  v_cvt_pk_bf16_f32 v115, v142, v143
  v_cvt_pk_bf16_f32 v116, v144, v145
  v_cvt_pk_bf16_f32 v117, v146, v147
  s_add_u32 s44, s60, 8192000
  buffer_store_dwordx4 v[114:117], v16, s[36:39], s44 offen sc1
  v_cvt_pk_bf16_f32 v118, v148, v149
  v_cvt_pk_bf16_f32 v119, v150, v151
  s_add_u32 s44, s60, 8192000
  buffer_store_dwordx2 v[118:119], v17, s[36:39], s44 offen offset:1024 sc1
  s_waitcnt lgkmcnt(8)
  v_mfma_f32_32x32x16_bf16 v[168:183], v[220:223], v[24:27], v[168:183]
  v_mfma_f32_32x32x16_bf16 v[168:183], v[224:227], v[28:31], v[168:183]
  v_mfma_f32_32x32x16_bf16 v[168:183], v[228:231], v[32:35], v[168:183]
  v_mfma_f32_32x32x16_bf16 v[168:183], v[232:235], v[36:39], v[168:183]
  s_nop 7
  v_cvt_pk_bf16_f32 v120, v152, v153
  v_cvt_pk_bf16_f32 v121, v154, v155
  v_cvt_pk_bf16_f32 v122, v156, v157
  v_cvt_pk_bf16_f32 v123, v158, v159
  s_add_u32 s44, s60, 8355840
  buffer_store_dwordx4 v[120:123], v16, s[36:39], s44 offen sc1
  v_cvt_pk_bf16_f32 v124, v160, v161
  v_cvt_pk_bf16_f32 v125, v162, v163
  v_cvt_pk_bf16_f32 v126, v164, v165
  v_cvt_pk_bf16_f32 v127, v166, v167
  s_add_u32 s44, s60, 8519680
  buffer_store_dwordx4 v[124:127], v16, s[36:39], s44 offen sc1
  s_waitcnt lgkmcnt(0)
  v_mfma_f32_32x32x16_bf16 v[184:199], v[40:43], v[24:27], v[184:199]
  v_mfma_f32_32x32x16_bf16 v[184:199], v[44:47], v[28:31], v[184:199]
  v_mfma_f32_32x32x16_bf16 v[184:199], v[48:51], v[32:35], v[184:199]
  v_mfma_f32_32x32x16_bf16 v[184:199], v[52:55], v[36:39], v[184:199]
  s_nop 7
  v_cvt_pk_bf16_f32 v128, v168, v169
  v_cvt_pk_bf16_f32 v129, v170, v171
  s_add_u32 s44, s60, 8519680
  buffer_store_dwordx2 v[128:129], v17, s[36:39], s44 offen offset:1024 sc1
  v_cvt_pk_bf16_f32 v130, v172, v173
  v_cvt_pk_bf16_f32 v131, v174, v175
  v_cvt_pk_bf16_f32 v132, v176, v177
  v_cvt_pk_bf16_f32 v133, v178, v179
  s_add_u32 s44, s60, 8683520
  buffer_store_dwordx4 v[130:133], v16, s[36:39], s44 offen sc1
  v_cvt_pk_bf16_f32 v134, v180, v181
  v_cvt_pk_bf16_f32 v135, v182, v183
  s_nop 3
  v_cvt_pk_bf16_f32 v136, v184, v185
  v_cvt_pk_bf16_f32 v137, v186, v187
  s_add_u32 s44, s60, 8847360
  buffer_store_dwordx4 v[134:137], v16, s[36:39], s44 offen sc1
  v_cvt_pk_bf16_f32 v138, v188, v189
  v_cvt_pk_bf16_f32 v139, v190, v191
  s_add_u32 s44, s60, 8847360
  buffer_store_dwordx2 v[138:139], v17, s[36:39], s44 offen offset:1024 sc1
  v_cvt_pk_bf16_f32 v140, v192, v193
  v_cvt_pk_bf16_f32 v141, v194, v195
  v_cvt_pk_bf16_f32 v142, v196, v197
  v_cvt_pk_bf16_f32 v143, v198, v199
  s_add_u32 s44, s60, 9011200
  buffer_store_dwordx4 v[140:143], v16, s[36:39], s44 offen sc1
  s_branch proj_kernel_end
proj_kernel_c_qk5:
  v_and_b32 v12, 31, v2
  v_lshrrev_b32 v13, 5, v2
  v_lshrrev_b32 v14, 1, v12
  v_and_b32 v14, 7, v14
  s_lshl_b32 s44, s40, 12
  v_add_u32 v15, 0, v13
  v_xor_b32 v15, v15, v14
  v_lshlrev_b32 v15, 4, v15
  v_lshl_add_u32 v15, v12, 7, v15
  v_add_u32 v4, s44, v15
  v_add_u32 v15, 2, v13
  v_xor_b32 v15, v15, v14
  v_lshlrev_b32 v15, 4, v15
  v_lshl_add_u32 v15, v12, 7, v15
  v_add_u32 v5, s44, v15
  v_add_u32 v15, 4, v13
  v_xor_b32 v15, v15, v14
  v_lshlrev_b32 v15, 4, v15
  v_lshl_add_u32 v15, v12, 7, v15
  v_add_u32 v6, s44, v15
  v_add_u32 v15, 6, v13
  v_xor_b32 v15, v15, v14
  v_lshlrev_b32 v15, 4, v15
  v_lshl_add_u32 v15, v12, 7, v15
  v_add_u32 v7, s44, v15
  v_lshlrev_b32 v15, 3, v13
  v_bfe_u32 v3, v2, 2, 2
  v_add_u32 v15, v15, v3
  v_mul_u32_u24 v15, 320, v15
  v_bfe_u32 v3, v2, 4, 1
  v_lshl_add_u32 v15, v3, 5, v15
  v_and_b32 v3, 3, v2
  v_lshl_add_u32 v15, v3, 3, v15
  v_add_u32 v8, 16384, v15
  s_lshl_b32 s45, s41, 2
  s_add_u32 s45, s45, s40
  s_mul_i32 s60, s45, 2560
  v_lshlrev_b32 v16, 4, v2
  v_mul_u32_u24 v17, 163840, v13
  v_lshl_add_u32 v17, v12, 3, v17
  s_mov_b32 s56, 0x3ea52b5c
  s_mov_b32 s57, s56
  s_mov_b32 s48, 0
  s_barrier
  ds_read_b128 v[24:27], v4
  ds_read_b64_tr_b16 v[28:29], v8 offset:0
  ds_read_b64_tr_b16 v[30:31], v8 offset:1280
  ds_read_b64_tr_b16 v[32:33], v8 offset:64
  ds_read_b64_tr_b16 v[34:35], v8 offset:1344
  ds_read_b64_tr_b16 v[36:37], v8 offset:128
  ds_read_b64_tr_b16 v[38:39], v8 offset:1408
  ds_read_b64_tr_b16 v[40:41], v8 offset:192
  ds_read_b64_tr_b16 v[42:43], v8 offset:1472
  ds_read_b64_tr_b16 v[44:45], v8 offset:256
  ds_read_b64_tr_b16 v[46:47], v8 offset:1536
  s_waitcnt lgkmcnt(8)
  v_mfma_f32_32x32x16_bf16 v[88:103], v[28:31], v[24:27], 0
  ds_read_b128 v[56:59], v5
  ds_read_b64_tr_b16 v[60:61], v8 offset:5120
  ds_read_b64_tr_b16 v[62:63], v8 offset:6400
  s_waitcnt lgkmcnt(9)
  v_mfma_f32_32x32x16_bf16 v[104:119], v[32:35], v[24:27], 0
  ds_read_b64_tr_b16 v[64:65], v8 offset:5184
  ds_read_b64_tr_b16 v[66:67], v8 offset:6464
  s_waitcnt lgkmcnt(9)
  v_mfma_f32_32x32x16_bf16 v[120:135], v[36:39], v[24:27], 0
  ds_read_b64_tr_b16 v[68:69], v8 offset:5248
  ds_read_b64_tr_b16 v[70:71], v8 offset:6528
  s_waitcnt lgkmcnt(9)
  v_mfma_f32_32x32x16_bf16 v[136:151], v[40:43], v[24:27], 0
  ds_read_b64_tr_b16 v[72:73], v8 offset:5312
  ds_read_b64_tr_b16 v[74:75], v8 offset:6592
  s_waitcnt lgkmcnt(9)
  v_mfma_f32_32x32x16_bf16 v[152:167], v[44:47], v[24:27], 0
  ds_read_b64_tr_b16 v[76:77], v8 offset:5376
  ds_read_b64_tr_b16 v[78:79], v8 offset:6656
  s_waitcnt lgkmcnt(8)
  v_mfma_f32_32x32x16_bf16 v[88:103], v[60:63], v[56:59], v[88:103]
  ds_read_b128 v[24:27], v6
  ds_read_b64_tr_b16 v[28:29], v8 offset:10240
  ds_read_b64_tr_b16 v[30:31], v8 offset:11520
  s_waitcnt lgkmcnt(9)
  v_mfma_f32_32x32x16_bf16 v[104:119], v[64:67], v[56:59], v[104:119]
  ds_read_b64_tr_b16 v[32:33], v8 offset:10304
  ds_read_b64_tr_b16 v[34:35], v8 offset:11584
  s_waitcnt lgkmcnt(9)
  v_mfma_f32_32x32x16_bf16 v[120:135], v[68:71], v[56:59], v[120:135]
  ds_read_b64_tr_b16 v[36:37], v8 offset:10368
  ds_read_b64_tr_b16 v[38:39], v8 offset:11648
  s_waitcnt lgkmcnt(9)
  v_mfma_f32_32x32x16_bf16 v[136:151], v[72:75], v[56:59], v[136:151]
  ds_read_b64_tr_b16 v[40:41], v8 offset:10432
  ds_read_b64_tr_b16 v[42:43], v8 offset:11712
  s_waitcnt lgkmcnt(9)
  v_mfma_f32_32x32x16_bf16 v[152:167], v[76:79], v[56:59], v[152:167]
  ds_read_b64_tr_b16 v[44:45], v8 offset:10496
  ds_read_b64_tr_b16 v[46:47], v8 offset:11776
  s_waitcnt lgkmcnt(8)
  v_mfma_f32_32x32x16_bf16 v[88:103], v[28:31], v[24:27], v[88:103]
  ds_read_b128 v[56:59], v7
  ds_read_b64_tr_b16 v[60:61], v8 offset:15360
  ds_read_b64_tr_b16 v[62:63], v8 offset:16640
  s_waitcnt lgkmcnt(9)
  v_mfma_f32_32x32x16_bf16 v[104:119], v[32:35], v[24:27], v[104:119]
  ds_read_b64_tr_b16 v[64:65], v8 offset:15424
  ds_read_b64_tr_b16 v[66:67], v8 offset:16704
  s_waitcnt lgkmcnt(9)
  v_mfma_f32_32x32x16_bf16 v[120:135], v[36:39], v[24:27], v[120:135]
  ds_read_b64_tr_b16 v[68:69], v8 offset:15488
  ds_read_b64_tr_b16 v[70:71], v8 offset:16768
  s_waitcnt lgkmcnt(9)
  v_mfma_f32_32x32x16_bf16 v[136:151], v[40:43], v[24:27], v[136:151]
  ds_read_b64_tr_b16 v[72:73], v8 offset:15552
  ds_read_b64_tr_b16 v[74:75], v8 offset:16832
  s_waitcnt lgkmcnt(9)
  v_mfma_f32_32x32x16_bf16 v[152:167], v[44:47], v[24:27], v[152:167]
  ds_read_b64_tr_b16 v[76:77], v8 offset:15616
  ds_read_b64_tr_b16 v[78:79], v8 offset:16896
  s_waitcnt lgkmcnt(8)
  v_mfma_f32_32x32x16_bf16 v[88:103], v[60:63], v[56:59], v[88:103]
  s_mov_b32 s49, s48
  s_add_u32 s48, s48, 45056
  s_cmp_eq_u32 s48, 135168
  s_cselect_b32 s48, 0, s48
  s_sub_u32 s49, s48, s49
  v_add_u32 v4, s49, v4
  v_add_u32 v5, s49, v5
  v_add_u32 v6, s49, v6
  v_add_u32 v7, s49, v7
  v_add_u32 v8, s49, v8
  s_waitcnt lgkmcnt(6)
  v_mfma_f32_32x32x16_bf16 v[104:119], v[64:67], v[56:59], v[104:119]
  s_waitcnt lgkmcnt(0)
  s_mov_b32 s50, 8
proj_kernel_c_qk5_loop_9:
  s_barrier
  ds_read_b128 v[24:27], v4
  ds_read_b64_tr_b16 v[28:29], v8 offset:0
  ds_read_b64_tr_b16 v[30:31], v8 offset:1280
  ds_read_b64_tr_b16 v[32:33], v8 offset:64
  ds_read_b64_tr_b16 v[34:35], v8 offset:1344
  v_mfma_f32_32x32x16_bf16 v[120:135], v[68:71], v[56:59], v[120:135]
  ds_read_b64_tr_b16 v[36:37], v8 offset:128
  ds_read_b64_tr_b16 v[38:39], v8 offset:1408
  v_mfma_f32_32x32x16_bf16 v[136:151], v[72:75], v[56:59], v[136:151]
  ds_read_b64_tr_b16 v[40:41], v8 offset:192
  ds_read_b64_tr_b16 v[42:43], v8 offset:1472
  v_mfma_f32_32x32x16_bf16 v[152:167], v[76:79], v[56:59], v[152:167]
  ds_read_b64_tr_b16 v[44:45], v8 offset:256
  ds_read_b64_tr_b16 v[46:47], v8 offset:1536
  s_waitcnt lgkmcnt(8)
  v_mfma_f32_32x32x16_bf16 v[88:103], v[28:31], v[24:27], v[88:103]
  ds_read_b128 v[56:59], v5
  ds_read_b64_tr_b16 v[60:61], v8 offset:5120
  ds_read_b64_tr_b16 v[62:63], v8 offset:6400
  s_waitcnt lgkmcnt(9)
  v_mfma_f32_32x32x16_bf16 v[104:119], v[32:35], v[24:27], v[104:119]
  ds_read_b64_tr_b16 v[64:65], v8 offset:5184
  ds_read_b64_tr_b16 v[66:67], v8 offset:6464
  s_waitcnt lgkmcnt(9)
  v_mfma_f32_32x32x16_bf16 v[120:135], v[36:39], v[24:27], v[120:135]
  ds_read_b64_tr_b16 v[68:69], v8 offset:5248
  ds_read_b64_tr_b16 v[70:71], v8 offset:6528
  s_waitcnt lgkmcnt(9)
  v_mfma_f32_32x32x16_bf16 v[136:151], v[40:43], v[24:27], v[136:151]
  ds_read_b64_tr_b16 v[72:73], v8 offset:5312
  ds_read_b64_tr_b16 v[74:75], v8 offset:6592
  s_waitcnt lgkmcnt(9)
  v_mfma_f32_32x32x16_bf16 v[152:167], v[44:47], v[24:27], v[152:167]
  ds_read_b64_tr_b16 v[76:77], v8 offset:5376
  ds_read_b64_tr_b16 v[78:79], v8 offset:6656
  s_waitcnt lgkmcnt(8)
  v_mfma_f32_32x32x16_bf16 v[88:103], v[60:63], v[56:59], v[88:103]
  ds_read_b128 v[24:27], v6
  ds_read_b64_tr_b16 v[28:29], v8 offset:10240
  ds_read_b64_tr_b16 v[30:31], v8 offset:11520
  s_waitcnt lgkmcnt(9)
  v_mfma_f32_32x32x16_bf16 v[104:119], v[64:67], v[56:59], v[104:119]
  ds_read_b64_tr_b16 v[32:33], v8 offset:10304
  ds_read_b64_tr_b16 v[34:35], v8 offset:11584
  s_waitcnt lgkmcnt(9)
  v_mfma_f32_32x32x16_bf16 v[120:135], v[68:71], v[56:59], v[120:135]
  ds_read_b64_tr_b16 v[36:37], v8 offset:10368
  ds_read_b64_tr_b16 v[38:39], v8 offset:11648
  s_waitcnt lgkmcnt(9)
  v_mfma_f32_32x32x16_bf16 v[136:151], v[72:75], v[56:59], v[136:151]
  ds_read_b64_tr_b16 v[40:41], v8 offset:10432
  ds_read_b64_tr_b16 v[42:43], v8 offset:11712
  s_waitcnt lgkmcnt(9)
  v_mfma_f32_32x32x16_bf16 v[152:167], v[76:79], v[56:59], v[152:167]
  ds_read_b64_tr_b16 v[44:45], v8 offset:10496
  ds_read_b64_tr_b16 v[46:47], v8 offset:11776
  s_waitcnt lgkmcnt(8)
  v_mfma_f32_32x32x16_bf16 v[88:103], v[28:31], v[24:27], v[88:103]
  ds_read_b128 v[56:59], v7
  ds_read_b64_tr_b16 v[60:61], v8 offset:15360
  ds_read_b64_tr_b16 v[62:63], v8 offset:16640
  s_waitcnt lgkmcnt(9)
  v_mfma_f32_32x32x16_bf16 v[104:119], v[32:35], v[24:27], v[104:119]
  ds_read_b64_tr_b16 v[64:65], v8 offset:15424
  ds_read_b64_tr_b16 v[66:67], v8 offset:16704
  s_waitcnt lgkmcnt(9)
  v_mfma_f32_32x32x16_bf16 v[120:135], v[36:39], v[24:27], v[120:135]
  ds_read_b64_tr_b16 v[68:69], v8 offset:15488
  ds_read_b64_tr_b16 v[70:71], v8 offset:16768
  s_waitcnt lgkmcnt(9)
  v_mfma_f32_32x32x16_bf16 v[136:151], v[40:43], v[24:27], v[136:151]
  ds_read_b64_tr_b16 v[72:73], v8 offset:15552
  ds_read_b64_tr_b16 v[74:75], v8 offset:16832
  s_waitcnt lgkmcnt(9)
  v_mfma_f32_32x32x16_bf16 v[152:167], v[44:47], v[24:27], v[152:167]
  ds_read_b64_tr_b16 v[76:77], v8 offset:15616
  ds_read_b64_tr_b16 v[78:79], v8 offset:16896
  s_waitcnt lgkmcnt(8)
  v_mfma_f32_32x32x16_bf16 v[88:103], v[60:63], v[56:59], v[88:103]
  s_mov_b32 s49, s48
  s_add_u32 s48, s48, 45056
  s_cmp_eq_u32 s48, 135168
  s_cselect_b32 s48, 0, s48
  s_sub_u32 s49, s48, s49
  v_add_u32 v4, s49, v4
  v_add_u32 v5, s49, v5
  v_add_u32 v6, s49, v6
  v_add_u32 v7, s49, v7
  v_add_u32 v8, s49, v8
  s_waitcnt lgkmcnt(6)
  v_mfma_f32_32x32x16_bf16 v[104:119], v[64:67], v[56:59], v[104:119]
  s_waitcnt lgkmcnt(0)
  s_sub_u32 s50, s50, 1
  s_cmp_lg_u32 s50, 0
  s_cbranch_scc1 proj_kernel_c_qk5_loop_9
proj_kernel_c_qk5_e5:
  s_barrier
  ds_read_b128 v[24:27], v4
  ds_read_b128 v[28:31], v5
  ds_read_b128 v[32:35], v6
  ds_read_b128 v[36:39], v7
  ds_read_b64_tr_b16 v[40:41], v8 offset:0
  v_mfma_f32_32x32x16_bf16 v[120:135], v[68:71], v[56:59], v[120:135]
  ds_read_b64_tr_b16 v[42:43], v8 offset:1280
  ds_read_b64_tr_b16 v[44:45], v8 offset:5120
  ds_read_b64_tr_b16 v[46:47], v8 offset:6400
  ds_read_b64_tr_b16 v[48:49], v8 offset:10240
  ds_read_b64_tr_b16 v[50:51], v8 offset:11520
  v_mfma_f32_32x32x16_bf16 v[136:151], v[72:75], v[56:59], v[136:151]
  ds_read_b64_tr_b16 v[52:53], v8 offset:15360
  ds_read_b64_tr_b16 v[54:55], v8 offset:16640
  ds_read_b64_tr_b16 v[204:205], v8 offset:64
  ds_read_b64_tr_b16 v[206:207], v8 offset:1344
  ds_read_b64_tr_b16 v[208:209], v8 offset:5184
  v_mfma_f32_32x32x16_bf16 v[152:167], v[76:79], v[56:59], v[152:167]
  ds_read_b64_tr_b16 v[210:211], v8 offset:6464
  ds_read_b64_tr_b16 v[212:213], v8 offset:10304
  ds_read_b64_tr_b16 v[214:215], v8 offset:11584
  ds_read_b64_tr_b16 v[216:217], v8 offset:15424
  ds_read_b64_tr_b16 v[218:219], v8 offset:16704
  s_waitcnt lgkmcnt(8)
  v_mfma_f32_32x32x16_bf16 v[88:103], v[40:43], v[24:27], v[88:103]
  v_mfma_f32_32x32x16_bf16 v[88:103], v[44:47], v[28:31], v[88:103]
  ds_read_b64_tr_b16 v[220:221], v8 offset:128
  ds_read_b64_tr_b16 v[222:223], v8 offset:1408
  ds_read_b64_tr_b16 v[224:225], v8 offset:5248
  v_mfma_f32_32x32x16_bf16 v[88:103], v[48:51], v[32:35], v[88:103]
  ds_read_b64_tr_b16 v[226:227], v8 offset:6528
  ds_read_b64_tr_b16 v[228:229], v8 offset:10368
  ds_read_b64_tr_b16 v[230:231], v8 offset:11648
  v_mfma_f32_32x32x16_bf16 v[88:103], v[52:55], v[36:39], v[88:103]
  ds_read_b64_tr_b16 v[232:233], v8 offset:15488
  ds_read_b64_tr_b16 v[234:235], v8 offset:16768
  s_waitcnt lgkmcnt(8)
  v_mfma_f32_32x32x16_bf16 v[104:119], v[204:207], v[24:27], v[104:119]
  v_mfma_f32_32x32x16_bf16 v[104:119], v[208:211], v[28:31], v[104:119]
  ds_read_b64_tr_b16 v[40:41], v8 offset:192
  ds_read_b64_tr_b16 v[42:43], v8 offset:1472
  ds_read_b64_tr_b16 v[44:45], v8 offset:5312
  v_mfma_f32_32x32x16_bf16 v[104:119], v[212:215], v[32:35], v[104:119]
  ds_read_b64_tr_b16 v[46:47], v8 offset:6592
  ds_read_b64_tr_b16 v[48:49], v8 offset:10432
  ds_read_b64_tr_b16 v[50:51], v8 offset:11712
  v_mfma_f32_32x32x16_bf16 v[104:119], v[216:219], v[36:39], v[104:119]
  ds_read_b64_tr_b16 v[52:53], v8 offset:15552
  ds_read_b64_tr_b16 v[54:55], v8 offset:16832
  v_cvt_pk_bf16_f32 v88, v88, v89
  v_cvt_pk_bf16_f32 v89, v90, v91
  v_cvt_pk_bf16_f32 v90, v92, v93
  v_cvt_pk_bf16_f32 v91, v94, v95
  s_add_u32 s44, s60, 9175040
  buffer_store_dwordx4 v[88:91], v16, s[36:39], s44 offen sc1
  v_cvt_pk_bf16_f32 v92, v96, v97
  v_cvt_pk_bf16_f32 v93, v98, v99
  s_add_u32 s44, s60, 9175040
  buffer_store_dwordx2 v[92:93], v17, s[36:39], s44 offen offset:1024 sc1
  v_cvt_pk_bf16_f32 v94, v100, v101
  v_cvt_pk_bf16_f32 v95, v102, v103
  s_waitcnt lgkmcnt(8)
  v_mfma_f32_32x32x16_bf16 v[120:135], v[220:223], v[24:27], v[120:135]
  v_mfma_f32_32x32x16_bf16 v[120:135], v[224:227], v[28:31], v[120:135]
  ds_read_b64_tr_b16 v[204:205], v8 offset:256
  ds_read_b64_tr_b16 v[206:207], v8 offset:1536
  ds_read_b64_tr_b16 v[208:209], v8 offset:5376
  v_mfma_f32_32x32x16_bf16 v[120:135], v[228:231], v[32:35], v[120:135]
  ds_read_b64_tr_b16 v[210:211], v8 offset:6656
  ds_read_b64_tr_b16 v[212:213], v8 offset:10496
  ds_read_b64_tr_b16 v[214:215], v8 offset:11776
  v_mfma_f32_32x32x16_bf16 v[120:135], v[232:235], v[36:39], v[120:135]
  ds_read_b64_tr_b16 v[216:217], v8 offset:15616
  ds_read_b64_tr_b16 v[218:219], v8 offset:16896
  v_cvt_pk_bf16_f32 v96, v104, v105
  v_cvt_pk_bf16_f32 v97, v106, v107
  s_add_u32 s44, s60, 9338880
  buffer_store_dwordx4 v[94:97], v16, s[36:39], s44 offen sc1
  v_cvt_pk_bf16_f32 v98, v108, v109
  v_cvt_pk_bf16_f32 v99, v110, v111
  v_cvt_pk_bf16_f32 v100, v112, v113
  v_cvt_pk_bf16_f32 v101, v114, v115
  s_add_u32 s44, s60, 9502720
  buffer_store_dwordx4 v[98:101], v16, s[36:39], s44 offen sc1
  v_cvt_pk_bf16_f32 v102, v116, v117
  v_cvt_pk_bf16_f32 v103, v118, v119
  s_add_u32 s44, s60, 9502720
  buffer_store_dwordx2 v[102:103], v17, s[36:39], s44 offen offset:1024 sc1
  s_waitcnt lgkmcnt(8)
  v_mfma_f32_32x32x16_bf16 v[136:151], v[40:43], v[24:27], v[136:151]
  v_mfma_f32_32x32x16_bf16 v[136:151], v[44:47], v[28:31], v[136:151]
  v_mfma_f32_32x32x16_bf16 v[136:151], v[48:51], v[32:35], v[136:151]
  v_mfma_f32_32x32x16_bf16 v[136:151], v[52:55], v[36:39], v[136:151]
  s_nop 7
  v_cvt_pk_bf16_f32 v104, v120, v121
  v_cvt_pk_bf16_f32 v105, v122, v123
  v_cvt_pk_bf16_f32 v106, v124, v125
  v_cvt_pk_bf16_f32 v107, v126, v127
  s_add_u32 s44, s60, 9666560
  buffer_store_dwordx4 v[104:107], v16, s[36:39], s44 offen sc1
  v_cvt_pk_bf16_f32 v108, v128, v129
  v_cvt_pk_bf16_f32 v109, v130, v131
  v_cvt_pk_bf16_f32 v110, v132, v133
  v_cvt_pk_bf16_f32 v111, v134, v135
  s_add_u32 s44, s60, 9830400
  buffer_store_dwordx4 v[108:111], v16, s[36:39], s44 offen sc1
  s_waitcnt lgkmcnt(0)
  v_mfma_f32_32x32x16_bf16 v[152:167], v[204:207], v[24:27], v[152:167]
  v_mfma_f32_32x32x16_bf16 v[152:167], v[208:211], v[28:31], v[152:167]
  v_mfma_f32_32x32x16_bf16 v[152:167], v[212:215], v[32:35], v[152:167]
  v_mfma_f32_32x32x16_bf16 v[152:167], v[216:219], v[36:39], v[152:167]
  s_nop 7
  v_cvt_pk_bf16_f32 v112, v136, v137
  v_cvt_pk_bf16_f32 v113, v138, v139
  s_add_u32 s44, s60, 9830400
  buffer_store_dwordx2 v[112:113], v17, s[36:39], s44 offen offset:1024 sc1
  v_cvt_pk_bf16_f32 v114, v140, v141
  v_cvt_pk_bf16_f32 v115, v142, v143
  v_cvt_pk_bf16_f32 v116, v144, v145
  v_cvt_pk_bf16_f32 v117, v146, v147
  s_add_u32 s44, s60, 9994240
  buffer_store_dwordx4 v[114:117], v16, s[36:39], s44 offen sc1
  v_cvt_pk_bf16_f32 v118, v148, v149
  v_cvt_pk_bf16_f32 v119, v150, v151
  s_nop 3
  v_cvt_pk_bf16_f32 v120, v152, v153
  v_cvt_pk_bf16_f32 v121, v154, v155
  s_add_u32 s44, s60, 10158080
  buffer_store_dwordx4 v[118:121], v16, s[36:39], s44 offen sc1
  v_cvt_pk_bf16_f32 v122, v156, v157
  v_cvt_pk_bf16_f32 v123, v158, v159
  s_add_u32 s44, s60, 10158080
  buffer_store_dwordx2 v[122:123], v17, s[36:39], s44 offen offset:1024 sc1
  v_cvt_pk_bf16_f32 v124, v160, v161
  v_cvt_pk_bf16_f32 v125, v162, v163
  v_cvt_pk_bf16_f32 v126, v164, v165
  v_cvt_pk_bf16_f32 v127, v166, v167
  s_add_u32 s44, s60, 10321920
  buffer_store_dwordx4 v[124:127], v16, s[36:39], s44 offen sc1
  s_branch proj_kernel_end
proj_kernel_c_v5:
  v_and_b32 v12, 31, v2
  v_lshrrev_b32 v13, 5, v2
  v_lshrrev_b32 v14, 1, v12
  v_and_b32 v14, 7, v14
  s_lshl_b32 s44, s40, 12
  v_add_u32 v15, 0, v13
  v_xor_b32 v15, v15, v14
  v_lshlrev_b32 v15, 4, v15
  v_lshl_add_u32 v15, v12, 7, v15
  v_add_u32 v4, s44, v15
  v_add_u32 v15, 2, v13
  v_xor_b32 v15, v15, v14
  v_lshlrev_b32 v15, 4, v15
  v_lshl_add_u32 v15, v12, 7, v15
  v_add_u32 v5, s44, v15
  v_add_u32 v15, 4, v13
  v_xor_b32 v15, v15, v14
  v_lshlrev_b32 v15, 4, v15
  v_lshl_add_u32 v15, v12, 7, v15
  v_add_u32 v6, s44, v15
  v_add_u32 v15, 6, v13
  v_xor_b32 v15, v15, v14
  v_lshlrev_b32 v15, 4, v15
  v_lshl_add_u32 v15, v12, 7, v15
  v_add_u32 v7, s44, v15
  v_lshlrev_b32 v15, 3, v13
  v_bfe_u32 v3, v2, 2, 2
  v_add_u32 v15, v15, v3
  v_mul_u32_u24 v15, 320, v15
  v_bfe_u32 v3, v2, 4, 1
  v_lshl_add_u32 v15, v3, 5, v15
  v_and_b32 v3, 3, v2
  v_lshl_add_u32 v15, v3, 3, v15
  v_add_u32 v8, 16384, v15
  s_lshl_b32 s45, s41, 2
  s_add_u32 s45, s45, s40
  s_mul_i32 s60, s45, 2560
  s_add_u32 s60, s60, 5244160
  s_sub_u32 s46, s43, 40
  s_lshl_b32 s46, s46, 5
  v_add_u32 v3, s46, v12
  v_mul_u32_u24 v14, 320, v13
  v_add_u32 v15, 0, v3
  v_mul_u32_u24 v1, 3277, v15
  v_lshrrev_b32 v1, 16, v1
  v_mul_u32_u24 v1, 163520, v1
  v_lshl_add_u32 v16, v15, 4, v1
  v_add_u32 v16, v16, v14
  v_add_u32 v15, 32, v3
  v_mul_u32_u24 v1, 3277, v15
  v_lshrrev_b32 v1, 16, v1
  v_mul_u32_u24 v1, 163520, v1
  v_lshl_add_u32 v17, v15, 4, v1
  v_add_u32 v17, v17, v14
  v_add_u32 v15, 64, v3
  v_mul_u32_u24 v1, 3277, v15
  v_lshrrev_b32 v1, 16, v1
  v_mul_u32_u24 v1, 163520, v1
  v_lshl_add_u32 v18, v15, 4, v1
  v_add_u32 v18, v18, v14
  v_add_u32 v15, 96, v3
  v_mul_u32_u24 v1, 3277, v15
  v_lshrrev_b32 v1, 16, v1
  v_mul_u32_u24 v1, 163520, v1
  v_lshl_add_u32 v19, v15, 4, v1
  v_add_u32 v19, v19, v14
  v_add_u32 v15, 128, v3
  v_mul_u32_u24 v1, 3277, v15
  v_lshrrev_b32 v1, 16, v1
  v_mul_u32_u24 v1, 163520, v1
  v_lshl_add_u32 v20, v15, 4, v1
  v_add_u32 v20, v20, v14
  s_mov_b32 s48, 0
  s_barrier
  ds_read_b128 v[24:27], v4
  ds_read_b64_tr_b16 v[28:29], v8 offset:0
  ds_read_b64_tr_b16 v[30:31], v8 offset:1280
  ds_read_b64_tr_b16 v[32:33], v8 offset:64
  ds_read_b64_tr_b16 v[34:35], v8 offset:1344
  ds_read_b64_tr_b16 v[36:37], v8 offset:128
  ds_read_b64_tr_b16 v[38:39], v8 offset:1408
  ds_read_b64_tr_b16 v[40:41], v8 offset:192
  ds_read_b64_tr_b16 v[42:43], v8 offset:1472
  ds_read_b64_tr_b16 v[44:45], v8 offset:256
  ds_read_b64_tr_b16 v[46:47], v8 offset:1536
  s_waitcnt lgkmcnt(8)
  v_mfma_f32_32x32x16_bf16 v[88:103], v[24:27], v[28:31], 0
  ds_read_b128 v[56:59], v5
  ds_read_b64_tr_b16 v[60:61], v8 offset:5120
  ds_read_b64_tr_b16 v[62:63], v8 offset:6400
  s_waitcnt lgkmcnt(9)
  v_mfma_f32_32x32x16_bf16 v[104:119], v[24:27], v[32:35], 0
  ds_read_b64_tr_b16 v[64:65], v8 offset:5184
  ds_read_b64_tr_b16 v[66:67], v8 offset:6464
  s_waitcnt lgkmcnt(9)
  v_mfma_f32_32x32x16_bf16 v[120:135], v[24:27], v[36:39], 0
  ds_read_b64_tr_b16 v[68:69], v8 offset:5248
  ds_read_b64_tr_b16 v[70:71], v8 offset:6528
  s_waitcnt lgkmcnt(9)
  v_mfma_f32_32x32x16_bf16 v[136:151], v[24:27], v[40:43], 0
  ds_read_b64_tr_b16 v[72:73], v8 offset:5312
  ds_read_b64_tr_b16 v[74:75], v8 offset:6592
  s_waitcnt lgkmcnt(9)
  v_mfma_f32_32x32x16_bf16 v[152:167], v[24:27], v[44:47], 0
  ds_read_b64_tr_b16 v[76:77], v8 offset:5376
  ds_read_b64_tr_b16 v[78:79], v8 offset:6656
  s_waitcnt lgkmcnt(8)
  v_mfma_f32_32x32x16_bf16 v[88:103], v[56:59], v[60:63], v[88:103]
  ds_read_b128 v[24:27], v6
  ds_read_b64_tr_b16 v[28:29], v8 offset:10240
  ds_read_b64_tr_b16 v[30:31], v8 offset:11520
  s_waitcnt lgkmcnt(9)
  v_mfma_f32_32x32x16_bf16 v[104:119], v[56:59], v[64:67], v[104:119]
  ds_read_b64_tr_b16 v[32:33], v8 offset:10304
  ds_read_b64_tr_b16 v[34:35], v8 offset:11584
  s_waitcnt lgkmcnt(9)
  v_mfma_f32_32x32x16_bf16 v[120:135], v[56:59], v[68:71], v[120:135]
  ds_read_b64_tr_b16 v[36:37], v8 offset:10368
  ds_read_b64_tr_b16 v[38:39], v8 offset:11648
  s_waitcnt lgkmcnt(9)
  v_mfma_f32_32x32x16_bf16 v[136:151], v[56:59], v[72:75], v[136:151]
  ds_read_b64_tr_b16 v[40:41], v8 offset:10432
  ds_read_b64_tr_b16 v[42:43], v8 offset:11712
  s_waitcnt lgkmcnt(9)
  v_mfma_f32_32x32x16_bf16 v[152:167], v[56:59], v[76:79], v[152:167]
  ds_read_b64_tr_b16 v[44:45], v8 offset:10496
  ds_read_b64_tr_b16 v[46:47], v8 offset:11776
  s_waitcnt lgkmcnt(8)
  v_mfma_f32_32x32x16_bf16 v[88:103], v[24:27], v[28:31], v[88:103]
  ds_read_b128 v[56:59], v7
  ds_read_b64_tr_b16 v[60:61], v8 offset:15360
  ds_read_b64_tr_b16 v[62:63], v8 offset:16640
  s_waitcnt lgkmcnt(9)
  v_mfma_f32_32x32x16_bf16 v[104:119], v[24:27], v[32:35], v[104:119]
  ds_read_b64_tr_b16 v[64:65], v8 offset:15424
  ds_read_b64_tr_b16 v[66:67], v8 offset:16704
  s_waitcnt lgkmcnt(9)
  v_mfma_f32_32x32x16_bf16 v[120:135], v[24:27], v[36:39], v[120:135]
  ds_read_b64_tr_b16 v[68:69], v8 offset:15488
  ds_read_b64_tr_b16 v[70:71], v8 offset:16768
  s_waitcnt lgkmcnt(9)
  v_mfma_f32_32x32x16_bf16 v[136:151], v[24:27], v[40:43], v[136:151]
  ds_read_b64_tr_b16 v[72:73], v8 offset:15552
  ds_read_b64_tr_b16 v[74:75], v8 offset:16832
  s_waitcnt lgkmcnt(9)
  v_mfma_f32_32x32x16_bf16 v[152:167], v[24:27], v[44:47], v[152:167]
  ds_read_b64_tr_b16 v[76:77], v8 offset:15616
  ds_read_b64_tr_b16 v[78:79], v8 offset:16896
  s_waitcnt lgkmcnt(8)
  v_mfma_f32_32x32x16_bf16 v[88:103], v[56:59], v[60:63], v[88:103]
  s_mov_b32 s49, s48
  s_add_u32 s48, s48, 45056
  s_cmp_eq_u32 s48, 135168
  s_cselect_b32 s48, 0, s48
  s_sub_u32 s49, s48, s49
  v_add_u32 v4, s49, v4
  v_add_u32 v5, s49, v5
  v_add_u32 v6, s49, v6
  v_add_u32 v7, s49, v7
  v_add_u32 v8, s49, v8
  s_waitcnt lgkmcnt(6)
  v_mfma_f32_32x32x16_bf16 v[104:119], v[56:59], v[64:67], v[104:119]
  s_waitcnt lgkmcnt(0)
  s_mov_b32 s50, 8
proj_kernel_c_v5_loop_10:
  s_barrier
  ds_read_b128 v[24:27], v4
  ds_read_b64_tr_b16 v[28:29], v8 offset:0
  ds_read_b64_tr_b16 v[30:31], v8 offset:1280
  ds_read_b64_tr_b16 v[32:33], v8 offset:64
  ds_read_b64_tr_b16 v[34:35], v8 offset:1344
  v_mfma_f32_32x32x16_bf16 v[120:135], v[56:59], v[68:71], v[120:135]
  ds_read_b64_tr_b16 v[36:37], v8 offset:128
  ds_read_b64_tr_b16 v[38:39], v8 offset:1408
  v_mfma_f32_32x32x16_bf16 v[136:151], v[56:59], v[72:75], v[136:151]
  ds_read_b64_tr_b16 v[40:41], v8 offset:192
  ds_read_b64_tr_b16 v[42:43], v8 offset:1472
  v_mfma_f32_32x32x16_bf16 v[152:167], v[56:59], v[76:79], v[152:167]
  ds_read_b64_tr_b16 v[44:45], v8 offset:256
  ds_read_b64_tr_b16 v[46:47], v8 offset:1536
  s_waitcnt lgkmcnt(8)
  v_mfma_f32_32x32x16_bf16 v[88:103], v[24:27], v[28:31], v[88:103]
  ds_read_b128 v[56:59], v5
  ds_read_b64_tr_b16 v[60:61], v8 offset:5120
  ds_read_b64_tr_b16 v[62:63], v8 offset:6400
  s_waitcnt lgkmcnt(9)
  v_mfma_f32_32x32x16_bf16 v[104:119], v[24:27], v[32:35], v[104:119]
  ds_read_b64_tr_b16 v[64:65], v8 offset:5184
  ds_read_b64_tr_b16 v[66:67], v8 offset:6464
  s_waitcnt lgkmcnt(9)
  v_mfma_f32_32x32x16_bf16 v[120:135], v[24:27], v[36:39], v[120:135]
  ds_read_b64_tr_b16 v[68:69], v8 offset:5248
  ds_read_b64_tr_b16 v[70:71], v8 offset:6528
  s_waitcnt lgkmcnt(9)
  v_mfma_f32_32x32x16_bf16 v[136:151], v[24:27], v[40:43], v[136:151]
  ds_read_b64_tr_b16 v[72:73], v8 offset:5312
  ds_read_b64_tr_b16 v[74:75], v8 offset:6592
  s_waitcnt lgkmcnt(9)
  v_mfma_f32_32x32x16_bf16 v[152:167], v[24:27], v[44:47], v[152:167]
  ds_read_b64_tr_b16 v[76:77], v8 offset:5376
  ds_read_b64_tr_b16 v[78:79], v8 offset:6656
  s_waitcnt lgkmcnt(8)
  v_mfma_f32_32x32x16_bf16 v[88:103], v[56:59], v[60:63], v[88:103]
  ds_read_b128 v[24:27], v6
  ds_read_b64_tr_b16 v[28:29], v8 offset:10240
  ds_read_b64_tr_b16 v[30:31], v8 offset:11520
  s_waitcnt lgkmcnt(9)
  v_mfma_f32_32x32x16_bf16 v[104:119], v[56:59], v[64:67], v[104:119]
  ds_read_b64_tr_b16 v[32:33], v8 offset:10304
  ds_read_b64_tr_b16 v[34:35], v8 offset:11584
  s_waitcnt lgkmcnt(9)
  v_mfma_f32_32x32x16_bf16 v[120:135], v[56:59], v[68:71], v[120:135]
  ds_read_b64_tr_b16 v[36:37], v8 offset:10368
  ds_read_b64_tr_b16 v[38:39], v8 offset:11648
  s_waitcnt lgkmcnt(9)
  v_mfma_f32_32x32x16_bf16 v[136:151], v[56:59], v[72:75], v[136:151]
  ds_read_b64_tr_b16 v[40:41], v8 offset:10432
  ds_read_b64_tr_b16 v[42:43], v8 offset:11712
  s_waitcnt lgkmcnt(9)
  v_mfma_f32_32x32x16_bf16 v[152:167], v[56:59], v[76:79], v[152:167]
  ds_read_b64_tr_b16 v[44:45], v8 offset:10496
  ds_read_b64_tr_b16 v[46:47], v8 offset:11776
  s_waitcnt lgkmcnt(8)
  v_mfma_f32_32x32x16_bf16 v[88:103], v[24:27], v[28:31], v[88:103]
  ds_read_b128 v[56:59], v7
  ds_read_b64_tr_b16 v[60:61], v8 offset:15360
  ds_read_b64_tr_b16 v[62:63], v8 offset:16640
  s_waitcnt lgkmcnt(9)
  v_mfma_f32_32x32x16_bf16 v[104:119], v[24:27], v[32:35], v[104:119]
  ds_read_b64_tr_b16 v[64:65], v8 offset:15424
  ds_read_b64_tr_b16 v[66:67], v8 offset:16704
  s_waitcnt lgkmcnt(9)
  v_mfma_f32_32x32x16_bf16 v[120:135], v[24:27], v[36:39], v[120:135]
  ds_read_b64_tr_b16 v[68:69], v8 offset:15488
  ds_read_b64_tr_b16 v[70:71], v8 offset:16768
  s_waitcnt lgkmcnt(9)
  v_mfma_f32_32x32x16_bf16 v[136:151], v[24:27], v[40:43], v[136:151]
  ds_read_b64_tr_b16 v[72:73], v8 offset:15552
  ds_read_b64_tr_b16 v[74:75], v8 offset:16832
  s_waitcnt lgkmcnt(9)
  v_mfma_f32_32x32x16_bf16 v[152:167], v[24:27], v[44:47], v[152:167]
  ds_read_b64_tr_b16 v[76:77], v8 offset:15616
  ds_read_b64_tr_b16 v[78:79], v8 offset:16896
  s_waitcnt lgkmcnt(8)
  v_mfma_f32_32x32x16_bf16 v[88:103], v[56:59], v[60:63], v[88:103]
  s_mov_b32 s49, s48
  s_add_u32 s48, s48, 45056
  s_cmp_eq_u32 s48, 135168
  s_cselect_b32 s48, 0, s48
  s_sub_u32 s49, s48, s49
  v_add_u32 v4, s49, v4
  v_add_u32 v5, s49, v5
  v_add_u32 v6, s49, v6
  v_add_u32 v7, s49, v7
  v_add_u32 v8, s49, v8
  s_waitcnt lgkmcnt(6)
  v_mfma_f32_32x32x16_bf16 v[104:119], v[56:59], v[64:67], v[104:119]
  s_waitcnt lgkmcnt(0)
  s_sub_u32 s50, s50, 1
  s_cmp_lg_u32 s50, 0
  s_cbranch_scc1 proj_kernel_c_v5_loop_10
  s_barrier
  ds_read_b128 v[24:27], v4
  ds_read_b128 v[28:31], v5
  ds_read_b128 v[32:35], v6
  ds_read_b128 v[36:39], v7
  ds_read_b64_tr_b16 v[40:41], v8 offset:0
  v_mfma_f32_32x32x16_bf16 v[120:135], v[56:59], v[68:71], v[120:135]
  ds_read_b64_tr_b16 v[42:43], v8 offset:1280
  ds_read_b64_tr_b16 v[44:45], v8 offset:5120
  ds_read_b64_tr_b16 v[46:47], v8 offset:6400
  ds_read_b64_tr_b16 v[48:49], v8 offset:10240
  ds_read_b64_tr_b16 v[50:51], v8 offset:11520
  v_mfma_f32_32x32x16_bf16 v[136:151], v[56:59], v[72:75], v[136:151]
  ds_read_b64_tr_b16 v[52:53], v8 offset:15360
  ds_read_b64_tr_b16 v[54:55], v8 offset:16640
  ds_read_b64_tr_b16 v[204:205], v8 offset:64
  ds_read_b64_tr_b16 v[206:207], v8 offset:1344
  ds_read_b64_tr_b16 v[208:209], v8 offset:5184
  v_mfma_f32_32x32x16_bf16 v[152:167], v[56:59], v[76:79], v[152:167]
  ds_read_b64_tr_b16 v[210:211], v8 offset:6464
  ds_read_b64_tr_b16 v[212:213], v8 offset:10304
  ds_read_b64_tr_b16 v[214:215], v8 offset:11584
  ds_read_b64_tr_b16 v[216:217], v8 offset:15424
  ds_read_b64_tr_b16 v[218:219], v8 offset:16704
  s_waitcnt lgkmcnt(8)
  v_mfma_f32_32x32x16_bf16 v[88:103], v[24:27], v[40:43], v[88:103]
  v_mfma_f32_32x32x16_bf16 v[88:103], v[28:31], v[44:47], v[88:103]
  ds_read_b64_tr_b16 v[220:221], v8 offset:128
  ds_read_b64_tr_b16 v[222:223], v8 offset:1408
  ds_read_b64_tr_b16 v[224:225], v8 offset:5248
  v_mfma_f32_32x32x16_bf16 v[88:103], v[32:35], v[48:51], v[88:103]
  ds_read_b64_tr_b16 v[226:227], v8 offset:6528
  ds_read_b64_tr_b16 v[228:229], v8 offset:10368
  ds_read_b64_tr_b16 v[230:231], v8 offset:11648
  v_mfma_f32_32x32x16_bf16 v[88:103], v[36:39], v[52:55], v[88:103]
  ds_read_b64_tr_b16 v[232:233], v8 offset:15488
  ds_read_b64_tr_b16 v[234:235], v8 offset:16768
  s_waitcnt lgkmcnt(8)
  v_mfma_f32_32x32x16_bf16 v[104:119], v[24:27], v[204:207], v[104:119]
  v_mfma_f32_32x32x16_bf16 v[104:119], v[28:31], v[208:211], v[104:119]
  ds_read_b64_tr_b16 v[40:41], v8 offset:192
  ds_read_b64_tr_b16 v[42:43], v8 offset:1472
  ds_read_b64_tr_b16 v[44:45], v8 offset:5312
  v_mfma_f32_32x32x16_bf16 v[104:119], v[32:35], v[212:215], v[104:119]
  ds_read_b64_tr_b16 v[46:47], v8 offset:6592
  ds_read_b64_tr_b16 v[48:49], v8 offset:10432
  ds_read_b64_tr_b16 v[50:51], v8 offset:11712
  v_mfma_f32_32x32x16_bf16 v[104:119], v[36:39], v[216:219], v[104:119]
  ds_read_b64_tr_b16 v[52:53], v8 offset:15552
  ds_read_b64_tr_b16 v[54:55], v8 offset:16832
  v_cvt_pk_bf16_f32 v88, v88, v89
  v_cvt_pk_bf16_f32 v89, v90, v91
  v_cvt_pk_bf16_f32 v90, v92, v93
  v_cvt_pk_bf16_f32 v91, v94, v95
  v_cvt_pk_bf16_f32 v96, v96, v97
  v_cvt_pk_bf16_f32 v97, v98, v99
  v_cvt_pk_bf16_f32 v98, v100, v101
  v_cvt_pk_bf16_f32 v99, v102, v103
  buffer_store_dwordx4 v[88:91], v16, s[36:39], s60 offen offset:0 sc1
  buffer_store_dwordx4 v[96:99], v16, s[36:39], s60 offen offset:640 sc1
  s_waitcnt lgkmcnt(8)
  v_mfma_f32_32x32x16_bf16 v[120:135], v[24:27], v[220:223], v[120:135]
  v_mfma_f32_32x32x16_bf16 v[120:135], v[28:31], v[224:227], v[120:135]
  ds_read_b64_tr_b16 v[204:205], v8 offset:256
  ds_read_b64_tr_b16 v[206:207], v8 offset:1536
  ds_read_b64_tr_b16 v[208:209], v8 offset:5376
  v_mfma_f32_32x32x16_bf16 v[120:135], v[32:35], v[228:231], v[120:135]
  ds_read_b64_tr_b16 v[210:211], v8 offset:6656
  ds_read_b64_tr_b16 v[212:213], v8 offset:10496
  ds_read_b64_tr_b16 v[214:215], v8 offset:11776
  v_mfma_f32_32x32x16_bf16 v[120:135], v[36:39], v[232:235], v[120:135]
  ds_read_b64_tr_b16 v[216:217], v8 offset:15616
  ds_read_b64_tr_b16 v[218:219], v8 offset:16896
  v_cvt_pk_bf16_f32 v104, v104, v105
  v_cvt_pk_bf16_f32 v105, v106, v107
  v_cvt_pk_bf16_f32 v106, v108, v109
  v_cvt_pk_bf16_f32 v107, v110, v111
  v_cvt_pk_bf16_f32 v112, v112, v113
  v_cvt_pk_bf16_f32 v113, v114, v115
  v_cvt_pk_bf16_f32 v114, v116, v117
  v_cvt_pk_bf16_f32 v115, v118, v119
  buffer_store_dwordx4 v[104:107], v17, s[36:39], s60 offen offset:0 sc1
  buffer_store_dwordx4 v[112:115], v17, s[36:39], s60 offen offset:640 sc1
  s_waitcnt lgkmcnt(8)
  v_mfma_f32_32x32x16_bf16 v[136:151], v[24:27], v[40:43], v[136:151]
  v_mfma_f32_32x32x16_bf16 v[136:151], v[28:31], v[44:47], v[136:151]
  v_mfma_f32_32x32x16_bf16 v[136:151], v[32:35], v[48:51], v[136:151]
  v_mfma_f32_32x32x16_bf16 v[136:151], v[36:39], v[52:55], v[136:151]
  s_nop 7
  v_cvt_pk_bf16_f32 v120, v120, v121
  v_cvt_pk_bf16_f32 v121, v122, v123
  v_cvt_pk_bf16_f32 v122, v124, v125
  v_cvt_pk_bf16_f32 v123, v126, v127
  v_cvt_pk_bf16_f32 v128, v128, v129
  v_cvt_pk_bf16_f32 v129, v130, v131
  v_cvt_pk_bf16_f32 v130, v132, v133
  v_cvt_pk_bf16_f32 v131, v134, v135
  buffer_store_dwordx4 v[120:123], v18, s[36:39], s60 offen offset:0 sc1
  buffer_store_dwordx4 v[128:131], v18, s[36:39], s60 offen offset:640 sc1
  s_waitcnt lgkmcnt(0)
  v_mfma_f32_32x32x16_bf16 v[152:167], v[24:27], v[204:207], v[152:167]
  v_mfma_f32_32x32x16_bf16 v[152:167], v[28:31], v[208:211], v[152:167]
  v_mfma_f32_32x32x16_bf16 v[152:167], v[32:35], v[212:215], v[152:167]
  v_mfma_f32_32x32x16_bf16 v[152:167], v[36:39], v[216:219], v[152:167]
  s_nop 7
  v_cvt_pk_bf16_f32 v136, v136, v137
  v_cvt_pk_bf16_f32 v137, v138, v139
  v_cvt_pk_bf16_f32 v138, v140, v141
  v_cvt_pk_bf16_f32 v139, v142, v143
  v_cvt_pk_bf16_f32 v144, v144, v145
  v_cvt_pk_bf16_f32 v145, v146, v147
  v_cvt_pk_bf16_f32 v146, v148, v149
  v_cvt_pk_bf16_f32 v147, v150, v151
  buffer_store_dwordx4 v[136:139], v19, s[36:39], s60 offen offset:0 sc1
  buffer_store_dwordx4 v[144:147], v19, s[36:39], s60 offen offset:640 sc1
  s_nop 3
  v_cvt_pk_bf16_f32 v152, v152, v153
  v_cvt_pk_bf16_f32 v153, v154, v155
  v_cvt_pk_bf16_f32 v154, v156, v157
  v_cvt_pk_bf16_f32 v155, v158, v159
  v_cvt_pk_bf16_f32 v160, v160, v161
  v_cvt_pk_bf16_f32 v161, v162, v163
  v_cvt_pk_bf16_f32 v162, v164, v165
  v_cvt_pk_bf16_f32 v163, v166, v167
  buffer_store_dwordx4 v[152:155], v20, s[36:39], s60 offen offset:0 sc1
  buffer_store_dwordx4 v[160:163], v20, s[36:39], s60 offen offset:640 sc1
  s_branch proj_kernel_end
proj_kernel_c_ab7:
  v_and_b32 v12, 31, v2
  v_lshrrev_b32 v13, 5, v2
  v_lshrrev_b32 v14, 1, v12
  v_and_b32 v14, 7, v14
  s_lshl_b32 s44, s40, 12
  v_add_u32 v15, 0, v13
  v_xor_b32 v15, v15, v14
  v_lshlrev_b32 v15, 4, v15
  v_lshl_add_u32 v15, v12, 7, v15
  v_add_u32 v4, s44, v15
  v_add_u32 v8, 16384, v15
  v_add_u32 v15, 2, v13
  v_xor_b32 v15, v15, v14
  v_lshlrev_b32 v15, 4, v15
  v_lshl_add_u32 v15, v12, 7, v15
  v_add_u32 v5, s44, v15
  v_add_u32 v9, 16384, v15
  v_add_u32 v15, 4, v13
  v_xor_b32 v15, v15, v14
  v_lshlrev_b32 v15, 4, v15
  v_lshl_add_u32 v15, v12, 7, v15
  v_add_u32 v6, s44, v15
  v_add_u32 v10, 16384, v15
  v_add_u32 v15, 6, v13
  v_xor_b32 v15, v15, v14
  v_lshlrev_b32 v15, 4, v15
  v_lshl_add_u32 v15, v12, 7, v15
  v_add_u32 v7, s44, v15
  v_add_u32 v11, 16384, v15
  s_lshl_b32 s45, s41, 2
  s_add_u32 s45, s45, s40
  s_lshl_b32 s46, s55, 6
  s_add_u32 s46, s46, s45
  s_mul_i32 s60, s46, 5120
  s_add_u32 s60, s60, 10485760
  s_lshl_b32 s47, s43, 1
  v_lshrrev_b32 v3, 4, v12
  v_add_u32 v3, s47, v3
  v_and_b32 v14, 15, v12
  v_lshlrev_b32 v14, 4, v14
  v_lshl_add_u32 v14, v13, 8, v14
  v_add_u32 v15, 0, v3
  v_mul_u32_u24 v1, 205, v15
  v_lshrrev_b32 v1, 10, v1
  v_mul_u32_u24 v1, 650240, v1
  v_lshl_add_u32 v16, v15, 10, v1
  v_add_u32 v16, v16, v14
  v_add_u32 v15, 2, v3
  v_mul_u32_u24 v1, 205, v15
  v_lshrrev_b32 v1, 10, v1
  v_mul_u32_u24 v1, 650240, v1
  v_lshl_add_u32 v17, v15, 10, v1
  v_add_u32 v17, v17, v14
  v_add_u32 v15, 4, v3
  v_mul_u32_u24 v1, 205, v15
  v_lshrrev_b32 v1, 10, v1
  v_mul_u32_u24 v1, 650240, v1
  v_lshl_add_u32 v18, v15, 10, v1
  v_add_u32 v18, v18, v14
  v_add_u32 v15, 6, v3
  v_mul_u32_u24 v1, 205, v15
  v_lshrrev_b32 v1, 10, v1
  v_mul_u32_u24 v1, 650240, v1
  v_lshl_add_u32 v19, v15, 10, v1
  v_add_u32 v19, v19, v14
  v_add_u32 v15, 8, v3
  v_mul_u32_u24 v1, 205, v15
  v_lshrrev_b32 v1, 10, v1
  v_mul_u32_u24 v1, 650240, v1
  v_lshl_add_u32 v20, v15, 10, v1
  v_add_u32 v20, v20, v14
  v_add_u32 v15, 10, v3
  v_mul_u32_u24 v1, 205, v15
  v_lshrrev_b32 v1, 10, v1
  v_mul_u32_u24 v1, 650240, v1
  v_lshl_add_u32 v21, v15, 10, v1
  v_add_u32 v21, v21, v14
  v_add_u32 v15, 12, v3
  v_mul_u32_u24 v1, 205, v15
  v_lshrrev_b32 v1, 10, v1
  v_mul_u32_u24 v1, 650240, v1
  v_lshl_add_u32 v22, v15, 10, v1
  v_add_u32 v22, v22, v14
  s_mov_b32 s48, 0
  s_barrier
  ds_read_b128 v[24:27], v4
  ds_read_b128 v[28:31], v8 offset:0
  ds_read_b128 v[32:35], v8 offset:4096
  ds_read_b128 v[36:39], v8 offset:8192
  ds_read_b128 v[40:43], v8 offset:12288
  ds_read_b128 v[44:47], v8 offset:16384
  ds_read_b128 v[48:51], v8 offset:20480
  ds_read_b128 v[52:55], v8 offset:24576
  s_waitcnt lgkmcnt(6)
  v_mfma_f32_32x32x16_bf16 v[88:103], v[24:27], v[28:31], 0
  ds_read_b128 v[56:59], v5
  ds_read_b128 v[60:63], v9 offset:0
  s_waitcnt lgkmcnt(7)
  v_mfma_f32_32x32x16_bf16 v[104:119], v[24:27], v[32:35], 0
  ds_read_b128 v[64:67], v9 offset:4096
  s_waitcnt lgkmcnt(7)
  v_mfma_f32_32x32x16_bf16 v[120:135], v[24:27], v[36:39], 0
  ds_read_b128 v[68:71], v9 offset:8192
  s_waitcnt lgkmcnt(7)
  v_mfma_f32_32x32x16_bf16 v[136:151], v[24:27], v[40:43], 0
  ds_read_b128 v[72:75], v9 offset:12288
  s_waitcnt lgkmcnt(7)
  v_mfma_f32_32x32x16_bf16 v[152:167], v[24:27], v[44:47], 0
  ds_read_b128 v[76:79], v9 offset:16384
  s_waitcnt lgkmcnt(7)
  v_mfma_f32_32x32x16_bf16 v[168:183], v[24:27], v[48:51], 0
  ds_read_b128 v[80:83], v9 offset:20480
  s_waitcnt lgkmcnt(7)
  v_mfma_f32_32x32x16_bf16 v[184:199], v[24:27], v[52:55], 0
  ds_read_b128 v[84:87], v9 offset:24576
  s_waitcnt lgkmcnt(6)
  v_mfma_f32_32x32x16_bf16 v[88:103], v[56:59], v[60:63], v[88:103]
  ds_read_b128 v[24:27], v6
  ds_read_b128 v[28:31], v10 offset:0
  s_waitcnt lgkmcnt(7)
  v_mfma_f32_32x32x16_bf16 v[104:119], v[56:59], v[64:67], v[104:119]
  ds_read_b128 v[32:35], v10 offset:4096
  s_waitcnt lgkmcnt(7)
  v_mfma_f32_32x32x16_bf16 v[120:135], v[56:59], v[68:71], v[120:135]
  ds_read_b128 v[36:39], v10 offset:8192
  s_waitcnt lgkmcnt(7)
  v_mfma_f32_32x32x16_bf16 v[136:151], v[56:59], v[72:75], v[136:151]
  ds_read_b128 v[40:43], v10 offset:12288
  s_waitcnt lgkmcnt(7)
  v_mfma_f32_32x32x16_bf16 v[152:167], v[56:59], v[76:79], v[152:167]
  ds_read_b128 v[44:47], v10 offset:16384
  s_waitcnt lgkmcnt(7)
  v_mfma_f32_32x32x16_bf16 v[168:183], v[56:59], v[80:83], v[168:183]
  ds_read_b128 v[48:51], v10 offset:20480
  s_waitcnt lgkmcnt(7)
  v_mfma_f32_32x32x16_bf16 v[184:199], v[56:59], v[84:87], v[184:199]
  ds_read_b128 v[52:55], v10 offset:24576
  s_waitcnt lgkmcnt(6)
  v_mfma_f32_32x32x16_bf16 v[88:103], v[24:27], v[28:31], v[88:103]
  ds_read_b128 v[56:59], v7
  ds_read_b128 v[60:63], v11 offset:0
  s_waitcnt lgkmcnt(7)
  v_mfma_f32_32x32x16_bf16 v[104:119], v[24:27], v[32:35], v[104:119]
  ds_read_b128 v[64:67], v11 offset:4096
  s_waitcnt lgkmcnt(7)
  v_mfma_f32_32x32x16_bf16 v[120:135], v[24:27], v[36:39], v[120:135]
  ds_read_b128 v[68:71], v11 offset:8192
  s_waitcnt lgkmcnt(7)
  v_mfma_f32_32x32x16_bf16 v[136:151], v[24:27], v[40:43], v[136:151]
  ds_read_b128 v[72:75], v11 offset:12288
  s_waitcnt lgkmcnt(7)
  v_mfma_f32_32x32x16_bf16 v[152:167], v[24:27], v[44:47], v[152:167]
  ds_read_b128 v[76:79], v11 offset:16384
  s_waitcnt lgkmcnt(7)
  v_mfma_f32_32x32x16_bf16 v[168:183], v[24:27], v[48:51], v[168:183]
  ds_read_b128 v[80:83], v11 offset:20480
  s_waitcnt lgkmcnt(7)
  v_mfma_f32_32x32x16_bf16 v[184:199], v[24:27], v[52:55], v[184:199]
  ds_read_b128 v[84:87], v11 offset:24576
  s_waitcnt lgkmcnt(6)
  v_mfma_f32_32x32x16_bf16 v[88:103], v[56:59], v[60:63], v[88:103]
  s_mov_b32 s49, s48
  s_add_u32 s48, s48, 45056
  s_cmp_eq_u32 s48, 135168
  s_cselect_b32 s48, 0, s48
  s_sub_u32 s49, s48, s49
  v_add_u32 v4, s49, v4
  v_add_u32 v5, s49, v5
  v_add_u32 v6, s49, v6
  v_add_u32 v7, s49, v7
  v_add_u32 v8, s49, v8
  v_add_u32 v9, s49, v9
  v_add_u32 v10, s49, v10
  v_add_u32 v11, s49, v11
  s_waitcnt lgkmcnt(5)
  v_mfma_f32_32x32x16_bf16 v[104:119], v[56:59], v[64:67], v[104:119]
  s_waitcnt lgkmcnt(0)
  s_mov_b32 s50, 8
proj_kernel_c_ab7_loop_11:
  s_barrier
  ds_read_b128 v[24:27], v4
  ds_read_b128 v[28:31], v8 offset:0
  ds_read_b128 v[32:35], v8 offset:4096
  v_mfma_f32_32x32x16_bf16 v[120:135], v[56:59], v[68:71], v[120:135]
  ds_read_b128 v[36:39], v8 offset:8192
  v_mfma_f32_32x32x16_bf16 v[136:151], v[56:59], v[72:75], v[136:151]
  ds_read_b128 v[40:43], v8 offset:12288
  v_mfma_f32_32x32x16_bf16 v[152:167], v[56:59], v[76:79], v[152:167]
  ds_read_b128 v[44:47], v8 offset:16384
  v_mfma_f32_32x32x16_bf16 v[168:183], v[56:59], v[80:83], v[168:183]
  ds_read_b128 v[48:51], v8 offset:20480
  v_mfma_f32_32x32x16_bf16 v[184:199], v[56:59], v[84:87], v[184:199]
  ds_read_b128 v[52:55], v8 offset:24576
  s_waitcnt lgkmcnt(6)
  v_mfma_f32_32x32x16_bf16 v[88:103], v[24:27], v[28:31], v[88:103]
  ds_read_b128 v[56:59], v5
  ds_read_b128 v[60:63], v9 offset:0
  s_waitcnt lgkmcnt(7)
  v_mfma_f32_32x32x16_bf16 v[104:119], v[24:27], v[32:35], v[104:119]
  ds_read_b128 v[64:67], v9 offset:4096
  s_waitcnt lgkmcnt(7)
  v_mfma_f32_32x32x16_bf16 v[120:135], v[24:27], v[36:39], v[120:135]
  ds_read_b128 v[68:71], v9 offset:8192
  s_waitcnt lgkmcnt(7)
  v_mfma_f32_32x32x16_bf16 v[136:151], v[24:27], v[40:43], v[136:151]
  ds_read_b128 v[72:75], v9 offset:12288
  s_waitcnt lgkmcnt(7)
  v_mfma_f32_32x32x16_bf16 v[152:167], v[24:27], v[44:47], v[152:167]
  ds_read_b128 v[76:79], v9 offset:16384
  s_waitcnt lgkmcnt(7)
  v_mfma_f32_32x32x16_bf16 v[168:183], v[24:27], v[48:51], v[168:183]
  ds_read_b128 v[80:83], v9 offset:20480
  s_waitcnt lgkmcnt(7)
  v_mfma_f32_32x32x16_bf16 v[184:199], v[24:27], v[52:55], v[184:199]
  ds_read_b128 v[84:87], v9 offset:24576
  s_waitcnt lgkmcnt(6)
  v_mfma_f32_32x32x16_bf16 v[88:103], v[56:59], v[60:63], v[88:103]
  ds_read_b128 v[24:27], v6
  ds_read_b128 v[28:31], v10 offset:0
  s_waitcnt lgkmcnt(7)
  v_mfma_f32_32x32x16_bf16 v[104:119], v[56:59], v[64:67], v[104:119]
  ds_read_b128 v[32:35], v10 offset:4096
  s_waitcnt lgkmcnt(7)
  v_mfma_f32_32x32x16_bf16 v[120:135], v[56:59], v[68:71], v[120:135]
  ds_read_b128 v[36:39], v10 offset:8192
  s_waitcnt lgkmcnt(7)
  v_mfma_f32_32x32x16_bf16 v[136:151], v[56:59], v[72:75], v[136:151]
  ds_read_b128 v[40:43], v10 offset:12288
  s_waitcnt lgkmcnt(7)
  v_mfma_f32_32x32x16_bf16 v[152:167], v[56:59], v[76:79], v[152:167]
  ds_read_b128 v[44:47], v10 offset:16384
  s_waitcnt lgkmcnt(7)
  v_mfma_f32_32x32x16_bf16 v[168:183], v[56:59], v[80:83], v[168:183]
  ds_read_b128 v[48:51], v10 offset:20480
  s_waitcnt lgkmcnt(7)
  v_mfma_f32_32x32x16_bf16 v[184:199], v[56:59], v[84:87], v[184:199]
  ds_read_b128 v[52:55], v10 offset:24576
  s_waitcnt lgkmcnt(6)
  v_mfma_f32_32x32x16_bf16 v[88:103], v[24:27], v[28:31], v[88:103]
  ds_read_b128 v[56:59], v7
  ds_read_b128 v[60:63], v11 offset:0
  s_waitcnt lgkmcnt(7)
  v_mfma_f32_32x32x16_bf16 v[104:119], v[24:27], v[32:35], v[104:119]
  ds_read_b128 v[64:67], v11 offset:4096
  s_waitcnt lgkmcnt(7)
  v_mfma_f32_32x32x16_bf16 v[120:135], v[24:27], v[36:39], v[120:135]
  ds_read_b128 v[68:71], v11 offset:8192
  s_waitcnt lgkmcnt(7)
  v_mfma_f32_32x32x16_bf16 v[136:151], v[24:27], v[40:43], v[136:151]
  ds_read_b128 v[72:75], v11 offset:12288
  s_waitcnt lgkmcnt(7)
  v_mfma_f32_32x32x16_bf16 v[152:167], v[24:27], v[44:47], v[152:167]
  ds_read_b128 v[76:79], v11 offset:16384
  s_waitcnt lgkmcnt(7)
  v_mfma_f32_32x32x16_bf16 v[168:183], v[24:27], v[48:51], v[168:183]
  ds_read_b128 v[80:83], v11 offset:20480
  s_waitcnt lgkmcnt(7)
  v_mfma_f32_32x32x16_bf16 v[184:199], v[24:27], v[52:55], v[184:199]
  ds_read_b128 v[84:87], v11 offset:24576
  s_waitcnt lgkmcnt(6)
  v_mfma_f32_32x32x16_bf16 v[88:103], v[56:59], v[60:63], v[88:103]
  s_mov_b32 s49, s48
  s_add_u32 s48, s48, 45056
  s_cmp_eq_u32 s48, 135168
  s_cselect_b32 s48, 0, s48
  s_sub_u32 s49, s48, s49
  v_add_u32 v4, s49, v4
  v_add_u32 v5, s49, v5
  v_add_u32 v6, s49, v6
  v_add_u32 v7, s49, v7
  v_add_u32 v8, s49, v8
  v_add_u32 v9, s49, v9
  v_add_u32 v10, s49, v10
  v_add_u32 v11, s49, v11
  s_waitcnt lgkmcnt(5)
  v_mfma_f32_32x32x16_bf16 v[104:119], v[56:59], v[64:67], v[104:119]
  s_waitcnt lgkmcnt(0)
  s_sub_u32 s50, s50, 1
  s_cmp_lg_u32 s50, 0
  s_cbranch_scc1 proj_kernel_c_ab7_loop_11
  s_barrier
  ds_read_b128 v[24:27], v4
  ds_read_b128 v[28:31], v5
  v_mfma_f32_32x32x16_bf16 v[120:135], v[56:59], v[68:71], v[120:135]
  ds_read_b128 v[32:35], v6
  ds_read_b128 v[36:39], v7
  v_mfma_f32_32x32x16_bf16 v[136:151], v[56:59], v[72:75], v[136:151]
  ds_read_b128 v[40:43], v8 offset:0
  ds_read_b128 v[44:47], v9 offset:0
  v_mfma_f32_32x32x16_bf16 v[152:167], v[56:59], v[76:79], v[152:167]
  ds_read_b128 v[48:51], v10 offset:0
  ds_read_b128 v[52:55], v11 offset:0
  v_mfma_f32_32x32x16_bf16 v[168:183], v[56:59], v[80:83], v[168:183]
  ds_read_b128 v[204:207], v8 offset:4096
  ds_read_b128 v[208:211], v9 offset:4096
  v_mfma_f32_32x32x16_bf16 v[184:199], v[56:59], v[84:87], v[184:199]
  ds_read_b128 v[212:215], v10 offset:4096
  ds_read_b128 v[216:219], v11 offset:4096
  s_waitcnt lgkmcnt(4)
  v_mfma_f32_32x32x16_bf16 v[88:103], v[24:27], v[40:43], v[88:103]
  v_mfma_f32_32x32x16_bf16 v[88:103], v[28:31], v[44:47], v[88:103]
  ds_read_b128 v[220:223], v8 offset:8192
  ds_read_b128 v[224:227], v9 offset:8192
  v_mfma_f32_32x32x16_bf16 v[88:103], v[32:35], v[48:51], v[88:103]
  ds_read_b128 v[228:231], v10 offset:8192
  ds_read_b128 v[232:235], v11 offset:8192
  v_mfma_f32_32x32x16_bf16 v[88:103], v[36:39], v[52:55], v[88:103]
  s_waitcnt lgkmcnt(4)
  v_mfma_f32_32x32x16_bf16 v[104:119], v[24:27], v[204:207], v[104:119]
  v_mfma_f32_32x32x16_bf16 v[104:119], v[28:31], v[208:211], v[104:119]
  ds_read_b128 v[40:43], v8 offset:12288
  ds_read_b128 v[44:47], v9 offset:12288
  v_mfma_f32_32x32x16_bf16 v[104:119], v[32:35], v[212:215], v[104:119]
  ds_read_b128 v[48:51], v10 offset:12288
  ds_read_b128 v[52:55], v11 offset:12288
  v_mfma_f32_32x32x16_bf16 v[104:119], v[36:39], v[216:219], v[104:119]
  s_nop 3
  v_cvt_pk_bf16_f32 v88, v88, v89
  v_cvt_pk_bf16_f32 v89, v90, v91
  v_cvt_pk_bf16_f32 v90, v92, v93
  v_cvt_pk_bf16_f32 v91, v94, v95
  v_cvt_pk_bf16_f32 v96, v96, v97
  v_cvt_pk_bf16_f32 v97, v98, v99
  v_cvt_pk_bf16_f32 v98, v100, v101
  v_cvt_pk_bf16_f32 v99, v102, v103
  v_permlane32_swap_b32 v88, v90
  v_permlane32_swap_b32 v89, v91
  buffer_store_dwordx4 v[88:91], v16, s[36:39], s60 offen offset:0 sc1
  v_permlane32_swap_b32 v96, v98
  v_permlane32_swap_b32 v97, v99
  buffer_store_dwordx4 v[96:99], v16, s[36:39], s60 offen offset:512 sc1
  s_waitcnt lgkmcnt(4)
  v_mfma_f32_32x32x16_bf16 v[120:135], v[24:27], v[220:223], v[120:135]
  v_mfma_f32_32x32x16_bf16 v[120:135], v[28:31], v[224:227], v[120:135]
  ds_read_b128 v[204:207], v8 offset:16384
  ds_read_b128 v[208:211], v9 offset:16384
  v_mfma_f32_32x32x16_bf16 v[120:135], v[32:35], v[228:231], v[120:135]
  ds_read_b128 v[212:215], v10 offset:16384
  ds_read_b128 v[216:219], v11 offset:16384
  v_mfma_f32_32x32x16_bf16 v[120:135], v[36:39], v[232:235], v[120:135]
  s_nop 3
  v_cvt_pk_bf16_f32 v104, v104, v105
  v_cvt_pk_bf16_f32 v105, v106, v107
  v_cvt_pk_bf16_f32 v106, v108, v109
  v_cvt_pk_bf16_f32 v107, v110, v111
  v_cvt_pk_bf16_f32 v112, v112, v113
  v_cvt_pk_bf16_f32 v113, v114, v115
  v_cvt_pk_bf16_f32 v114, v116, v117
  v_cvt_pk_bf16_f32 v115, v118, v119
  v_permlane32_swap_b32 v104, v106
  v_permlane32_swap_b32 v105, v107
  buffer_store_dwordx4 v[104:107], v17, s[36:39], s60 offen offset:0 sc1
  v_permlane32_swap_b32 v112, v114
  v_permlane32_swap_b32 v113, v115
  buffer_store_dwordx4 v[112:115], v17, s[36:39], s60 offen offset:512 sc1
  s_waitcnt lgkmcnt(4)
  v_mfma_f32_32x32x16_bf16 v[136:151], v[24:27], v[40:43], v[136:151]
  v_mfma_f32_32x32x16_bf16 v[136:151], v[28:31], v[44:47], v[136:151]
  ds_read_b128 v[220:223], v8 offset:20480
  ds_read_b128 v[224:227], v9 offset:20480
  v_mfma_f32_32x32x16_bf16 v[136:151], v[32:35], v[48:51], v[136:151]
  ds_read_b128 v[228:231], v10 offset:20480
  ds_read_b128 v[232:235], v11 offset:20480
  v_mfma_f32_32x32x16_bf16 v[136:151], v[36:39], v[52:55], v[136:151]
  s_nop 3
  v_cvt_pk_bf16_f32 v120, v120, v121
  v_cvt_pk_bf16_f32 v121, v122, v123
  v_cvt_pk_bf16_f32 v122, v124, v125
  v_cvt_pk_bf16_f32 v123, v126, v127
  v_cvt_pk_bf16_f32 v128, v128, v129
  v_cvt_pk_bf16_f32 v129, v130, v131
  v_cvt_pk_bf16_f32 v130, v132, v133
  v_cvt_pk_bf16_f32 v131, v134, v135
  v_permlane32_swap_b32 v120, v122
  v_permlane32_swap_b32 v121, v123
  buffer_store_dwordx4 v[120:123], v18, s[36:39], s60 offen offset:0 sc1
  v_permlane32_swap_b32 v128, v130
  v_permlane32_swap_b32 v129, v131
  buffer_store_dwordx4 v[128:131], v18, s[36:39], s60 offen offset:512 sc1
  s_waitcnt lgkmcnt(4)
  v_mfma_f32_32x32x16_bf16 v[152:167], v[24:27], v[204:207], v[152:167]
  v_mfma_f32_32x32x16_bf16 v[152:167], v[28:31], v[208:211], v[152:167]
  ds_read_b128 v[40:43], v8 offset:24576
  ds_read_b128 v[44:47], v9 offset:24576
  v_mfma_f32_32x32x16_bf16 v[152:167], v[32:35], v[212:215], v[152:167]
  ds_read_b128 v[48:51], v10 offset:24576
  ds_read_b128 v[52:55], v11 offset:24576
  v_mfma_f32_32x32x16_bf16 v[152:167], v[36:39], v[216:219], v[152:167]
  s_nop 3
  v_cvt_pk_bf16_f32 v136, v136, v137
  v_cvt_pk_bf16_f32 v137, v138, v139
  v_cvt_pk_bf16_f32 v138, v140, v141
  v_cvt_pk_bf16_f32 v139, v142, v143
  v_cvt_pk_bf16_f32 v144, v144, v145
  v_cvt_pk_bf16_f32 v145, v146, v147
  v_cvt_pk_bf16_f32 v146, v148, v149
  v_cvt_pk_bf16_f32 v147, v150, v151
  v_permlane32_swap_b32 v136, v138
  v_permlane32_swap_b32 v137, v139
  buffer_store_dwordx4 v[136:139], v19, s[36:39], s60 offen offset:0 sc1
  v_permlane32_swap_b32 v144, v146
  v_permlane32_swap_b32 v145, v147
  buffer_store_dwordx4 v[144:147], v19, s[36:39], s60 offen offset:512 sc1
  s_waitcnt lgkmcnt(4)
  v_mfma_f32_32x32x16_bf16 v[168:183], v[24:27], v[220:223], v[168:183]
  v_mfma_f32_32x32x16_bf16 v[168:183], v[28:31], v[224:227], v[168:183]
  v_mfma_f32_32x32x16_bf16 v[168:183], v[32:35], v[228:231], v[168:183]
  v_mfma_f32_32x32x16_bf16 v[168:183], v[36:39], v[232:235], v[168:183]
  s_nop 7
  v_cvt_pk_bf16_f32 v152, v152, v153
  v_cvt_pk_bf16_f32 v153, v154, v155
  v_cvt_pk_bf16_f32 v154, v156, v157
  v_cvt_pk_bf16_f32 v155, v158, v159
  v_cvt_pk_bf16_f32 v160, v160, v161
  v_cvt_pk_bf16_f32 v161, v162, v163
  v_cvt_pk_bf16_f32 v162, v164, v165
  v_cvt_pk_bf16_f32 v163, v166, v167
  v_permlane32_swap_b32 v152, v154
  v_permlane32_swap_b32 v153, v155
  buffer_store_dwordx4 v[152:155], v20, s[36:39], s60 offen offset:0 sc1
  v_permlane32_swap_b32 v160, v162
  v_permlane32_swap_b32 v161, v163
  buffer_store_dwordx4 v[160:163], v20, s[36:39], s60 offen offset:512 sc1
  s_waitcnt lgkmcnt(0)
  v_mfma_f32_32x32x16_bf16 v[184:199], v[24:27], v[40:43], v[184:199]
  v_mfma_f32_32x32x16_bf16 v[184:199], v[28:31], v[44:47], v[184:199]
  v_mfma_f32_32x32x16_bf16 v[184:199], v[32:35], v[48:51], v[184:199]
  v_mfma_f32_32x32x16_bf16 v[184:199], v[36:39], v[52:55], v[184:199]
  s_nop 7
  v_cvt_pk_bf16_f32 v168, v168, v169
  v_cvt_pk_bf16_f32 v169, v170, v171
  v_cvt_pk_bf16_f32 v170, v172, v173
  v_cvt_pk_bf16_f32 v171, v174, v175
  v_cvt_pk_bf16_f32 v176, v176, v177
  v_cvt_pk_bf16_f32 v177, v178, v179
  v_cvt_pk_bf16_f32 v178, v180, v181
  v_cvt_pk_bf16_f32 v179, v182, v183
  v_permlane32_swap_b32 v168, v170
  v_permlane32_swap_b32 v169, v171
  buffer_store_dwordx4 v[168:171], v21, s[36:39], s60 offen offset:0 sc1
  v_permlane32_swap_b32 v176, v178
  v_permlane32_swap_b32 v177, v179
  buffer_store_dwordx4 v[176:179], v21, s[36:39], s60 offen offset:512 sc1
  s_nop 3
  v_cvt_pk_bf16_f32 v184, v184, v185
  v_cvt_pk_bf16_f32 v185, v186, v187
  v_cvt_pk_bf16_f32 v186, v188, v189
  v_cvt_pk_bf16_f32 v187, v190, v191
  v_cvt_pk_bf16_f32 v192, v192, v193
  v_cvt_pk_bf16_f32 v193, v194, v195
  v_cvt_pk_bf16_f32 v194, v196, v197
  v_cvt_pk_bf16_f32 v195, v198, v199
  v_permlane32_swap_b32 v184, v186
  v_permlane32_swap_b32 v185, v187
  buffer_store_dwordx4 v[184:187], v22, s[36:39], s60 offen offset:0 sc1
  v_permlane32_swap_b32 v192, v194
  v_permlane32_swap_b32 v193, v195
  buffer_store_dwordx4 v[192:195], v22, s[36:39], s60 offen offset:512 sc1
  s_branch proj_kernel_end
proj_kernel_c_ab6:
  v_and_b32 v12, 31, v2
  v_lshrrev_b32 v13, 5, v2
  v_lshrrev_b32 v14, 1, v12
  v_and_b32 v14, 7, v14
  s_lshl_b32 s44, s40, 12
  v_add_u32 v15, 0, v13
  v_xor_b32 v15, v15, v14
  v_lshlrev_b32 v15, 4, v15
  v_lshl_add_u32 v15, v12, 7, v15
  v_add_u32 v4, s44, v15
  v_add_u32 v8, 16384, v15
  v_add_u32 v15, 2, v13
  v_xor_b32 v15, v15, v14
  v_lshlrev_b32 v15, 4, v15
  v_lshl_add_u32 v15, v12, 7, v15
  v_add_u32 v5, s44, v15
  v_add_u32 v9, 16384, v15
  v_add_u32 v15, 4, v13
  v_xor_b32 v15, v15, v14
  v_lshlrev_b32 v15, 4, v15
  v_lshl_add_u32 v15, v12, 7, v15
  v_add_u32 v6, s44, v15
  v_add_u32 v10, 16384, v15
  v_add_u32 v15, 6, v13
  v_xor_b32 v15, v15, v14
  v_lshlrev_b32 v15, 4, v15
  v_lshl_add_u32 v15, v12, 7, v15
  v_add_u32 v7, s44, v15
  v_add_u32 v11, 16384, v15
  s_lshl_b32 s45, s41, 2
  s_add_u32 s45, s45, s40
  s_lshl_b32 s46, s55, 6
  s_add_u32 s46, s46, s45
  s_mul_i32 s60, s46, 5120
  s_add_u32 s60, s60, 10485760
  s_lshl_b32 s47, s43, 1
  v_lshrrev_b32 v3, 4, v12
  v_add_u32 v3, s47, v3
  v_and_b32 v14, 15, v12
  v_lshlrev_b32 v14, 4, v14
  v_lshl_add_u32 v14, v13, 8, v14
  v_add_u32 v15, 0, v3
  v_mul_u32_u24 v1, 205, v15
  v_lshrrev_b32 v1, 10, v1
  v_mul_u32_u24 v1, 650240, v1
  v_lshl_add_u32 v16, v15, 10, v1
  v_add_u32 v16, v16, v14
  v_add_u32 v15, 2, v3
  v_mul_u32_u24 v1, 205, v15
  v_lshrrev_b32 v1, 10, v1
  v_mul_u32_u24 v1, 650240, v1
  v_lshl_add_u32 v17, v15, 10, v1
  v_add_u32 v17, v17, v14
  v_add_u32 v15, 4, v3
  v_mul_u32_u24 v1, 205, v15
  v_lshrrev_b32 v1, 10, v1
  v_mul_u32_u24 v1, 650240, v1
  v_lshl_add_u32 v18, v15, 10, v1
  v_add_u32 v18, v18, v14
  v_add_u32 v15, 6, v3
  v_mul_u32_u24 v1, 205, v15
  v_lshrrev_b32 v1, 10, v1
  v_mul_u32_u24 v1, 650240, v1
  v_lshl_add_u32 v19, v15, 10, v1
  v_add_u32 v19, v19, v14
  v_add_u32 v15, 8, v3
  v_mul_u32_u24 v1, 205, v15
  v_lshrrev_b32 v1, 10, v1
  v_mul_u32_u24 v1, 650240, v1
  v_lshl_add_u32 v20, v15, 10, v1
  v_add_u32 v20, v20, v14
  v_add_u32 v15, 10, v3
  v_mul_u32_u24 v1, 205, v15
  v_lshrrev_b32 v1, 10, v1
  v_mul_u32_u24 v1, 650240, v1
  v_lshl_add_u32 v21, v15, 10, v1
  v_add_u32 v21, v21, v14
  s_mov_b32 s48, 0
  s_barrier
  ds_read_b128 v[24:27], v4
  ds_read_b128 v[28:31], v8 offset:0
  ds_read_b128 v[32:35], v8 offset:4096
  ds_read_b128 v[36:39], v8 offset:8192
  ds_read_b128 v[40:43], v8 offset:12288
  ds_read_b128 v[44:47], v8 offset:16384
  ds_read_b128 v[48:51], v8 offset:20480
  s_waitcnt lgkmcnt(5)
  v_mfma_f32_32x32x16_bf16 v[88:103], v[24:27], v[28:31], 0
  ds_read_b128 v[56:59], v5
  ds_read_b128 v[60:63], v9 offset:0
  s_waitcnt lgkmcnt(6)
  v_mfma_f32_32x32x16_bf16 v[104:119], v[24:27], v[32:35], 0
  ds_read_b128 v[64:67], v9 offset:4096
  s_waitcnt lgkmcnt(6)
  v_mfma_f32_32x32x16_bf16 v[120:135], v[24:27], v[36:39], 0
  ds_read_b128 v[68:71], v9 offset:8192
  s_waitcnt lgkmcnt(6)
  v_mfma_f32_32x32x16_bf16 v[136:151], v[24:27], v[40:43], 0
  ds_read_b128 v[72:75], v9 offset:12288
  s_waitcnt lgkmcnt(6)
  v_mfma_f32_32x32x16_bf16 v[152:167], v[24:27], v[44:47], 0
  ds_read_b128 v[76:79], v9 offset:16384
  s_waitcnt lgkmcnt(6)
  v_mfma_f32_32x32x16_bf16 v[168:183], v[24:27], v[48:51], 0
  ds_read_b128 v[80:83], v9 offset:20480
  s_waitcnt lgkmcnt(5)
  v_mfma_f32_32x32x16_bf16 v[88:103], v[56:59], v[60:63], v[88:103]
  ds_read_b128 v[24:27], v6
  ds_read_b128 v[28:31], v10 offset:0
  s_waitcnt lgkmcnt(6)
  v_mfma_f32_32x32x16_bf16 v[104:119], v[56:59], v[64:67], v[104:119]
  ds_read_b128 v[32:35], v10 offset:4096
  s_waitcnt lgkmcnt(6)
  v_mfma_f32_32x32x16_bf16 v[120:135], v[56:59], v[68:71], v[120:135]
  ds_read_b128 v[36:39], v10 offset:8192
  s_waitcnt lgkmcnt(6)
  v_mfma_f32_32x32x16_bf16 v[136:151], v[56:59], v[72:75], v[136:151]
  ds_read_b128 v[40:43], v10 offset:12288
  s_waitcnt lgkmcnt(6)
  v_mfma_f32_32x32x16_bf16 v[152:167], v[56:59], v[76:79], v[152:167]
  ds_read_b128 v[44:47], v10 offset:16384
  s_waitcnt lgkmcnt(6)
  v_mfma_f32_32x32x16_bf16 v[168:183], v[56:59], v[80:83], v[168:183]
  ds_read_b128 v[48:51], v10 offset:20480
  s_waitcnt lgkmcnt(5)
  v_mfma_f32_32x32x16_bf16 v[88:103], v[24:27], v[28:31], v[88:103]
  ds_read_b128 v[56:59], v7
  ds_read_b128 v[60:63], v11 offset:0
  s_waitcnt lgkmcnt(6)
  v_mfma_f32_32x32x16_bf16 v[104:119], v[24:27], v[32:35], v[104:119]
  ds_read_b128 v[64:67], v11 offset:4096
  s_waitcnt lgkmcnt(6)
  v_mfma_f32_32x32x16_bf16 v[120:135], v[24:27], v[36:39], v[120:135]
  ds_read_b128 v[68:71], v11 offset:8192
  s_waitcnt lgkmcnt(6)
  v_mfma_f32_32x32x16_bf16 v[136:151], v[24:27], v[40:43], v[136:151]
  ds_read_b128 v[72:75], v11 offset:12288
  s_waitcnt lgkmcnt(6)
  v_mfma_f32_32x32x16_bf16 v[152:167], v[24:27], v[44:47], v[152:167]
  ds_read_b128 v[76:79], v11 offset:16384
  s_waitcnt lgkmcnt(6)
  v_mfma_f32_32x32x16_bf16 v[168:183], v[24:27], v[48:51], v[168:183]
  ds_read_b128 v[80:83], v11 offset:20480
  s_waitcnt lgkmcnt(5)
  v_mfma_f32_32x32x16_bf16 v[88:103], v[56:59], v[60:63], v[88:103]
  s_mov_b32 s49, s48
  s_add_u32 s48, s48, 45056
  s_cmp_eq_u32 s48, 135168
  s_cselect_b32 s48, 0, s48
  s_sub_u32 s49, s48, s49
  v_add_u32 v4, s49, v4
  v_add_u32 v5, s49, v5
  v_add_u32 v6, s49, v6
  v_add_u32 v7, s49, v7
  v_add_u32 v8, s49, v8
  v_add_u32 v9, s49, v9
  v_add_u32 v10, s49, v10
  v_add_u32 v11, s49, v11
  s_waitcnt lgkmcnt(4)
  v_mfma_f32_32x32x16_bf16 v[104:119], v[56:59], v[64:67], v[104:119]
  s_waitcnt lgkmcnt(0)
  s_mov_b32 s50, 8
proj_kernel_c_ab6_loop_12:
  s_barrier
  ds_read_b128 v[24:27], v4
  ds_read_b128 v[28:31], v8 offset:0
  ds_read_b128 v[32:35], v8 offset:4096
  v_mfma_f32_32x32x16_bf16 v[120:135], v[56:59], v[68:71], v[120:135]
  ds_read_b128 v[36:39], v8 offset:8192
  v_mfma_f32_32x32x16_bf16 v[136:151], v[56:59], v[72:75], v[136:151]
  ds_read_b128 v[40:43], v8 offset:12288
  v_mfma_f32_32x32x16_bf16 v[152:167], v[56:59], v[76:79], v[152:167]
  ds_read_b128 v[44:47], v8 offset:16384
  v_mfma_f32_32x32x16_bf16 v[168:183], v[56:59], v[80:83], v[168:183]
  ds_read_b128 v[48:51], v8 offset:20480
  s_waitcnt lgkmcnt(5)
  v_mfma_f32_32x32x16_bf16 v[88:103], v[24:27], v[28:31], v[88:103]
  ds_read_b128 v[56:59], v5
  ds_read_b128 v[60:63], v9 offset:0
  s_waitcnt lgkmcnt(6)
  v_mfma_f32_32x32x16_bf16 v[104:119], v[24:27], v[32:35], v[104:119]
  ds_read_b128 v[64:67], v9 offset:4096
  s_waitcnt lgkmcnt(6)
  v_mfma_f32_32x32x16_bf16 v[120:135], v[24:27], v[36:39], v[120:135]
  ds_read_b128 v[68:71], v9 offset:8192
  s_waitcnt lgkmcnt(6)
  v_mfma_f32_32x32x16_bf16 v[136:151], v[24:27], v[40:43], v[136:151]
  ds_read_b128 v[72:75], v9 offset:12288
  s_waitcnt lgkmcnt(6)
  v_mfma_f32_32x32x16_bf16 v[152:167], v[24:27], v[44:47], v[152:167]
  ds_read_b128 v[76:79], v9 offset:16384
  s_waitcnt lgkmcnt(6)
  v_mfma_f32_32x32x16_bf16 v[168:183], v[24:27], v[48:51], v[168:183]
  ds_read_b128 v[80:83], v9 offset:20480
  s_waitcnt lgkmcnt(5)
  v_mfma_f32_32x32x16_bf16 v[88:103], v[56:59], v[60:63], v[88:103]
  ds_read_b128 v[24:27], v6
  ds_read_b128 v[28:31], v10 offset:0
  s_waitcnt lgkmcnt(6)
  v_mfma_f32_32x32x16_bf16 v[104:119], v[56:59], v[64:67], v[104:119]
  ds_read_b128 v[32:35], v10 offset:4096
  s_waitcnt lgkmcnt(6)
  v_mfma_f32_32x32x16_bf16 v[120:135], v[56:59], v[68:71], v[120:135]
  ds_read_b128 v[36:39], v10 offset:8192
  s_waitcnt lgkmcnt(6)
  v_mfma_f32_32x32x16_bf16 v[136:151], v[56:59], v[72:75], v[136:151]
  ds_read_b128 v[40:43], v10 offset:12288
  s_waitcnt lgkmcnt(6)
  v_mfma_f32_32x32x16_bf16 v[152:167], v[56:59], v[76:79], v[152:167]
  ds_read_b128 v[44:47], v10 offset:16384
  s_waitcnt lgkmcnt(6)
  v_mfma_f32_32x32x16_bf16 v[168:183], v[56:59], v[80:83], v[168:183]
  ds_read_b128 v[48:51], v10 offset:20480
  s_waitcnt lgkmcnt(5)
  v_mfma_f32_32x32x16_bf16 v[88:103], v[24:27], v[28:31], v[88:103]
  ds_read_b128 v[56:59], v7
  ds_read_b128 v[60:63], v11 offset:0
  s_waitcnt lgkmcnt(6)
  v_mfma_f32_32x32x16_bf16 v[104:119], v[24:27], v[32:35], v[104:119]
  ds_read_b128 v[64:67], v11 offset:4096
  s_waitcnt lgkmcnt(6)
  v_mfma_f32_32x32x16_bf16 v[120:135], v[24:27], v[36:39], v[120:135]
  ds_read_b128 v[68:71], v11 offset:8192
  s_waitcnt lgkmcnt(6)
  v_mfma_f32_32x32x16_bf16 v[136:151], v[24:27], v[40:43], v[136:151]
  ds_read_b128 v[72:75], v11 offset:12288
  s_waitcnt lgkmcnt(6)
  v_mfma_f32_32x32x16_bf16 v[152:167], v[24:27], v[44:47], v[152:167]
  ds_read_b128 v[76:79], v11 offset:16384
  s_waitcnt lgkmcnt(6)
  v_mfma_f32_32x32x16_bf16 v[168:183], v[24:27], v[48:51], v[168:183]
  ds_read_b128 v[80:83], v11 offset:20480
  s_waitcnt lgkmcnt(5)
  v_mfma_f32_32x32x16_bf16 v[88:103], v[56:59], v[60:63], v[88:103]
  s_mov_b32 s49, s48
  s_add_u32 s48, s48, 45056
  s_cmp_eq_u32 s48, 135168
  s_cselect_b32 s48, 0, s48
  s_sub_u32 s49, s48, s49
  v_add_u32 v4, s49, v4
  v_add_u32 v5, s49, v5
  v_add_u32 v6, s49, v6
  v_add_u32 v7, s49, v7
  v_add_u32 v8, s49, v8
  v_add_u32 v9, s49, v9
  v_add_u32 v10, s49, v10
  v_add_u32 v11, s49, v11
  s_waitcnt lgkmcnt(4)
  v_mfma_f32_32x32x16_bf16 v[104:119], v[56:59], v[64:67], v[104:119]
  s_waitcnt lgkmcnt(0)
  s_sub_u32 s50, s50, 1
  s_cmp_lg_u32 s50, 0
  s_cbranch_scc1 proj_kernel_c_ab6_loop_12
  s_barrier
  ds_read_b128 v[24:27], v4
  ds_read_b128 v[28:31], v5
  ds_read_b128 v[32:35], v6
  v_mfma_f32_32x32x16_bf16 v[120:135], v[56:59], v[68:71], v[120:135]
  ds_read_b128 v[36:39], v7
  ds_read_b128 v[40:43], v8 offset:0
  ds_read_b128 v[44:47], v9 offset:0
  v_mfma_f32_32x32x16_bf16 v[136:151], v[56:59], v[72:75], v[136:151]
  ds_read_b128 v[48:51], v10 offset:0
  ds_read_b128 v[52:55], v11 offset:0
  ds_read_b128 v[204:207], v8 offset:4096
  v_mfma_f32_32x32x16_bf16 v[152:167], v[56:59], v[76:79], v[152:167]
  ds_read_b128 v[208:211], v9 offset:4096
  ds_read_b128 v[212:215], v10 offset:4096
  ds_read_b128 v[216:219], v11 offset:4096
  v_mfma_f32_32x32x16_bf16 v[168:183], v[56:59], v[80:83], v[168:183]
  s_waitcnt lgkmcnt(4)
  v_mfma_f32_32x32x16_bf16 v[88:103], v[24:27], v[40:43], v[88:103]
  v_mfma_f32_32x32x16_bf16 v[88:103], v[28:31], v[44:47], v[88:103]
  ds_read_b128 v[220:223], v8 offset:8192
  ds_read_b128 v[224:227], v9 offset:8192
  v_mfma_f32_32x32x16_bf16 v[88:103], v[32:35], v[48:51], v[88:103]
  ds_read_b128 v[228:231], v10 offset:8192
  ds_read_b128 v[232:235], v11 offset:8192
  v_mfma_f32_32x32x16_bf16 v[88:103], v[36:39], v[52:55], v[88:103]
  s_waitcnt lgkmcnt(4)
  v_mfma_f32_32x32x16_bf16 v[104:119], v[24:27], v[204:207], v[104:119]
  v_mfma_f32_32x32x16_bf16 v[104:119], v[28:31], v[208:211], v[104:119]
  ds_read_b128 v[40:43], v8 offset:12288
  ds_read_b128 v[44:47], v9 offset:12288
  v_mfma_f32_32x32x16_bf16 v[104:119], v[32:35], v[212:215], v[104:119]
  ds_read_b128 v[48:51], v10 offset:12288
  ds_read_b128 v[52:55], v11 offset:12288
  v_mfma_f32_32x32x16_bf16 v[104:119], v[36:39], v[216:219], v[104:119]
  s_nop 3
  v_cvt_pk_bf16_f32 v88, v88, v89
  v_cvt_pk_bf16_f32 v89, v90, v91
  v_cvt_pk_bf16_f32 v90, v92, v93
  v_cvt_pk_bf16_f32 v91, v94, v95
  v_cvt_pk_bf16_f32 v96, v96, v97
  v_cvt_pk_bf16_f32 v97, v98, v99
  v_cvt_pk_bf16_f32 v98, v100, v101
  v_cvt_pk_bf16_f32 v99, v102, v103
  v_permlane32_swap_b32 v88, v90
  v_permlane32_swap_b32 v89, v91
  buffer_store_dwordx4 v[88:91], v16, s[36:39], s60 offen offset:0 sc1
  v_permlane32_swap_b32 v96, v98
  v_permlane32_swap_b32 v97, v99
  buffer_store_dwordx4 v[96:99], v16, s[36:39], s60 offen offset:512 sc1
  s_waitcnt lgkmcnt(4)
  v_mfma_f32_32x32x16_bf16 v[120:135], v[24:27], v[220:223], v[120:135]
  v_mfma_f32_32x32x16_bf16 v[120:135], v[28:31], v[224:227], v[120:135]
  ds_read_b128 v[204:207], v8 offset:16384
  ds_read_b128 v[208:211], v9 offset:16384
  v_mfma_f32_32x32x16_bf16 v[120:135], v[32:35], v[228:231], v[120:135]
  ds_read_b128 v[212:215], v10 offset:16384
  ds_read_b128 v[216:219], v11 offset:16384
  v_mfma_f32_32x32x16_bf16 v[120:135], v[36:39], v[232:235], v[120:135]
  s_nop 3
  v_cvt_pk_bf16_f32 v104, v104, v105
  v_cvt_pk_bf16_f32 v105, v106, v107
  v_cvt_pk_bf16_f32 v106, v108, v109
  v_cvt_pk_bf16_f32 v107, v110, v111
  v_cvt_pk_bf16_f32 v112, v112, v113
  v_cvt_pk_bf16_f32 v113, v114, v115
  v_cvt_pk_bf16_f32 v114, v116, v117
  v_cvt_pk_bf16_f32 v115, v118, v119
  v_permlane32_swap_b32 v104, v106
  v_permlane32_swap_b32 v105, v107
  buffer_store_dwordx4 v[104:107], v17, s[36:39], s60 offen offset:0 sc1
  v_permlane32_swap_b32 v112, v114
  v_permlane32_swap_b32 v113, v115
  buffer_store_dwordx4 v[112:115], v17, s[36:39], s60 offen offset:512 sc1
  s_waitcnt lgkmcnt(4)
  v_mfma_f32_32x32x16_bf16 v[136:151], v[24:27], v[40:43], v[136:151]
  v_mfma_f32_32x32x16_bf16 v[136:151], v[28:31], v[44:47], v[136:151]
  ds_read_b128 v[220:223], v8 offset:20480
  ds_read_b128 v[224:227], v9 offset:20480
  v_mfma_f32_32x32x16_bf16 v[136:151], v[32:35], v[48:51], v[136:151]
  ds_read_b128 v[228:231], v10 offset:20480
  ds_read_b128 v[232:235], v11 offset:20480
  v_mfma_f32_32x32x16_bf16 v[136:151], v[36:39], v[52:55], v[136:151]
  s_nop 3
  v_cvt_pk_bf16_f32 v120, v120, v121
  v_cvt_pk_bf16_f32 v121, v122, v123
  v_cvt_pk_bf16_f32 v122, v124, v125
  v_cvt_pk_bf16_f32 v123, v126, v127
  v_cvt_pk_bf16_f32 v128, v128, v129
  v_cvt_pk_bf16_f32 v129, v130, v131
  v_cvt_pk_bf16_f32 v130, v132, v133
  v_cvt_pk_bf16_f32 v131, v134, v135
  v_permlane32_swap_b32 v120, v122
  v_permlane32_swap_b32 v121, v123
  buffer_store_dwordx4 v[120:123], v18, s[36:39], s60 offen offset:0 sc1
  v_permlane32_swap_b32 v128, v130
  v_permlane32_swap_b32 v129, v131
  buffer_store_dwordx4 v[128:131], v18, s[36:39], s60 offen offset:512 sc1
  s_waitcnt lgkmcnt(4)
  v_mfma_f32_32x32x16_bf16 v[152:167], v[24:27], v[204:207], v[152:167]
  v_mfma_f32_32x32x16_bf16 v[152:167], v[28:31], v[208:211], v[152:167]
  v_mfma_f32_32x32x16_bf16 v[152:167], v[32:35], v[212:215], v[152:167]
  v_mfma_f32_32x32x16_bf16 v[152:167], v[36:39], v[216:219], v[152:167]
  s_nop 7
  v_cvt_pk_bf16_f32 v136, v136, v137
  v_cvt_pk_bf16_f32 v137, v138, v139
  v_cvt_pk_bf16_f32 v138, v140, v141
  v_cvt_pk_bf16_f32 v139, v142, v143
  v_cvt_pk_bf16_f32 v144, v144, v145
  v_cvt_pk_bf16_f32 v145, v146, v147
  v_cvt_pk_bf16_f32 v146, v148, v149
  v_cvt_pk_bf16_f32 v147, v150, v151
  v_permlane32_swap_b32 v136, v138
  v_permlane32_swap_b32 v137, v139
  buffer_store_dwordx4 v[136:139], v19, s[36:39], s60 offen offset:0 sc1
  v_permlane32_swap_b32 v144, v146
  v_permlane32_swap_b32 v145, v147
  buffer_store_dwordx4 v[144:147], v19, s[36:39], s60 offen offset:512 sc1
  s_waitcnt lgkmcnt(0)
  v_mfma_f32_32x32x16_bf16 v[168:183], v[24:27], v[220:223], v[168:183]
  v_mfma_f32_32x32x16_bf16 v[168:183], v[28:31], v[224:227], v[168:183]
  v_mfma_f32_32x32x16_bf16 v[168:183], v[32:35], v[228:231], v[168:183]
  v_mfma_f32_32x32x16_bf16 v[168:183], v[36:39], v[232:235], v[168:183]
  s_nop 7
  v_cvt_pk_bf16_f32 v152, v152, v153
  v_cvt_pk_bf16_f32 v153, v154, v155
  v_cvt_pk_bf16_f32 v154, v156, v157
  v_cvt_pk_bf16_f32 v155, v158, v159
  v_cvt_pk_bf16_f32 v160, v160, v161
  v_cvt_pk_bf16_f32 v161, v162, v163
  v_cvt_pk_bf16_f32 v162, v164, v165
  v_cvt_pk_bf16_f32 v163, v166, v167
  v_permlane32_swap_b32 v152, v154
  v_permlane32_swap_b32 v153, v155
  buffer_store_dwordx4 v[152:155], v20, s[36:39], s60 offen offset:0 sc1
  v_permlane32_swap_b32 v160, v162
  v_permlane32_swap_b32 v161, v163
  buffer_store_dwordx4 v[160:163], v20, s[36:39], s60 offen offset:512 sc1
  s_nop 3
  v_cvt_pk_bf16_f32 v168, v168, v169
  v_cvt_pk_bf16_f32 v169, v170, v171
  v_cvt_pk_bf16_f32 v170, v172, v173
  v_cvt_pk_bf16_f32 v171, v174, v175
  v_cvt_pk_bf16_f32 v176, v176, v177
  v_cvt_pk_bf16_f32 v177, v178, v179
  v_cvt_pk_bf16_f32 v178, v180, v181
  v_cvt_pk_bf16_f32 v179, v182, v183
  v_permlane32_swap_b32 v168, v170
  v_permlane32_swap_b32 v169, v171
  buffer_store_dwordx4 v[168:171], v21, s[36:39], s60 offen offset:0 sc1
  v_permlane32_swap_b32 v176, v178
  v_permlane32_swap_b32 v177, v179
  buffer_store_dwordx4 v[176:179], v21, s[36:39], s60 offen offset:512 sc1
  s_branch proj_kernel_end
proj_kernel_end:
  s_endpgm
.globl attn_kernel
.p2align 8
.type attn_kernel,@function
attn_kernel:
  s_load_dwordx16 s[4:19], s[0:1], 0
  s_load_dwordx8 s[20:27], s[0:1], 64
  s_cmp_ge_u32 s2, 256
  s_cbranch_scc1 attn_kernel_end
  v_lshrrev_b32 v1, 6, v0
  v_and_b32 v2, 63, v0
  v_readfirstlane_b32 s40, v1
  s_and_b32 s46, s2, 7
  s_lshr_b32 s47, s2, 3
  s_lshl_b32 s41, s46, 2
  s_lshr_b32 s48, s47, 3
  s_add_u32 s41, s41, s48
  s_and_b32 s42, s47, 7
  s_mov_b32 s60, -1
  s_mov_b32 s61, 0
  s_mov_b32 s62, 0xfffff
  s_mov_b32 s63, 0xfffff
  s_mov_b32 s71, 0x5f800000
  s_mov_b32 s72, 0x1f800000
  v_lshlrev_b32 v3, 4, v2
  v_and_b32 v8, 31, v2
  v_lshrrev_b32 v9, 5, v2
  v_lshlrev_b32 v15, 3, v8
  v_mov_b32 v20, 0
  v_mov_b32 v21, 0
  v_mov_b32 v28, 0
  v_mov_b32 v29, 0
  v_mov_b32 v37, 0
  v_mov_b32 v36, 0x3f80
  v_lshlrev_b32 v4, 2, v2
  v_add_u32 v4, 155648, v4
  ds_write_b32 v4, v20
  s_cmp_ge_u32 s40, 8
  s_cbranch_scc1 attn_kernel_g
attn_kernel_a:
  s_setprio 2
  s_and_b32 s46, s40, 3
  s_lshr_b32 s47, s40, 2
  s_add_u32 s55, s41, 32
  s_lshl_b32 s55, s55, 6
  s_lshl_b32 s48, s47, 5
  s_add_u32 s55, s55, s48
  s_add_u32 s55, s55, s46
  s_mul_i32 s55, s55, 2560
  s_mul_i32 s49, s47, 20480
  s_add_u32 s49, s49, 98304
  s_mul_i32 s58, s46, 2560
  s_add_u32 s58, s58, s49
  s_mov_b32 s51, 10240
  s_mul_i32 s73, s46, 2560
  s_sub_u32 s73, s55, s73
  s_lshl_b32 s48, s42, 3
  s_lshl_b32 s70, s46, 1
  s_add_u32 s70, s70, s48
  s_add_u32 s70, s70, s47
  s_lshl_b32 s69, s41, 6
  s_add_u32 s69, s69, s70
  s_xor_b32 s48, s69, 1
  s_mul_i32 s69, s69, 2560
  s_mul_i32 s48, s48, 2560
  s_mov_b32 s57, 8
  v_add_u32 v10, s49, v3
  v_add_u32 v11, s49, v15
  v_mul_u32_u24 v4, 320, v9
  v_lshl_add_u32 v4, v8, 4, v4
  v_add_u32 v12, s49, v4
  v_mov_b32 v22, 155648
  v_mov_b32 v23, 1
  v_mov_b32 v44, 0x3f80
  v_mov_b32 v45, 0
  v_mov_b32 v48, 0x3f803f80
  v_mov_b32 v49, 0x3f803f80
  v_mov_b32 v50, 0x3f803f80
  v_mov_b32 v51, 0x3f803f80
  v_mov_b32 v52, 0x3f803f80
  v_mov_b32 v53, 0x3f803f80
  v_mov_b32 v54, 0x3f803f80
  v_mov_b32 v55, 0x3f803f80
  v_mov_b32 v56, 0x3f803f80
  v_mov_b32 v57, 0x3f803f80
  v_mov_b32 v58, 0x3f803f80
  v_mov_b32 v59, 0x3f803f80
  v_mov_b32 v60, 0x3f803f80
  v_mov_b32 v61, 0x3f803f80
  v_mov_b32 v62, 0x3f803f80
  v_mov_b32 v63, 0x3f803f80
  v_mov_b32 v64, 0
  v_mov_b32 v65, 0
  v_mov_b32 v66, 0
  v_mov_b32 v67, 0
  v_mov_b32 v68, 0
  v_mov_b32 v69, 0
  v_mov_b32 v70, 0
  v_mov_b32 v71, 0
  v_mov_b32 v104, 0
  v_mov_b32 v105, 0
  v_mov_b32 v106, 0
  v_mov_b32 v107, 0
  v_mov_b32 v108, 0
  v_mov_b32 v109, 0
  v_mov_b32 v110, 0
  v_mov_b32 v111, 0
  v_mov_b32 v112, 0
  v_mov_b32 v113, 0
  v_mov_b32 v114, 0
  v_mov_b32 v115, 0
  v_mov_b32 v116, 0
  v_mov_b32 v117, 0
  v_mov_b32 v118, 0
  v_mov_b32 v119, 0
  v_mov_b32 v120, 0
  v_mov_b32 v121, 0
  v_mov_b32 v122, 0
  v_mov_b32 v123, 0
  v_mov_b32 v124, 0
  v_mov_b32 v125, 0
  v_mov_b32 v126, 0
  v_mov_b32 v127, 0
  v_mov_b32 v128, 0
  v_mov_b32 v129, 0
  v_mov_b32 v130, 0
  v_mov_b32 v131, 0
  v_mov_b32 v132, 0
  v_mov_b32 v133, 0
  v_mov_b32 v134, 0
  v_mov_b32 v135, 0
  s_waitcnt lgkmcnt(0)
  s_mov_b32 s36, s26
  s_and_b32 s37, s27, 0xffff
  s_mov_b32 s38, 19210240
  s_mov_b32 s39, 0x20000
  buffer_load_dwordx4 v[32:35], v3, s[36:39], s73 offen
  buffer_load_dwordx4 v[16:19], v3, s[36:39], s48 offen
  buffer_load_dwordx4 v[24:27], v3, s[36:39], s69 offen
  s_mov_b64 exec, s[60:61]
  buffer_load_dwordx2 v[36:37], v15, s[36:39], s73 offen offset:1024
  buffer_load_dwordx2 v[20:21], v15, s[36:39], s48 offen offset:1024
  buffer_load_dwordx2 v[28:29], v15, s[36:39], s69 offen offset:1024
  s_mov_b64 exec, -1
  s_mov_b32 m0, s58
  s_nop 0
  buffer_load_dwordx4 v3, s[36:39], s55 offen lds
  buffer_load_dwordx4 v3, s[36:39], s55 offen offset:1024 lds
  s_mov_b64 exec, s[60:61]
  buffer_load_dwordx4 v3, s[36:39], s55 offen offset:2048 lds
  s_mov_b64 exec, -1
  s_add_u32 s55, s55, 10240
  s_add_u32 s58, s58, 10240
  s_barrier
  s_xor_b32 s48, s40, 0
  s_lshl_b32 s49, s48, 11
  s_add_u32 s49, s49, 139264
  v_add_u32 v140, s49, v3
  s_lshr_b32 s48, s48, 2
  s_mul_i32 s48, s48, 20480
  s_lshl_b32 s49, s46, 11
  s_add_u32 s48, s48, s49
  s_add_u32 s48, s48, 98304
  v_add_u32 v141, s48, v3
  s_xor_b32 s48, s40, 4
  s_lshl_b32 s49, s48, 11
  s_add_u32 s49, s49, 139264
  v_add_u32 v142, s49, v3
  s_lshr_b32 s48, s48, 2
  s_mul_i32 s48, s48, 20480
  s_lshl_b32 s49, s46, 11
  s_add_u32 s48, s48, s49
  s_add_u32 s48, s48, 98304
  v_add_u32 v143, s48, v3
  s_lshl_b32 s48, s40, 2
  s_add_u32 s48, s48, 155680
  v_mov_b32 v144, s48
  v_xor_b32 v145, 16, v144
  v_lshrrev_b32 v4, 4, v8
  v_mul_u32_u24 v4, 20480, v4
  v_and_b32 v5, 15, v8
  v_lshl_add_u32 v146, v5, 4, v4
  v_lshl_add_u32 v147, v9, 8, v146
  v_mov_b32 v148, 155656
  v_mov_b32 v149, 0
  s_mul_i32 s48, s70, 40960
  s_add_u32 s48, s48, 15728640
  s_lshl_b32 s64, s41, 9
  s_add_u32 s64, s64, s48
  s_lshr_b32 s49, s41, 1
  s_lshl_b32 s49, s49, 8
  s_add_u32 s48, s48, s49
  s_and_b32 s49, s41, 1
  s_lshl_b32 s49, s49, 3
  s_add_u32 s48, s48, s49
  s_add_u32 s65, s48, 16384
  s_lshl_b32 s48, s42, 5
  s_add_u32 s48, s48, s41
  s_lshl_b32 s48, s48, 7
  s_add_u32 s66, s48, 19177472
  s_waitcnt vmcnt(3)
  v_mfma_f32_32x32x16_bf16 v[72:87], v[32:35], v[16:19], 0
  v_mfma_f32_32x32x8_bf16 v[72:87], v[36:37], v[20:21], v[72:87]
  v_mfma_f32_32x32x16_bf16 v[88:103], v[32:35], v[24:27], 0
  v_mfma_f32_32x32x8_bf16 v[88:103], v[36:37], v[28:29], v[88:103]
  s_lshl_b32 s48, s70, 7
  s_add_u32 s48, s48, 19169280
  v_lshlrev_b32 v4, 2, v8
  buffer_load_dword v31, v4, s[36:39], s48 offen
  s_mov_b32 m0, s58
  s_nop 0
  buffer_load_dwordx4 v3, s[36:39], s55 offen lds
  buffer_load_dwordx4 v3, s[36:39], s55 offen offset:1024 lds
  s_mov_b64 exec, s[60:61]
  buffer_load_dwordx4 v3, s[36:39], s55 offen offset:2048 lds
  s_mov_b64 exec, -1
  s_add_u32 s55, s55, 10240
  s_sub_u32 s58, s58, 10240
  s_waitcnt vmcnt(4)
  s_mov_b64 exec, 1
  ds_add_u32 v22, v23
  s_mov_b64 exec, -1
  v_max3_f32 v4, v72, v73, v74
  v_max3_f32 v4, v4, v75, v76
  v_max3_f32 v4, v4, v77, v78
  v_max3_f32 v4, v4, v79, v80
  v_max3_f32 v4, v4, v81, v82
  v_max3_f32 v4, v4, v83, v84
  v_max3_f32 v4, v4, v85, v86
  v_max_f32 v4, v4, v87
  v_mov_b32 v5, v4
  s_nop 1
  v_permlane32_swap_b32 v4, v5
  v_max_f32 v4, v4, v5
  v_cvt_pk_bf16_f32 v4, -v4, 0
  v_lshlrev_b32 v13, 16, v4
  v_cndmask_b32 v20, v4, v20, s[60:61]
  v_max3_f32 v4, v88, v89, v90
  v_max3_f32 v4, v4, v91, v92
  v_max3_f32 v4, v4, v93, v94
  v_max3_f32 v4, v4, v95, v96
  v_max3_f32 v4, v4, v97, v98
  v_max3_f32 v4, v4, v99, v100
  v_max3_f32 v4, v4, v101, v102
  v_max_f32 v4, v4, v103
  v_mov_b32 v5, v4
  s_nop 1
  v_permlane32_swap_b32 v4, v5
  v_max_f32 v4, v4, v5
  v_cvt_pk_bf16_f32 v4, -v4, 0
  v_lshlrev_b32 v14, 16, v4
  v_cndmask_b32 v28, v4, v28, s[60:61]
  ds_read_b32 v30, v22
  s_nop 0
  v_mfma_f32_32x32x16_bf16 v[72:87], v[32:35], v[16:19], 0
  v_mfma_f32_32x32x8_bf16 v[72:87], v[36:37], v[20:21], v[72:87]
  s_mov_b32 s52, 8
  s_waitcnt lgkmcnt(0)
kvspin_14:
  v_readfirstlane_b32 s48, v30
  s_cmp_ge_u32 s48, s57
  s_cbranch_scc1 kvok_13
  ds_read_b32 v30, v22
  s_waitcnt lgkmcnt(0)
  s_branch kvspin_14
kvok_13:
  s_add_u32 s57, s57, 8
  s_mov_b64 exec, s[62:63]
  ds_read_b128 v[48:51], v12 offset:1280
  ds_read_b128 v[52:55], v12 offset:1920
  s_mov_b64 exec, -1
  s_nop 1
  s_branch attn_kernel_a_mid_16
attn_kernel_a_loop_15:
  s_waitcnt lgkmcnt(0)
  s_setprio 3
  v_mfma_f32_32x32x16_bf16 v[88:103], v[40:43], v[24:27], 0
kvspin_19:
  v_readfirstlane_b32 s48, v30
  s_cmp_ge_u32 s48, s57
  s_cbranch_scc1 kvok_18
  ds_read_b32 v30, v22
  s_waitcnt lgkmcnt(0)
  s_branch kvspin_19
kvok_18:
  s_add_u32 s57, s57, 8
  s_cmp_eq_u32 s52, 1
  s_cbranch_scc1 nodma_20
  s_mov_b32 m0, s58
  s_nop 0
  buffer_load_dwordx4 v3, s[36:39], s55 offen lds
  buffer_load_dwordx4 v3, s[36:39], s55 offen offset:1024 lds
  s_mov_b64 exec, s[60:61]
  buffer_load_dwordx4 v3, s[36:39], s55 offen offset:2048 lds
  s_mov_b64 exec, -1
  s_add_u32 s55, s55, 10240
  s_add_u32 s58, s58, s51
nodma_20:
  v_add_u32 v10, s51, v10
  v_add_u32 v11, s51, v11
  v_add_u32 v12, s51, v12
  s_sub_u32 s51, 0, s51
  v_exp_f32 v72, v72
  v_exp_f32 v73, v73
  v_exp_f32 v74, v74
  v_exp_f32 v75, v75
  v_cvt_pk_bf16_f32 v64, v72, v73
  v_cvt_pk_bf16_f32 v65, v74, v75
  v_mfma_f32_32x32x16_bf16 v[120:135], v[52:55], v[68:71], v[120:135]
  v_exp_f32 v76, v76
  v_exp_f32 v77, v77
  v_exp_f32 v78, v78
  v_exp_f32 v79, v79
  v_cvt_pk_bf16_f32 v66, v76, v77
  v_cvt_pk_bf16_f32 v67, v78, v79
  ds_read_b128 v[32:35], v10 offset:0
  s_mov_b64 exec, s[60:61]
  ds_read_b64 v[36:37], v11 offset:1024
  s_mov_b64 exec, -1
  v_mfma_f32_32x32x8_bf16 v[88:103], v[44:45], v[28:29], v[88:103]
  v_exp_f32 v80, v80
  v_exp_f32 v81, v81
  v_exp_f32 v82, v82
  v_exp_f32 v83, v83
  v_cvt_pk_bf16_f32 v68, v80, v81
  v_cvt_pk_bf16_f32 v69, v82, v83
  v_mfma_f32_32x32x16_bf16 v[104:119], v[56:59], v[64:67], v[104:119]
  v_exp_f32 v84, v84
  v_exp_f32 v85, v85
  v_exp_f32 v86, v86
  v_exp_f32 v87, v87
  v_cvt_pk_bf16_f32 v70, v84, v85
  v_cvt_pk_bf16_f32 v71, v86, v87
  s_waitcnt lgkmcnt(0)
  s_setprio 3
  v_mfma_f32_32x32x16_bf16 v[72:87], v[32:35], v[16:19], 0
  s_mov_b64 exec, s[62:63]
  ds_read_b128 v[48:51], v12 offset:1280
  ds_read_b128 v[52:55], v12 offset:1920
  s_mov_b64 exec, -1
  v_exp_f32 v88, v88
  v_exp_f32 v89, v89
  v_exp_f32 v90, v90
  v_exp_f32 v91, v91
  v_cvt_pk_bf16_f32 v64, v88, v89
  v_cvt_pk_bf16_f32 v65, v90, v91
  v_mfma_f32_32x32x16_bf16 v[104:119], v[60:63], v[68:71], v[104:119]
  v_exp_f32 v92, v92
  v_exp_f32 v93, v93
  v_exp_f32 v94, v94
  v_exp_f32 v95, v95
  v_cvt_pk_bf16_f32 v66, v92, v93
  v_cvt_pk_bf16_f32 v67, v94, v95
  v_mfma_f32_32x32x8_bf16 v[72:87], v[36:37], v[20:21], v[72:87]
  v_exp_f32 v96, v96
  v_exp_f32 v97, v97
  v_exp_f32 v98, v98
  v_exp_f32 v99, v99
  v_cvt_pk_bf16_f32 v68, v96, v97
  v_cvt_pk_bf16_f32 v69, v98, v99
  v_mfma_f32_32x32x16_bf16 v[120:135], v[56:59], v[64:67], v[120:135]
  v_exp_f32 v100, v100
  v_exp_f32 v101, v101
  v_exp_f32 v102, v102
  v_exp_f32 v103, v103
  v_cvt_pk_bf16_f32 v70, v100, v101
  v_cvt_pk_bf16_f32 v71, v102, v103
attn_kernel_a_mid_16:
  s_waitcnt lgkmcnt(0)
  s_setprio 3
  v_mfma_f32_32x32x16_bf16 v[88:103], v[32:35], v[24:27], 0
  ds_read_b128 v[40:43], v10 offset:2560
  s_mov_b64 exec, s[60:61]
  ds_read_b64 v[44:45], v11 offset:3584
  s_mov_b64 exec, -1
  v_exp_f32 v72, v72
  v_exp_f32 v73, v73
  v_exp_f32 v74, v74
  v_exp_f32 v75, v75
  v_cvt_pk_bf16_f32 v64, v72, v73
  v_cvt_pk_bf16_f32 v65, v74, v75
  v_mfma_f32_32x32x16_bf16 v[120:135], v[60:63], v[68:71], v[120:135]
  v_exp_f32 v76, v76
  v_exp_f32 v77, v77
  v_exp_f32 v78, v78
  v_exp_f32 v79, v79
  v_cvt_pk_bf16_f32 v66, v76, v77
  v_cvt_pk_bf16_f32 v67, v78, v79
  v_mfma_f32_32x32x8_bf16 v[88:103], v[36:37], v[28:29], v[88:103]
  v_exp_f32 v80, v80
  v_exp_f32 v81, v81
  v_exp_f32 v82, v82
  v_exp_f32 v83, v83
  v_cvt_pk_bf16_f32 v68, v80, v81
  v_cvt_pk_bf16_f32 v69, v82, v83
  v_mfma_f32_32x32x16_bf16 v[104:119], v[48:51], v[64:67], v[104:119]
  v_exp_f32 v84, v84
  v_exp_f32 v85, v85
  v_exp_f32 v86, v86
  v_exp_f32 v87, v87
  v_cvt_pk_bf16_f32 v70, v84, v85
  v_cvt_pk_bf16_f32 v71, v86, v87
  s_waitcnt lgkmcnt(0)
  s_setprio 3
  v_mfma_f32_32x32x16_bf16 v[72:87], v[40:43], v[16:19], 0
  s_mov_b64 exec, s[62:63]
  ds_read_b128 v[56:59], v12 offset:3840
  ds_read_b128 v[60:63], v12 offset:4480
  s_mov_b64 exec, -1
  v_exp_f32 v88, v88
  v_exp_f32 v89, v89
  v_exp_f32 v90, v90
  v_exp_f32 v91, v91
  v_cvt_pk_bf16_f32 v64, v88, v89
  v_cvt_pk_bf16_f32 v65, v90, v91
  v_mfma_f32_32x32x16_bf16 v[104:119], v[52:55], v[68:71], v[104:119]
  v_exp_f32 v92, v92
  v_exp_f32 v93, v93
  v_exp_f32 v94, v94
  v_exp_f32 v95, v95
  v_cvt_pk_bf16_f32 v66, v92, v93
  v_cvt_pk_bf16_f32 v67, v94, v95
  v_mfma_f32_32x32x8_bf16 v[72:87], v[44:45], v[20:21], v[72:87]
  v_exp_f32 v96, v96
  v_exp_f32 v97, v97
  v_exp_f32 v98, v98
  v_exp_f32 v99, v99
  v_cvt_pk_bf16_f32 v68, v96, v97
  v_cvt_pk_bf16_f32 v69, v98, v99
  v_mfma_f32_32x32x16_bf16 v[120:135], v[48:51], v[64:67], v[120:135]
  v_exp_f32 v100, v100
  v_exp_f32 v101, v101
  v_exp_f32 v102, v102
  v_exp_f32 v103, v103
  v_cvt_pk_bf16_f32 v70, v100, v101
  v_cvt_pk_bf16_f32 v71, v102, v103
  s_waitcnt lgkmcnt(0)
  s_setprio 2
  v_mfma_f32_32x32x16_bf16 v[88:103], v[40:43], v[24:27], 0
  ds_read_b128 v[32:35], v10 offset:5120
  s_mov_b64 exec, s[60:61]
  ds_read_b64 v[36:37], v11 offset:6144
  s_mov_b64 exec, -1
  v_exp_f32 v72, v72
  v_exp_f32 v73, v73
  v_exp_f32 v74, v74
  v_exp_f32 v75, v75
  v_cvt_pk_bf16_f32 v64, v72, v73
  v_cvt_pk_bf16_f32 v65, v74, v75
  v_mfma_f32_32x32x16_bf16 v[120:135], v[52:55], v[68:71], v[120:135]
  v_exp_f32 v76, v76
  v_exp_f32 v77, v77
  v_exp_f32 v78, v78
  v_exp_f32 v79, v79
  v_cvt_pk_bf16_f32 v66, v76, v77
  v_cvt_pk_bf16_f32 v67, v78, v79
  v_mfma_f32_32x32x8_bf16 v[88:103], v[44:45], v[28:29], v[88:103]
  v_exp_f32 v80, v80
  v_exp_f32 v81, v81
  v_exp_f32 v82, v82
  v_exp_f32 v83, v83
  v_cvt_pk_bf16_f32 v68, v80, v81
  v_cvt_pk_bf16_f32 v69, v82, v83
  v_mfma_f32_32x32x16_bf16 v[104:119], v[56:59], v[64:67], v[104:119]
  v_exp_f32 v84, v84
  v_exp_f32 v85, v85
  v_exp_f32 v86, v86
  v_exp_f32 v87, v87
  v_cvt_pk_bf16_f32 v70, v84, v85
  v_cvt_pk_bf16_f32 v71, v86, v87
  s_waitcnt lgkmcnt(0)
  s_setprio 2
  v_mfma_f32_32x32x16_bf16 v[72:87], v[32:35], v[16:19], 0
  s_mov_b64 exec, s[62:63]
  ds_read_b128 v[48:51], v12 offset:6400
  ds_read_b128 v[52:55], v12 offset:7040
  s_mov_b64 exec, -1
  v_exp_f32 v88, v88
  v_exp_f32 v89, v89
  v_exp_f32 v90, v90
  v_exp_f32 v91, v91
  v_cvt_pk_bf16_f32 v64, v88, v89
  v_cvt_pk_bf16_f32 v65, v90, v91
  v_mfma_f32_32x32x16_bf16 v[104:119], v[60:63], v[68:71], v[104:119]
  v_exp_f32 v92, v92
  v_exp_f32 v93, v93
  v_exp_f32 v94, v94
  v_exp_f32 v95, v95
  v_cvt_pk_bf16_f32 v66, v92, v93
  v_cvt_pk_bf16_f32 v67, v94, v95
  v_mfma_f32_32x32x8_bf16 v[72:87], v[36:37], v[20:21], v[72:87]
  v_exp_f32 v96, v96
  v_exp_f32 v97, v97
  v_exp_f32 v98, v98
  v_exp_f32 v99, v99
  v_cvt_pk_bf16_f32 v68, v96, v97
  v_cvt_pk_bf16_f32 v69, v98, v99
  v_mfma_f32_32x32x16_bf16 v[120:135], v[56:59], v[64:67], v[120:135]
  v_exp_f32 v100, v100
  v_exp_f32 v101, v101
  v_exp_f32 v102, v102
  v_exp_f32 v103, v103
  v_cvt_pk_bf16_f32 v70, v100, v101
  v_cvt_pk_bf16_f32 v71, v102, v103
  s_waitcnt lgkmcnt(0)
  s_setprio 2
  v_mfma_f32_32x32x16_bf16 v[88:103], v[32:35], v[24:27], 0
  ds_read_b128 v[40:43], v10 offset:7680
  s_mov_b64 exec, s[60:61]
  ds_read_b64 v[44:45], v11 offset:8704
  s_mov_b64 exec, -1
  v_exp_f32 v72, v72
  v_exp_f32 v73, v73
  v_exp_f32 v74, v74
  v_exp_f32 v75, v75
  v_cvt_pk_bf16_f32 v64, v72, v73
  v_cvt_pk_bf16_f32 v65, v74, v75
  v_mfma_f32_32x32x16_bf16 v[120:135], v[60:63], v[68:71], v[120:135]
  v_exp_f32 v76, v76
  v_exp_f32 v77, v77
  v_exp_f32 v78, v78
  v_exp_f32 v79, v79
  v_cvt_pk_bf16_f32 v66, v76, v77
  v_cvt_pk_bf16_f32 v67, v78, v79
  s_mov_b64 exec, s[62:63]
  ds_read_b128 v[56:59], v12 offset:8960
  ds_read_b128 v[60:63], v12 offset:9600
  s_mov_b64 exec, -1
  v_mfma_f32_32x32x8_bf16 v[88:103], v[36:37], v[28:29], v[88:103]
  v_exp_f32 v80, v80
  v_exp_f32 v81, v81
  v_exp_f32 v82, v82
  v_exp_f32 v83, v83
  v_cvt_pk_bf16_f32 v68, v80, v81
  v_cvt_pk_bf16_f32 v69, v82, v83
  v_mfma_f32_32x32x16_bf16 v[104:119], v[48:51], v[64:67], v[104:119]
  v_exp_f32 v84, v84
  v_exp_f32 v85, v85
  v_exp_f32 v86, v86
  v_exp_f32 v87, v87
  v_cvt_pk_bf16_f32 v70, v84, v85
  v_cvt_pk_bf16_f32 v71, v86, v87
  s_waitcnt vmcnt(0) lgkmcnt(0)
  s_setprio 1
  v_mfma_f32_32x32x16_bf16 v[72:87], v[40:43], v[16:19], 0
  s_mov_b64 exec, 1
  ds_add_u32 v22, v23
  s_mov_b64 exec, -1
  v_exp_f32 v88, v88
  v_exp_f32 v89, v89
  v_exp_f32 v90, v90
  v_exp_f32 v91, v91
  v_cvt_pk_bf16_f32 v64, v88, v89
  v_cvt_pk_bf16_f32 v65, v90, v91
  v_mfma_f32_32x32x16_bf16 v[104:119], v[52:55], v[68:71], v[104:119]
  v_exp_f32 v92, v92
  v_exp_f32 v93, v93
  v_exp_f32 v94, v94
  v_exp_f32 v95, v95
  v_cvt_pk_bf16_f32 v66, v92, v93
  v_cvt_pk_bf16_f32 v67, v94, v95
  v_mfma_f32_32x32x8_bf16 v[72:87], v[44:45], v[20:21], v[72:87]
  v_exp_f32 v96, v96
  v_exp_f32 v97, v97
  v_exp_f32 v98, v98
  v_exp_f32 v99, v99
  v_cvt_pk_bf16_f32 v68, v96, v97
  v_cvt_pk_bf16_f32 v69, v98, v99
  v_mfma_f32_32x32x16_bf16 v[120:135], v[48:51], v[64:67], v[120:135]
  ds_read_b32 v30, v22
  v_exp_f32 v100, v100
  v_exp_f32 v101, v101
  v_exp_f32 v102, v102
  v_exp_f32 v103, v103
  v_cvt_pk_bf16_f32 v70, v100, v101
  v_cvt_pk_bf16_f32 v71, v102, v103
  s_sub_u32 s52, s52, 1
  s_cmp_lg_u32 s52, 0
  s_cbranch_scc1 attn_kernel_a_loop_15
  s_waitcnt lgkmcnt(0)
  s_setprio 3
  v_mfma_f32_32x32x16_bf16 v[88:103], v[40:43], v[24:27], 0
  v_exp_f32 v72, v72
  v_exp_f32 v73, v73
  v_exp_f32 v74, v74
  v_exp_f32 v75, v75
  v_cvt_pk_bf16_f32 v64, v72, v73
  v_cvt_pk_bf16_f32 v65, v74, v75
  v_mfma_f32_32x32x16_bf16 v[120:135], v[52:55], v[68:71], v[120:135]
  v_exp_f32 v76, v76
  v_exp_f32 v77, v77
  v_exp_f32 v78, v78
  v_exp_f32 v79, v79
  v_cvt_pk_bf16_f32 v66, v76, v77
  v_cvt_pk_bf16_f32 v67, v78, v79
  v_mfma_f32_32x32x8_bf16 v[88:103], v[44:45], v[28:29], v[88:103]
  v_exp_f32 v80, v80
  v_exp_f32 v81, v81
  v_exp_f32 v82, v82
  v_exp_f32 v83, v83
  v_cvt_pk_bf16_f32 v68, v80, v81
  v_cvt_pk_bf16_f32 v69, v82, v83
  v_mfma_f32_32x32x16_bf16 v[104:119], v[56:59], v[64:67], v[104:119]
  v_exp_f32 v84, v84
  v_exp_f32 v85, v85
  v_exp_f32 v86, v86
  v_exp_f32 v87, v87
  v_cvt_pk_bf16_f32 v70, v84, v85
  v_cvt_pk_bf16_f32 v71, v86, v87
  v_exp_f32 v88, v88
  v_exp_f32 v89, v89
  v_exp_f32 v90, v90
  v_exp_f32 v91, v91
  v_cvt_pk_bf16_f32 v64, v88, v89
  v_cvt_pk_bf16_f32 v65, v90, v91
  v_mfma_f32_32x32x16_bf16 v[104:119], v[60:63], v[68:71], v[104:119]
  v_exp_f32 v92, v92
  v_exp_f32 v93, v93
  v_exp_f32 v94, v94
  v_exp_f32 v95, v95
  v_cvt_pk_bf16_f32 v66, v92, v93
  v_cvt_pk_bf16_f32 v67, v94, v95
  v_exp_f32 v96, v96
  v_exp_f32 v97, v97
  v_exp_f32 v98, v98
  v_exp_f32 v99, v99
  v_cvt_pk_bf16_f32 v68, v96, v97
  v_cvt_pk_bf16_f32 v69, v98, v99
  v_mfma_f32_32x32x16_bf16 v[120:135], v[56:59], v[64:67], v[120:135]
  v_exp_f32 v100, v100
  v_exp_f32 v101, v101
  v_exp_f32 v102, v102
  v_exp_f32 v103, v103
  v_cvt_pk_bf16_f32 v70, v100, v101
  v_cvt_pk_bf16_f32 v71, v102, v103
  s_nop 1
  v_mfma_f32_32x32x16_bf16 v[120:135], v[60:63], v[68:71], v[120:135]
  s_nop 11
  v_mov_b32 v4, 0
  v_fmac_f32 v4, 0, v104
  v_fmac_f32 v4, 0, v105
  v_fmac_f32 v4, 0, v106
  v_fmac_f32 v4, 0, v107
  v_fmac_f32 v4, 0, v108
  v_fmac_f32 v4, 0, v109
  v_fmac_f32 v4, 0, v110
  v_fmac_f32 v4, 0, v111
  v_fmac_f32 v4, 0, v112
  v_fmac_f32 v4, 0, v113
  v_fmac_f32 v4, 0, v114
  v_fmac_f32 v4, 0, v115
  v_fmac_f32 v4, 0, v116
  v_fmac_f32 v4, 0, v120
  v_fmac_f32 v4, 0, v121
  v_fmac_f32 v4, 0, v122
  v_fmac_f32 v4, 0, v123
  v_fmac_f32 v4, 0, v124
  v_fmac_f32 v4, 0, v125
  v_fmac_f32 v4, 0, v126
  v_fmac_f32 v4, 0, v127
  v_fmac_f32 v4, 0, v128
  v_fmac_f32 v4, 0, v129
  v_fmac_f32 v4, 0, v130
  v_fmac_f32 v4, 0, v131
  v_fmac_f32 v4, 0, v132
  v_min_f32 v5, v116, v132
  v_max_f32 v6, v116, v132
  v_cmp_eq_f32 vcc, 0, v4
  v_cmp_lt_f32 s[48:49], v6, s71
  s_and_b64 vcc, vcc, s[48:49]
  v_cmp_gt_f32 s[48:49], v5, s72
  s_and_b64 vcc, vcc, s[48:49]
  s_cmp_eq_u64 vcc, -1
  s_cbranch_scc1 attn_kernel_a_comb
  s_add_u32 s55, s41, 32
  s_mul_i32 s55, s55, 163840
  s_mul_i32 s48, s47, 81920
  s_add_u32 s55, s55, s48
  v_mul_u32_u24 v7, 320, v9
  v_lshl_add_u32 v7, v8, 4, v7
  v_cndmask_b32 v20, 0, v20, s[60:61]
  v_mov_b32 v13, 0xff7fffff
  v_mov_b32 v104, 0
  v_mov_b32 v105, 0
  v_mov_b32 v106, 0
  v_mov_b32 v107, 0
  v_mov_b32 v108, 0
  v_mov_b32 v109, 0
  v_mov_b32 v110, 0
  v_mov_b32 v111, 0
  v_mov_b32 v112, 0
  v_mov_b32 v113, 0
  v_mov_b32 v114, 0
  v_mov_b32 v115, 0
  v_mov_b32 v116, 0
  v_mov_b32 v117, 0
  v_mov_b32 v118, 0
  v_mov_b32 v119, 0
  v_cndmask_b32 v28, 0, v28, s[60:61]
  v_mov_b32 v14, 0xff7fffff
  v_mov_b32 v120, 0
  v_mov_b32 v121, 0
  v_mov_b32 v122, 0
  v_mov_b32 v123, 0
  v_mov_b32 v124, 0
  v_mov_b32 v125, 0
  v_mov_b32 v126, 0
  v_mov_b32 v127, 0
  v_mov_b32 v128, 0
  v_mov_b32 v129, 0
  v_mov_b32 v130, 0
  v_mov_b32 v131, 0
  v_mov_b32 v132, 0
  v_mov_b32 v133, 0
  v_mov_b32 v134, 0
  v_mov_b32 v135, 0
  s_mov_b32 s52, 32
attn_kernel_a_fb_21:
  buffer_load_dwordx4 v[32:35], v3, s[36:39], s55 offen
  s_mov_b64 exec, s[60:61]
  buffer_load_dwordx2 v[36:37], v15, s[36:39], s55 offen offset:1024
  s_mov_b64 exec, s[62:63]
  buffer_load_dwordx4 v[48:51], v7, s[36:39], s55 offen offset:1280
  buffer_load_dwordx4 v[52:55], v7, s[36:39], s55 offen offset:1920
  s_mov_b64 exec, -1
  s_waitcnt vmcnt(0)
  v_mfma_f32_32x32x16_bf16 v[72:87], v[32:35], v[16:19], 0
  v_mfma_f32_32x32x8_bf16 v[72:87], v[36:37], v[20:21], v[72:87]
  s_nop 11
  v_max3_f32 v4, v72, v73, v74
  v_max3_f32 v4, v4, v75, v76
  v_max3_f32 v4, v4, v77, v78
  v_max3_f32 v4, v4, v79, v80
  v_max3_f32 v4, v4, v81, v82
  v_max3_f32 v4, v4, v83, v84
  v_max3_f32 v4, v4, v85, v86
  v_max_f32 v4, v4, v87
  v_mov_b32 v5, v4
  s_nop 1
  v_permlane32_swap_b32 v4, v5
  v_max_f32 v4, v4, v5
  v_max_f32 v4, v4, v13
  v_sub_f32 v5, v13, v4
  v_exp_f32 v5, v5
  v_mov_b32 v13, v4
  v_sub_f32 v72, v72, v4
  v_sub_f32 v73, v73, v4
  v_sub_f32 v74, v74, v4
  v_sub_f32 v75, v75, v4
  v_sub_f32 v76, v76, v4
  v_sub_f32 v77, v77, v4
  v_sub_f32 v78, v78, v4
  v_sub_f32 v79, v79, v4
  v_sub_f32 v80, v80, v4
  v_sub_f32 v81, v81, v4
  v_sub_f32 v82, v82, v4
  v_sub_f32 v83, v83, v4
  v_sub_f32 v84, v84, v4
  v_sub_f32 v85, v85, v4
  v_sub_f32 v86, v86, v4
  v_sub_f32 v87, v87, v4
  v_exp_f32 v72, v72
  v_exp_f32 v73, v73
  v_exp_f32 v74, v74
  v_exp_f32 v75, v75
  v_cvt_pk_bf16_f32 v64, v72, v73
  v_cvt_pk_bf16_f32 v65, v74, v75
  v_exp_f32 v76, v76
  v_exp_f32 v77, v77
  v_exp_f32 v78, v78
  v_exp_f32 v79, v79
  v_cvt_pk_bf16_f32 v66, v76, v77
  v_cvt_pk_bf16_f32 v67, v78, v79
  v_exp_f32 v80, v80
  v_exp_f32 v81, v81
  v_exp_f32 v82, v82
  v_exp_f32 v83, v83
  v_cvt_pk_bf16_f32 v68, v80, v81
  v_cvt_pk_bf16_f32 v69, v82, v83
  v_exp_f32 v84, v84
  v_exp_f32 v85, v85
  v_exp_f32 v86, v86
  v_exp_f32 v87, v87
  v_cvt_pk_bf16_f32 v70, v84, v85
  v_cvt_pk_bf16_f32 v71, v86, v87
  v_mul_f32 v104, v104, v5
  v_mul_f32 v105, v105, v5
  v_mul_f32 v106, v106, v5
  v_mul_f32 v107, v107, v5
  v_mul_f32 v108, v108, v5
  v_mul_f32 v109, v109, v5
  v_mul_f32 v110, v110, v5
  v_mul_f32 v111, v111, v5
  v_mul_f32 v112, v112, v5
  v_mul_f32 v113, v113, v5
  v_mul_f32 v114, v114, v5
  v_mul_f32 v115, v115, v5
  v_mul_f32 v116, v116, v5
  v_mul_f32 v117, v117, v5
  v_mul_f32 v118, v118, v5
  v_mul_f32 v119, v119, v5
  s_nop 1
  v_mfma_f32_32x32x16_bf16 v[104:119], v[48:51], v[64:67], v[104:119]
  v_mfma_f32_32x32x16_bf16 v[104:119], v[52:55], v[68:71], v[104:119]
  s_nop 11
  v_mfma_f32_32x32x16_bf16 v[88:103], v[32:35], v[24:27], 0
  v_mfma_f32_32x32x8_bf16 v[88:103], v[36:37], v[28:29], v[88:103]
  s_nop 11
  v_max3_f32 v4, v88, v89, v90
  v_max3_f32 v4, v4, v91, v92
  v_max3_f32 v4, v4, v93, v94
  v_max3_f32 v4, v4, v95, v96
  v_max3_f32 v4, v4, v97, v98
  v_max3_f32 v4, v4, v99, v100
  v_max3_f32 v4, v4, v101, v102
  v_max_f32 v4, v4, v103
  v_mov_b32 v5, v4
  s_nop 1
  v_permlane32_swap_b32 v4, v5
  v_max_f32 v4, v4, v5
  v_max_f32 v4, v4, v14
  v_sub_f32 v5, v14, v4
  v_exp_f32 v5, v5
  v_mov_b32 v14, v4
  v_sub_f32 v88, v88, v4
  v_sub_f32 v89, v89, v4
  v_sub_f32 v90, v90, v4
  v_sub_f32 v91, v91, v4
  v_sub_f32 v92, v92, v4
  v_sub_f32 v93, v93, v4
  v_sub_f32 v94, v94, v4
  v_sub_f32 v95, v95, v4
  v_sub_f32 v96, v96, v4
  v_sub_f32 v97, v97, v4
  v_sub_f32 v98, v98, v4
  v_sub_f32 v99, v99, v4
  v_sub_f32 v100, v100, v4
  v_sub_f32 v101, v101, v4
  v_sub_f32 v102, v102, v4
  v_sub_f32 v103, v103, v4
  v_exp_f32 v88, v88
  v_exp_f32 v89, v89
  v_exp_f32 v90, v90
  v_exp_f32 v91, v91
  v_cvt_pk_bf16_f32 v64, v88, v89
  v_cvt_pk_bf16_f32 v65, v90, v91
  v_exp_f32 v92, v92
  v_exp_f32 v93, v93
  v_exp_f32 v94, v94
  v_exp_f32 v95, v95
  v_cvt_pk_bf16_f32 v66, v92, v93
  v_cvt_pk_bf16_f32 v67, v94, v95
  v_exp_f32 v96, v96
  v_exp_f32 v97, v97
  v_exp_f32 v98, v98
  v_exp_f32 v99, v99
  v_cvt_pk_bf16_f32 v68, v96, v97
  v_cvt_pk_bf16_f32 v69, v98, v99
  v_exp_f32 v100, v100
  v_exp_f32 v101, v101
  v_exp_f32 v102, v102
  v_exp_f32 v103, v103
  v_cvt_pk_bf16_f32 v70, v100, v101
  v_cvt_pk_bf16_f32 v71, v102, v103
  v_mul_f32 v120, v120, v5
  v_mul_f32 v121, v121, v5
  v_mul_f32 v122, v122, v5
  v_mul_f32 v123, v123, v5
  v_mul_f32 v124, v124, v5
  v_mul_f32 v125, v125, v5
  v_mul_f32 v126, v126, v5
  v_mul_f32 v127, v127, v5
  v_mul_f32 v128, v128, v5
  v_mul_f32 v129, v129, v5
  v_mul_f32 v130, v130, v5
  v_mul_f32 v131, v131, v5
  v_mul_f32 v132, v132, v5
  v_mul_f32 v133, v133, v5
  v_mul_f32 v134, v134, v5
  v_mul_f32 v135, v135, v5
  s_nop 1
  v_mfma_f32_32x32x16_bf16 v[120:135], v[48:51], v[64:67], v[120:135]
  v_mfma_f32_32x32x16_bf16 v[120:135], v[52:55], v[68:71], v[120:135]
  s_nop 11
  s_add_u32 s55, s55, 2560
  s_sub_u32 s52, s52, 1
  s_cmp_lg_u32 s52, 0
  s_cbranch_scc1 attn_kernel_a_fb_21
  v_sub_f32 v13, 0, v13
  v_sub_f32 v14, 0, v14
attn_kernel_a_comb:
  v_mov_b32 v117, v13
  ds_write_b128 v140, v[104:107] offset:0
  ds_write_b128 v140, v[108:111] offset:1024
  ds_write_b128 v141, v[112:115] offset:0
  ds_write_b128 v141, v[116:119] offset:1024
  ds_write_b32 v144, v23
  v_sub_f32 v31, 1.0, v31
spin_22:
  ds_read_b32 v7, v145
  s_waitcnt lgkmcnt(0)
  v_readfirstlane_b32 s48, v7
  s_cmp_eq_u32 s48, 1
  s_cbranch_scc0 spin_22
  ds_read_b128 v[84:87], v143 offset:1024
  ds_read_b128 v[72:75], v142 offset:0
  ds_read_b128 v[76:79], v142 offset:1024
  ds_read_b128 v[80:83], v143 offset:0
  s_waitcnt lgkmcnt(3)
  v_min_f32 v6, v14, v85
  v_sub_f32 v4, v6, v14
  v_sub_f32 v5, v6, v85
  v_exp_f32 v4, v4
  v_exp_f32 v5, v5
  s_nop 0
  v_mul_f32 v6, v132, v4
  v_fmac_f32 v6, v84, v5
  v_rcp_f32 v6, v6
  s_nop 0
  v_mul_f32 v6, v6, v31
  v_mul_f32 v4, v4, v6
  v_mul_f32 v5, v5, v6
  s_waitcnt lgkmcnt(0)
  v_mul_f32 v120, v120, v4
  v_fmac_f32 v120, v72, v5
  v_mul_f32 v121, v121, v4
  v_fmac_f32 v121, v73, v5
  v_mul_f32 v122, v122, v4
  v_fmac_f32 v122, v74, v5
  v_mul_f32 v123, v123, v4
  v_fmac_f32 v123, v75, v5
  v_mul_f32 v124, v124, v4
  v_fmac_f32 v124, v76, v5
  v_mul_f32 v125, v125, v4
  v_fmac_f32 v125, v77, v5
  v_mul_f32 v126, v126, v4
  v_fmac_f32 v126, v78, v5
  v_mul_f32 v127, v127, v4
  v_fmac_f32 v127, v79, v5
  v_cvt_pk_bf16_f32 v64, v120, v121
  v_cvt_pk_bf16_f32 v65, v122, v123
  v_cvt_pk_bf16_f32 v66, v124, v125
  v_cvt_pk_bf16_f32 v67, v126, v127
  buffer_store_dwordx4 v[64:67], v147, s[36:39], s64 offen sc1
  v_mul_f32 v128, v128, v4
  v_fmac_f32 v128, v80, v5
  v_mul_f32 v129, v129, v4
  v_fmac_f32 v129, v81, v5
  v_mul_f32 v130, v130, v4
  v_fmac_f32 v130, v82, v5
  v_mul_f32 v131, v131, v4
  v_fmac_f32 v131, v83, v5
  v_cvt_pk_bf16_f32 v68, v128, v129
  v_cvt_pk_bf16_f32 v69, v130, v131
  s_mov_b64 exec, s[60:61]
  buffer_store_dwordx2 v[68:69], v146, s[36:39], s65 offen sc1
  s_mov_b64 exec, 1
  s_waitcnt vmcnt(0)
  ds_add_rtn_u32 v7, v148, v23
  s_waitcnt lgkmcnt(0)
  v_readfirstlane_b32 s48, v7
  s_cmp_lg_u32 s48, 7
  s_cbranch_scc1 noflag_23
  buffer_store_dword v23, v149, s[36:39], s66 offen sc1
noflag_23:
  s_mov_b64 exec, -1
  s_branch attn_kernel_end
attn_kernel_g:
  s_setprio 3
  s_sub_u32 s59, s40, 8
  s_and_b32 s46, s2, 7
  s_lshr_b32 s47, s2, 3
  s_lshr_b32 s41, s46, 1
  s_lshl_b32 s41, s41, 3
  s_lshr_b32 s48, s47, 2
  s_add_u32 s41, s41, s48
  s_and_b32 s42, s46, 1
  s_lshl_b32 s42, s42, 2
  s_and_b32 s48, s47, 3
  s_add_u32 s42, s42, s48
  v_lshlrev_b32 v5, 4, v2
  v_add_u32 v6, 4096, v5
  v_lshrrev_b32 v8, 3, v2
  v_and_b32 v9, 7, v2
  v_lshrrev_b32 v10, 4, v2
  v_add_u32 v11, 0, v10
  v_xor_b32 v11, v11, v9
  v_lshlrev_b32 v11, 4, v11
  v_lshl_add_u32 v3, v8, 12, v11
  v_add_u32 v11, 4, v10
  v_xor_b32 v11, v11, v9
  v_lshlrev_b32 v11, 4, v11
  v_lshl_add_u32 v4, v8, 12, v11
  s_waitcnt lgkmcnt(0)
  s_mov_b32 s36, s26
  s_and_b32 s37, s27, 0xffff
  s_mov_b32 s38, 19210240
  s_mov_b32 s39, 0x20000
  s_cmp_lt_u32 s59, 2
  s_cselect_b32 s46, s6, s8
  s_cselect_b32 s47, s7, s9
  s_mov_b32 s32, s46
  s_and_b32 s33, s47, 0xffff
  s_mov_b32 s34, 8388608
  s_mov_b32 s35, 0x20000
  s_lshl_b32 s53, s41, 18
  s_and_b32 s48, s59, 1
  s_lshl_b32 s48, s48, 11
  s_add_u32 s53, s53, s48
  s_mul_i32 s56, s59, 24576
  s_mul_i32 s54, s42, 655360
  s_mul_i32 s48, s59, 163840
  s_add_u32 s54, s54, s48
  s_add_u32 s54, s54, 10485760
  s_mov_b32 s43, s53
  s_add_u32 s44, s53, 2048
  s_mov_b32 s45, s54
  s_add_u32 s50, s54, 163840
  s_mul_i32 s48, s42, 0
  s_and_b32 s48, s48, 15
  s_lshl_b32 s49, s48, 7
  s_add_u32 s53, s53, s49
  s_mul_i32 s49, s48, 10240
  s_add_u32 s54, s54, s49
  s_waitcnt lgkmcnt(0)
  s_barrier
  v_mov_b32 v164, 155648
  s_mov_b32 s57, 8
gpspin_25:
  ds_read_b32 v165, v164
  s_waitcnt lgkmcnt(0)
  v_readfirstlane_b32 s48, v165
  s_cmp_ge_i32 s48, s57
  s_cbranch_scc1 gpok_24
  s_branch gpspin_25
gpok_24:
  s_add_u32 s57, s57, 8
  s_min_i32 s57, s57, 72
  s_add_u32 m0, s56, 0
  s_add_u32 s48, s53, 0
  buffer_load_dwordx4 v3, s[32:35], s48 offen offset:0  lds
  s_add_u32 s48, s53, 31744
  buffer_load_dwordx4 v4, s[32:35], s48 offen offset:1024  lds
  s_add_u32 s48, s53, 63488
  buffer_load_dwordx4 v3, s[32:35], s48 offen offset:2048  lds
  s_add_u32 s48, s53, 95232
  buffer_load_dwordx4 v4, s[32:35], s48 offen offset:3072  lds
  s_add_u32 m0, s56, 4096
  s_add_u32 s48, s53, 131072
  buffer_load_dwordx4 v3, s[32:35], s48 offen offset:0  lds
  s_add_u32 s48, s53, 162816
  buffer_load_dwordx4 v4, s[32:35], s48 offen offset:1024  lds
  s_add_u32 s48, s53, 194560
  buffer_load_dwordx4 v3, s[32:35], s48 offen offset:2048  lds
  s_add_u32 s48, s53, 226304
  buffer_load_dwordx4 v4, s[32:35], s48 offen offset:3072  lds
  s_add_u32 s53, s53, 128
  s_add_u32 m0, s56, 8192
  s_add_u32 s48, s53, 0
  buffer_load_dwordx4 v3, s[32:35], s48 offen offset:0  lds
  s_add_u32 s48, s53, 31744
  buffer_load_dwordx4 v4, s[32:35], s48 offen offset:1024  lds
  s_add_u32 s48, s53, 63488
  buffer_load_dwordx4 v3, s[32:35], s48 offen offset:2048  lds
  s_add_u32 s48, s53, 95232
  buffer_load_dwordx4 v4, s[32:35], s48 offen offset:3072  lds
  buffer_load_dwordx4 v[24:27], v5, s[36:39], s54 offen offset:0
  buffer_load_dwordx4 v[28:31], v5, s[36:39], s54 offen offset:1024
  buffer_load_dwordx4 v[32:35], v5, s[36:39], s54 offen offset:2048
  buffer_load_dwordx4 v[36:39], v5, s[36:39], s54 offen offset:3072
  buffer_load_dwordx4 v[40:43], v6, s[36:39], s54 offen offset:0
  s_add_u32 s54, s54, 5120
  s_add_u32 m0, s56, 12288
  s_add_u32 s48, s53, 131072
  buffer_load_dwordx4 v3, s[32:35], s48 offen offset:0  lds
  s_add_u32 s48, s53, 162816
  buffer_load_dwordx4 v4, s[32:35], s48 offen offset:1024  lds
  s_add_u32 s48, s53, 194560
  buffer_load_dwordx4 v3, s[32:35], s48 offen offset:2048  lds
  s_add_u32 s48, s53, 226304
  buffer_load_dwordx4 v4, s[32:35], s48 offen offset:3072  lds
  s_add_u32 s53, s53, 128
  buffer_load_dwordx4 v[44:47], v5, s[36:39], s54 offen offset:0
  buffer_load_dwordx4 v[48:51], v5, s[36:39], s54 offen offset:1024
  buffer_load_dwordx4 v[52:55], v5, s[36:39], s54 offen offset:2048
  buffer_load_dwordx4 v[56:59], v5, s[36:39], s54 offen offset:3072
  buffer_load_dwordx4 v[60:63], v6, s[36:39], s54 offen offset:0
  s_add_u32 s54, s54, 5120
  s_add_u32 m0, s56, 16384
  s_add_u32 s48, s53, 0
  buffer_load_dwordx4 v3, s[32:35], s48 offen offset:0  lds
  s_add_u32 s48, s53, 31744
  buffer_load_dwordx4 v4, s[32:35], s48 offen offset:1024  lds
  s_add_u32 s48, s53, 63488
  buffer_load_dwordx4 v3, s[32:35], s48 offen offset:2048  lds
  s_add_u32 s48, s53, 95232
  buffer_load_dwordx4 v4, s[32:35], s48 offen offset:3072  lds
  v_and_b32 v11, 15, v2
  v_lshrrev_b32 v8, 1, v11
  v_add_u32 v9, 0, v10
  v_xor_b32 v9, v9, v8
  v_lshlrev_b32 v9, 4, v9
  v_lshl_add_u32 v9, v11, 7, v9
  v_add_u32 v0, s56, v9
  v_add_u32 v9, 4, v10
  v_xor_b32 v9, v9, v8
  v_lshlrev_b32 v9, 4, v9
  v_lshl_add_u32 v9, v11, 7, v9
  v_add_u32 v1, s56, v9
  v_lshlrev_b32 v7, 2, v11
  s_mul_i32 s64, s42, 102400
  s_mul_i32 s48, s59, 5120
  s_add_u32 s64, s64, s48
  s_add_u32 s64, s64, 18350080
  s_add_u32 s65, s64, 20480
  s_add_u32 s66, s65, 20480
  s_add_u32 s67, s66, 20480
  s_add_u32 s68, s67, 20480
  s_mul_i32 s73, s41, 81920
  s_add_u32 s73, s73, s48
  s_add_u32 s73, s73, 15728640
  s_setprio 0
  s_waitcnt vmcnt(22)
  ds_read_b128 v[8:11], v0 offset:0
  ds_read_b128 v[12:15], v0 offset:2048
  ds_read_b128 v[16:19], v0 offset:4096
  s_waitcnt vmcnt(13)
  s_waitcnt lgkmcnt(2)
  v_mfma_f32_16x16x32_bf16 v[84:87], v[24:27], v[8:11], 0
  ds_read_b128 v[20:23], v0 offset:6144
  v_mfma_f32_16x16x32_bf16 v[88:91], v[28:31], v[8:11], 0
  buffer_load_dwordx4 v[64:67], v5, s[36:39], s54 offen offset:0
  buffer_load_dwordx4 v[68:71], v5, s[36:39], s54 offen offset:1024
  buffer_load_dwordx4 v[72:75], v5, s[36:39], s54 offen offset:2048
  buffer_load_dwordx4 v[76:79], v5, s[36:39], s54 offen offset:3072
  buffer_load_dwordx4 v[80:83], v6, s[36:39], s54 offen offset:0
  s_add_u32 s54, s54, 5120
  v_mfma_f32_16x16x32_bf16 v[92:95], v[32:35], v[8:11], 0
  v_mfma_f32_16x16x32_bf16 v[96:99], v[36:39], v[8:11], 0
  v_mfma_f32_16x16x32_bf16 v[100:103], v[40:43], v[8:11], 0
  s_waitcnt lgkmcnt(2)
  v_mfma_f32_16x16x32_bf16 v[104:107], v[24:27], v[12:15], 0
  ds_read_b128 v[8:11], v1 offset:0
  v_mfma_f32_16x16x32_bf16 v[108:111], v[28:31], v[12:15], 0
  v_mfma_f32_16x16x32_bf16 v[112:115], v[32:35], v[12:15], 0
  v_mfma_f32_16x16x32_bf16 v[116:119], v[36:39], v[12:15], 0
  v_mfma_f32_16x16x32_bf16 v[120:123], v[40:43], v[12:15], 0
  s_waitcnt lgkmcnt(2)
  v_mfma_f32_16x16x32_bf16 v[124:127], v[24:27], v[16:19], 0
  ds_read_b128 v[12:15], v1 offset:2048
  v_mfma_f32_16x16x32_bf16 v[128:131], v[28:31], v[16:19], 0
  v_mfma_f32_16x16x32_bf16 v[132:135], v[32:35], v[16:19], 0
  v_mfma_f32_16x16x32_bf16 v[136:139], v[36:39], v[16:19], 0
  v_mfma_f32_16x16x32_bf16 v[140:143], v[40:43], v[16:19], 0
  s_waitcnt lgkmcnt(2)
  v_mfma_f32_16x16x32_bf16 v[144:147], v[24:27], v[20:23], 0
  ds_read_b128 v[16:19], v1 offset:4096
  v_mfma_f32_16x16x32_bf16 v[148:151], v[28:31], v[20:23], 0
  s_add_u32 m0, s56, 20480
  s_add_u32 s48, s53, 131072
  buffer_load_dwordx4 v3, s[32:35], s48 offen offset:0  lds
  s_add_u32 s48, s53, 162816
  buffer_load_dwordx4 v4, s[32:35], s48 offen offset:1024  lds
  s_add_u32 s48, s53, 194560
  buffer_load_dwordx4 v3, s[32:35], s48 offen offset:2048  lds
  s_add_u32 s48, s53, 226304
  buffer_load_dwordx4 v4, s[32:35], s48 offen offset:3072  lds
  s_add_u32 s53, s53, 128
  v_mfma_f32_16x16x32_bf16 v[152:155], v[32:35], v[20:23], 0
  v_mfma_f32_16x16x32_bf16 v[156:159], v[36:39], v[20:23], 0
  v_mfma_f32_16x16x32_bf16 v[160:163], v[40:43], v[20:23], 0
  s_waitcnt vmcnt(13)
  s_waitcnt lgkmcnt(2)
  v_mfma_f32_16x16x32_bf16 v[84:87], v[44:47], v[8:11], v[84:87]
  ds_read_b128 v[20:23], v1 offset:6144
  v_mfma_f32_16x16x32_bf16 v[88:91], v[48:51], v[8:11], v[88:91]
  buffer_load_dwordx4 v[24:27], v5, s[36:39], s54 offen offset:0
  buffer_load_dwordx4 v[28:31], v5, s[36:39], s54 offen offset:1024
  buffer_load_dwordx4 v[32:35], v5, s[36:39], s54 offen offset:2048
  buffer_load_dwordx4 v[36:39], v5, s[36:39], s54 offen offset:3072
  buffer_load_dwordx4 v[40:43], v6, s[36:39], s54 offen offset:0
  s_add_u32 s54, s54, 5120
  v_mfma_f32_16x16x32_bf16 v[92:95], v[52:55], v[8:11], v[92:95]
  v_mfma_f32_16x16x32_bf16 v[96:99], v[56:59], v[8:11], v[96:99]
  v_mfma_f32_16x16x32_bf16 v[100:103], v[60:63], v[8:11], v[100:103]
  s_waitcnt lgkmcnt(2)
  v_mfma_f32_16x16x32_bf16 v[104:107], v[44:47], v[12:15], v[104:107]
  ds_read_b128 v[8:11], v0 offset:8192
  v_mfma_f32_16x16x32_bf16 v[108:111], v[48:51], v[12:15], v[108:111]
  v_mfma_f32_16x16x32_bf16 v[112:115], v[52:55], v[12:15], v[112:115]
  v_mfma_f32_16x16x32_bf16 v[116:119], v[56:59], v[12:15], v[116:119]
  v_mfma_f32_16x16x32_bf16 v[120:123], v[60:63], v[12:15], v[120:123]
  s_waitcnt lgkmcnt(2)
  v_mfma_f32_16x16x32_bf16 v[124:127], v[44:47], v[16:19], v[124:127]
  ds_read_b128 v[12:15], v0 offset:10240
  v_mfma_f32_16x16x32_bf16 v[128:131], v[48:51], v[16:19], v[128:131]
  v_mfma_f32_16x16x32_bf16 v[132:135], v[52:55], v[16:19], v[132:135]
  v_mfma_f32_16x16x32_bf16 v[136:139], v[56:59], v[16:19], v[136:139]
  v_mfma_f32_16x16x32_bf16 v[140:143], v[60:63], v[16:19], v[140:143]
  s_waitcnt lgkmcnt(2)
  v_mfma_f32_16x16x32_bf16 v[144:147], v[44:47], v[20:23], v[144:147]
  ds_read_b128 v[16:19], v0 offset:12288
  v_mfma_f32_16x16x32_bf16 v[148:151], v[48:51], v[20:23], v[148:151]
  s_add_u32 m0, s56, 0
  s_add_u32 s48, s53, 0
  buffer_load_dwordx4 v3, s[32:35], s48 offen offset:0  lds
  s_add_u32 s48, s53, 31744
  buffer_load_dwordx4 v4, s[32:35], s48 offen offset:1024  lds
  s_add_u32 s48, s53, 63488
  buffer_load_dwordx4 v3, s[32:35], s48 offen offset:2048  lds
  s_add_u32 s48, s53, 95232
  buffer_load_dwordx4 v4, s[32:35], s48 offen offset:3072  lds
  v_mfma_f32_16x16x32_bf16 v[152:155], v[52:55], v[20:23], v[152:155]
  v_mfma_f32_16x16x32_bf16 v[156:159], v[56:59], v[20:23], v[156:159]
  v_mfma_f32_16x16x32_bf16 v[160:163], v[60:63], v[20:23], v[160:163]
  s_waitcnt vmcnt(13)
  s_waitcnt lgkmcnt(2)
  v_mfma_f32_16x16x32_bf16 v[84:87], v[64:67], v[8:11], v[84:87]
  ds_read_b128 v[20:23], v0 offset:14336
  v_mfma_f32_16x16x32_bf16 v[88:91], v[68:71], v[8:11], v[88:91]
  buffer_load_dwordx4 v[44:47], v5, s[36:39], s54 offen offset:0
  buffer_load_dwordx4 v[48:51], v5, s[36:39], s54 offen offset:1024
  buffer_load_dwordx4 v[52:55], v5, s[36:39], s54 offen offset:2048
  buffer_load_dwordx4 v[56:59], v5, s[36:39], s54 offen offset:3072
  buffer_load_dwordx4 v[60:63], v6, s[36:39], s54 offen offset:0
  s_add_u32 s54, s54, 5120
  v_mfma_f32_16x16x32_bf16 v[92:95], v[72:75], v[8:11], v[92:95]
  v_mfma_f32_16x16x32_bf16 v[96:99], v[76:79], v[8:11], v[96:99]
  v_mfma_f32_16x16x32_bf16 v[100:103], v[80:83], v[8:11], v[100:103]
  s_waitcnt lgkmcnt(2)
  v_mfma_f32_16x16x32_bf16 v[104:107], v[64:67], v[12:15], v[104:107]
  ds_read_b128 v[8:11], v1 offset:8192
  v_mfma_f32_16x16x32_bf16 v[108:111], v[68:71], v[12:15], v[108:111]
  v_mfma_f32_16x16x32_bf16 v[112:115], v[72:75], v[12:15], v[112:115]
  v_mfma_f32_16x16x32_bf16 v[116:119], v[76:79], v[12:15], v[116:119]
  v_mfma_f32_16x16x32_bf16 v[120:123], v[80:83], v[12:15], v[120:123]
  s_waitcnt lgkmcnt(2)
  v_mfma_f32_16x16x32_bf16 v[124:127], v[64:67], v[16:19], v[124:127]
  ds_read_b128 v[12:15], v1 offset:10240
  v_mfma_f32_16x16x32_bf16 v[128:131], v[68:71], v[16:19], v[128:131]
  v_mfma_f32_16x16x32_bf16 v[132:135], v[72:75], v[16:19], v[132:135]
  v_mfma_f32_16x16x32_bf16 v[136:139], v[76:79], v[16:19], v[136:139]
  v_mfma_f32_16x16x32_bf16 v[140:143], v[80:83], v[16:19], v[140:143]
  s_waitcnt lgkmcnt(2)
  v_mfma_f32_16x16x32_bf16 v[144:147], v[64:67], v[20:23], v[144:147]
  ds_read_b128 v[16:19], v1 offset:12288
  v_mfma_f32_16x16x32_bf16 v[148:151], v[68:71], v[20:23], v[148:151]
  s_add_u32 m0, s56, 4096
  s_add_u32 s48, s53, 131072
  buffer_load_dwordx4 v3, s[32:35], s48 offen offset:0  lds
  s_add_u32 s48, s53, 162816
  buffer_load_dwordx4 v4, s[32:35], s48 offen offset:1024  lds
  s_add_u32 s48, s53, 194560
  buffer_load_dwordx4 v3, s[32:35], s48 offen offset:2048  lds
  s_add_u32 s48, s53, 226304
  buffer_load_dwordx4 v4, s[32:35], s48 offen offset:3072  lds
  s_add_u32 s53, s53, 128
  v_mfma_f32_16x16x32_bf16 v[152:155], v[72:75], v[20:23], v[152:155]
  v_mfma_f32_16x16x32_bf16 v[156:159], v[76:79], v[20:23], v[156:159]
  v_mfma_f32_16x16x32_bf16 v[160:163], v[80:83], v[20:23], v[160:163]
gpspin_27:
  ds_read_b32 v165, v164
  s_waitcnt lgkmcnt(0)
  v_readfirstlane_b32 s48, v165
  s_cmp_ge_i32 s48, s57
  s_cbranch_scc1 gpok_26
  s_branch gpspin_27
gpok_26:
  s_add_u32 s57, s57, 8
  s_min_i32 s57, s57, 72
  s_waitcnt vmcnt(13)
  s_waitcnt lgkmcnt(2)
  v_mfma_f32_16x16x32_bf16 v[84:87], v[24:27], v[8:11], v[84:87]
  ds_read_b128 v[20:23], v1 offset:14336
  v_mfma_f32_16x16x32_bf16 v[88:91], v[28:31], v[8:11], v[88:91]
  buffer_load_dwordx4 v[64:67], v5, s[36:39], s54 offen offset:0
  buffer_load_dwordx4 v[68:71], v5, s[36:39], s54 offen offset:1024
  buffer_load_dwordx4 v[72:75], v5, s[36:39], s54 offen offset:2048
  buffer_load_dwordx4 v[76:79], v5, s[36:39], s54 offen offset:3072
  buffer_load_dwordx4 v[80:83], v6, s[36:39], s54 offen offset:0
  s_add_u32 s54, s54, 5120
  v_mfma_f32_16x16x32_bf16 v[92:95], v[32:35], v[8:11], v[92:95]
  v_mfma_f32_16x16x32_bf16 v[96:99], v[36:39], v[8:11], v[96:99]
  v_mfma_f32_16x16x32_bf16 v[100:103], v[40:43], v[8:11], v[100:103]
  s_waitcnt lgkmcnt(2)
  v_mfma_f32_16x16x32_bf16 v[104:107], v[24:27], v[12:15], v[104:107]
  ds_read_b128 v[8:11], v0 offset:16384
  v_mfma_f32_16x16x32_bf16 v[108:111], v[28:31], v[12:15], v[108:111]
  v_mfma_f32_16x16x32_bf16 v[112:115], v[32:35], v[12:15], v[112:115]
  v_mfma_f32_16x16x32_bf16 v[116:119], v[36:39], v[12:15], v[116:119]
  v_mfma_f32_16x16x32_bf16 v[120:123], v[40:43], v[12:15], v[120:123]
  s_waitcnt lgkmcnt(2)
  v_mfma_f32_16x16x32_bf16 v[124:127], v[24:27], v[16:19], v[124:127]
  ds_read_b128 v[12:15], v0 offset:18432
  v_mfma_f32_16x16x32_bf16 v[128:131], v[28:31], v[16:19], v[128:131]
  v_mfma_f32_16x16x32_bf16 v[132:135], v[32:35], v[16:19], v[132:135]
  v_mfma_f32_16x16x32_bf16 v[136:139], v[36:39], v[16:19], v[136:139]
  v_mfma_f32_16x16x32_bf16 v[140:143], v[40:43], v[16:19], v[140:143]
  s_waitcnt lgkmcnt(2)
  v_mfma_f32_16x16x32_bf16 v[144:147], v[24:27], v[20:23], v[144:147]
  ds_read_b128 v[16:19], v0 offset:20480
  v_mfma_f32_16x16x32_bf16 v[148:151], v[28:31], v[20:23], v[148:151]
  s_add_u32 m0, s56, 8192
  s_add_u32 s48, s53, 0
  buffer_load_dwordx4 v3, s[32:35], s48 offen offset:0  lds
  s_add_u32 s48, s53, 31744
  buffer_load_dwordx4 v4, s[32:35], s48 offen offset:1024  lds
  s_add_u32 s48, s53, 63488
  buffer_load_dwordx4 v3, s[32:35], s48 offen offset:2048  lds
  s_add_u32 s48, s53, 95232
  buffer_load_dwordx4 v4, s[32:35], s48 offen offset:3072  lds
  v_mfma_f32_16x16x32_bf16 v[152:155], v[32:35], v[20:23], v[152:155]
  v_mfma_f32_16x16x32_bf16 v[156:159], v[36:39], v[20:23], v[156:159]
  v_mfma_f32_16x16x32_bf16 v[160:163], v[40:43], v[20:23], v[160:163]
  s_waitcnt vmcnt(13)
  s_waitcnt lgkmcnt(2)
  v_mfma_f32_16x16x32_bf16 v[84:87], v[44:47], v[8:11], v[84:87]
  ds_read_b128 v[20:23], v0 offset:22528
  v_mfma_f32_16x16x32_bf16 v[88:91], v[48:51], v[8:11], v[88:91]
  buffer_load_dwordx4 v[24:27], v5, s[36:39], s54 offen offset:0
  buffer_load_dwordx4 v[28:31], v5, s[36:39], s54 offen offset:1024
  buffer_load_dwordx4 v[32:35], v5, s[36:39], s54 offen offset:2048
  buffer_load_dwordx4 v[36:39], v5, s[36:39], s54 offen offset:3072
  buffer_load_dwordx4 v[40:43], v6, s[36:39], s54 offen offset:0
  s_add_u32 s54, s54, 5120
  v_mfma_f32_16x16x32_bf16 v[92:95], v[52:55], v[8:11], v[92:95]
  v_mfma_f32_16x16x32_bf16 v[96:99], v[56:59], v[8:11], v[96:99]
  v_mfma_f32_16x16x32_bf16 v[100:103], v[60:63], v[8:11], v[100:103]
  s_waitcnt lgkmcnt(2)
  v_mfma_f32_16x16x32_bf16 v[104:107], v[44:47], v[12:15], v[104:107]
  ds_read_b128 v[8:11], v1 offset:16384
  v_mfma_f32_16x16x32_bf16 v[108:111], v[48:51], v[12:15], v[108:111]
  v_mfma_f32_16x16x32_bf16 v[112:115], v[52:55], v[12:15], v[112:115]
  v_mfma_f32_16x16x32_bf16 v[116:119], v[56:59], v[12:15], v[116:119]
  v_mfma_f32_16x16x32_bf16 v[120:123], v[60:63], v[12:15], v[120:123]
  s_waitcnt lgkmcnt(2)
  v_mfma_f32_16x16x32_bf16 v[124:127], v[44:47], v[16:19], v[124:127]
  ds_read_b128 v[12:15], v1 offset:18432
  v_mfma_f32_16x16x32_bf16 v[128:131], v[48:51], v[16:19], v[128:131]
  v_mfma_f32_16x16x32_bf16 v[132:135], v[52:55], v[16:19], v[132:135]
  v_mfma_f32_16x16x32_bf16 v[136:139], v[56:59], v[16:19], v[136:139]
  v_mfma_f32_16x16x32_bf16 v[140:143], v[60:63], v[16:19], v[140:143]
  s_waitcnt lgkmcnt(2)
  v_mfma_f32_16x16x32_bf16 v[144:147], v[44:47], v[20:23], v[144:147]
  ds_read_b128 v[16:19], v1 offset:20480
  v_mfma_f32_16x16x32_bf16 v[148:151], v[48:51], v[20:23], v[148:151]
  s_add_u32 m0, s56, 12288
  s_add_u32 s48, s53, 131072
  buffer_load_dwordx4 v3, s[32:35], s48 offen offset:0  lds
  s_add_u32 s48, s53, 162816
  buffer_load_dwordx4 v4, s[32:35], s48 offen offset:1024  lds
  s_add_u32 s48, s53, 194560
  buffer_load_dwordx4 v3, s[32:35], s48 offen offset:2048  lds
  s_add_u32 s48, s53, 226304
  buffer_load_dwordx4 v4, s[32:35], s48 offen offset:3072  lds
  s_add_u32 s53, s53, 128
  v_mfma_f32_16x16x32_bf16 v[152:155], v[52:55], v[20:23], v[152:155]
  v_mfma_f32_16x16x32_bf16 v[156:159], v[56:59], v[20:23], v[156:159]
  v_mfma_f32_16x16x32_bf16 v[160:163], v[60:63], v[20:23], v[160:163]
  s_waitcnt vmcnt(13)
  s_waitcnt lgkmcnt(2)
  v_mfma_f32_16x16x32_bf16 v[84:87], v[64:67], v[8:11], v[84:87]
  ds_read_b128 v[20:23], v1 offset:22528
  v_mfma_f32_16x16x32_bf16 v[88:91], v[68:71], v[8:11], v[88:91]
  buffer_load_dwordx4 v[44:47], v5, s[36:39], s54 offen offset:0
  buffer_load_dwordx4 v[48:51], v5, s[36:39], s54 offen offset:1024
  buffer_load_dwordx4 v[52:55], v5, s[36:39], s54 offen offset:2048
  buffer_load_dwordx4 v[56:59], v5, s[36:39], s54 offen offset:3072
  buffer_load_dwordx4 v[60:63], v6, s[36:39], s54 offen offset:0
  s_add_u32 s54, s54, 5120
  v_mfma_f32_16x16x32_bf16 v[92:95], v[72:75], v[8:11], v[92:95]
  v_mfma_f32_16x16x32_bf16 v[96:99], v[76:79], v[8:11], v[96:99]
  v_mfma_f32_16x16x32_bf16 v[100:103], v[80:83], v[8:11], v[100:103]
  s_waitcnt lgkmcnt(2)
  v_mfma_f32_16x16x32_bf16 v[104:107], v[64:67], v[12:15], v[104:107]
  ds_read_b128 v[8:11], v0 offset:0
  v_mfma_f32_16x16x32_bf16 v[108:111], v[68:71], v[12:15], v[108:111]
  v_mfma_f32_16x16x32_bf16 v[112:115], v[72:75], v[12:15], v[112:115]
  v_mfma_f32_16x16x32_bf16 v[116:119], v[76:79], v[12:15], v[116:119]
  v_mfma_f32_16x16x32_bf16 v[120:123], v[80:83], v[12:15], v[120:123]
  s_waitcnt lgkmcnt(2)
  v_mfma_f32_16x16x32_bf16 v[124:127], v[64:67], v[16:19], v[124:127]
  ds_read_b128 v[12:15], v0 offset:2048
  v_mfma_f32_16x16x32_bf16 v[128:131], v[68:71], v[16:19], v[128:131]
  v_mfma_f32_16x16x32_bf16 v[132:135], v[72:75], v[16:19], v[132:135]
  v_mfma_f32_16x16x32_bf16 v[136:139], v[76:79], v[16:19], v[136:139]
  v_mfma_f32_16x16x32_bf16 v[140:143], v[80:83], v[16:19], v[140:143]
  s_waitcnt lgkmcnt(2)
  v_mfma_f32_16x16x32_bf16 v[144:147], v[64:67], v[20:23], v[144:147]
  ds_read_b128 v[16:19], v0 offset:4096
  v_mfma_f32_16x16x32_bf16 v[148:151], v[68:71], v[20:23], v[148:151]
  s_add_u32 m0, s56, 16384
  s_add_u32 s48, s53, 0
  buffer_load_dwordx4 v3, s[32:35], s48 offen offset:0  lds
  s_add_u32 s48, s53, 31744
  buffer_load_dwordx4 v4, s[32:35], s48 offen offset:1024  lds
  s_add_u32 s48, s53, 63488
  buffer_load_dwordx4 v3, s[32:35], s48 offen offset:2048  lds
  s_add_u32 s48, s53, 95232
  buffer_load_dwordx4 v4, s[32:35], s48 offen offset:3072  lds
  v_mfma_f32_16x16x32_bf16 v[152:155], v[72:75], v[20:23], v[152:155]
  v_mfma_f32_16x16x32_bf16 v[156:159], v[76:79], v[20:23], v[156:159]
  v_mfma_f32_16x16x32_bf16 v[160:163], v[80:83], v[20:23], v[160:163]
  s_mov_b32 s52, 3
attn_kernel_g_loop_28:
gpspin_30:
  ds_read_b32 v165, v164
  s_waitcnt lgkmcnt(0)
  v_readfirstlane_b32 s48, v165
  s_cmp_ge_i32 s48, s57
  s_cbranch_scc1 gpok_29
  s_branch gpspin_30
gpok_29:
  s_add_u32 s57, s57, 8
  s_min_i32 s57, s57, 72
  s_waitcnt vmcnt(13)
  s_waitcnt lgkmcnt(2)
  v_mfma_f32_16x16x32_bf16 v[84:87], v[24:27], v[8:11], v[84:87]
  ds_read_b128 v[20:23], v0 offset:6144
  v_mfma_f32_16x16x32_bf16 v[88:91], v[28:31], v[8:11], v[88:91]
  buffer_load_dwordx4 v[64:67], v5, s[36:39], s54 offen offset:0
  buffer_load_dwordx4 v[68:71], v5, s[36:39], s54 offen offset:1024
  buffer_load_dwordx4 v[72:75], v5, s[36:39], s54 offen offset:2048
  buffer_load_dwordx4 v[76:79], v5, s[36:39], s54 offen offset:3072
  buffer_load_dwordx4 v[80:83], v6, s[36:39], s54 offen offset:0
  s_add_u32 s54, s54, 5120
  v_mfma_f32_16x16x32_bf16 v[92:95], v[32:35], v[8:11], v[92:95]
  v_mfma_f32_16x16x32_bf16 v[96:99], v[36:39], v[8:11], v[96:99]
  v_mfma_f32_16x16x32_bf16 v[100:103], v[40:43], v[8:11], v[100:103]
  s_waitcnt lgkmcnt(2)
  v_mfma_f32_16x16x32_bf16 v[104:107], v[24:27], v[12:15], v[104:107]
  ds_read_b128 v[8:11], v1 offset:0
  v_mfma_f32_16x16x32_bf16 v[108:111], v[28:31], v[12:15], v[108:111]
  v_mfma_f32_16x16x32_bf16 v[112:115], v[32:35], v[12:15], v[112:115]
  v_mfma_f32_16x16x32_bf16 v[116:119], v[36:39], v[12:15], v[116:119]
  v_mfma_f32_16x16x32_bf16 v[120:123], v[40:43], v[12:15], v[120:123]
  s_waitcnt lgkmcnt(2)
  v_mfma_f32_16x16x32_bf16 v[124:127], v[24:27], v[16:19], v[124:127]
  ds_read_b128 v[12:15], v1 offset:2048
  v_mfma_f32_16x16x32_bf16 v[128:131], v[28:31], v[16:19], v[128:131]
  v_mfma_f32_16x16x32_bf16 v[132:135], v[32:35], v[16:19], v[132:135]
  v_mfma_f32_16x16x32_bf16 v[136:139], v[36:39], v[16:19], v[136:139]
  v_mfma_f32_16x16x32_bf16 v[140:143], v[40:43], v[16:19], v[140:143]
  s_waitcnt lgkmcnt(2)
  v_mfma_f32_16x16x32_bf16 v[144:147], v[24:27], v[20:23], v[144:147]
  ds_read_b128 v[16:19], v1 offset:4096
  v_mfma_f32_16x16x32_bf16 v[148:151], v[28:31], v[20:23], v[148:151]
  s_add_u32 m0, s56, 20480
  s_add_u32 s48, s53, 131072
  buffer_load_dwordx4 v3, s[32:35], s48 offen offset:0  lds
  s_add_u32 s48, s53, 162816
  buffer_load_dwordx4 v4, s[32:35], s48 offen offset:1024  lds
  s_add_u32 s48, s53, 194560
  buffer_load_dwordx4 v3, s[32:35], s48 offen offset:2048  lds
  s_add_u32 s48, s53, 226304
  buffer_load_dwordx4 v4, s[32:35], s48 offen offset:3072  lds
  s_add_u32 s53, s53, 128
  v_mfma_f32_16x16x32_bf16 v[152:155], v[32:35], v[20:23], v[152:155]
  v_mfma_f32_16x16x32_bf16 v[156:159], v[36:39], v[20:23], v[156:159]
  v_mfma_f32_16x16x32_bf16 v[160:163], v[40:43], v[20:23], v[160:163]
  s_waitcnt vmcnt(13)
  s_waitcnt lgkmcnt(2)
  v_mfma_f32_16x16x32_bf16 v[84:87], v[44:47], v[8:11], v[84:87]
  ds_read_b128 v[20:23], v1 offset:6144
  v_mfma_f32_16x16x32_bf16 v[88:91], v[48:51], v[8:11], v[88:91]
  buffer_load_dwordx4 v[24:27], v5, s[36:39], s54 offen offset:0
  buffer_load_dwordx4 v[28:31], v5, s[36:39], s54 offen offset:1024
  buffer_load_dwordx4 v[32:35], v5, s[36:39], s54 offen offset:2048
  buffer_load_dwordx4 v[36:39], v5, s[36:39], s54 offen offset:3072
  buffer_load_dwordx4 v[40:43], v6, s[36:39], s54 offen offset:0
  s_add_u32 s54, s54, 5120
  v_mfma_f32_16x16x32_bf16 v[92:95], v[52:55], v[8:11], v[92:95]
  v_mfma_f32_16x16x32_bf16 v[96:99], v[56:59], v[8:11], v[96:99]
  v_mfma_f32_16x16x32_bf16 v[100:103], v[60:63], v[8:11], v[100:103]
  s_waitcnt lgkmcnt(2)
  v_mfma_f32_16x16x32_bf16 v[104:107], v[44:47], v[12:15], v[104:107]
  ds_read_b128 v[8:11], v0 offset:8192
  v_mfma_f32_16x16x32_bf16 v[108:111], v[48:51], v[12:15], v[108:111]
  v_mfma_f32_16x16x32_bf16 v[112:115], v[52:55], v[12:15], v[112:115]
  v_mfma_f32_16x16x32_bf16 v[116:119], v[56:59], v[12:15], v[116:119]
  v_mfma_f32_16x16x32_bf16 v[120:123], v[60:63], v[12:15], v[120:123]
  s_waitcnt lgkmcnt(2)
  v_mfma_f32_16x16x32_bf16 v[124:127], v[44:47], v[16:19], v[124:127]
  ds_read_b128 v[12:15], v0 offset:10240
  v_mfma_f32_16x16x32_bf16 v[128:131], v[48:51], v[16:19], v[128:131]
  v_mfma_f32_16x16x32_bf16 v[132:135], v[52:55], v[16:19], v[132:135]
  v_mfma_f32_16x16x32_bf16 v[136:139], v[56:59], v[16:19], v[136:139]
  v_mfma_f32_16x16x32_bf16 v[140:143], v[60:63], v[16:19], v[140:143]
  s_waitcnt lgkmcnt(2)
  v_mfma_f32_16x16x32_bf16 v[144:147], v[44:47], v[20:23], v[144:147]
  ds_read_b128 v[16:19], v0 offset:12288
  v_mfma_f32_16x16x32_bf16 v[148:151], v[48:51], v[20:23], v[148:151]
  s_add_u32 m0, s56, 0
  s_add_u32 s48, s53, 0
  buffer_load_dwordx4 v3, s[32:35], s48 offen offset:0  lds
  s_add_u32 s48, s53, 31744
  buffer_load_dwordx4 v4, s[32:35], s48 offen offset:1024  lds
  s_add_u32 s48, s53, 63488
  buffer_load_dwordx4 v3, s[32:35], s48 offen offset:2048  lds
  s_add_u32 s48, s53, 95232
  buffer_load_dwordx4 v4, s[32:35], s48 offen offset:3072  lds
  v_mfma_f32_16x16x32_bf16 v[152:155], v[52:55], v[20:23], v[152:155]
  v_mfma_f32_16x16x32_bf16 v[156:159], v[56:59], v[20:23], v[156:159]
  v_mfma_f32_16x16x32_bf16 v[160:163], v[60:63], v[20:23], v[160:163]
  s_waitcnt vmcnt(13)
  s_waitcnt lgkmcnt(2)
  v_mfma_f32_16x16x32_bf16 v[84:87], v[64:67], v[8:11], v[84:87]
  ds_read_b128 v[20:23], v0 offset:14336
  v_mfma_f32_16x16x32_bf16 v[88:91], v[68:71], v[8:11], v[88:91]
  buffer_load_dwordx4 v[44:47], v5, s[36:39], s54 offen offset:0
  buffer_load_dwordx4 v[48:51], v5, s[36:39], s54 offen offset:1024
  buffer_load_dwordx4 v[52:55], v5, s[36:39], s54 offen offset:2048
  buffer_load_dwordx4 v[56:59], v5, s[36:39], s54 offen offset:3072
  buffer_load_dwordx4 v[60:63], v6, s[36:39], s54 offen offset:0
  s_add_u32 s54, s54, 5120
  v_mfma_f32_16x16x32_bf16 v[92:95], v[72:75], v[8:11], v[92:95]
  v_mfma_f32_16x16x32_bf16 v[96:99], v[76:79], v[8:11], v[96:99]
  v_mfma_f32_16x16x32_bf16 v[100:103], v[80:83], v[8:11], v[100:103]
  s_waitcnt lgkmcnt(2)
  v_mfma_f32_16x16x32_bf16 v[104:107], v[64:67], v[12:15], v[104:107]
  ds_read_b128 v[8:11], v1 offset:8192
  v_mfma_f32_16x16x32_bf16 v[108:111], v[68:71], v[12:15], v[108:111]
  v_mfma_f32_16x16x32_bf16 v[112:115], v[72:75], v[12:15], v[112:115]
  v_mfma_f32_16x16x32_bf16 v[116:119], v[76:79], v[12:15], v[116:119]
  v_mfma_f32_16x16x32_bf16 v[120:123], v[80:83], v[12:15], v[120:123]
  s_waitcnt lgkmcnt(2)
  v_mfma_f32_16x16x32_bf16 v[124:127], v[64:67], v[16:19], v[124:127]
  ds_read_b128 v[12:15], v1 offset:10240
  v_mfma_f32_16x16x32_bf16 v[128:131], v[68:71], v[16:19], v[128:131]
  v_mfma_f32_16x16x32_bf16 v[132:135], v[72:75], v[16:19], v[132:135]
  v_mfma_f32_16x16x32_bf16 v[136:139], v[76:79], v[16:19], v[136:139]
  v_mfma_f32_16x16x32_bf16 v[140:143], v[80:83], v[16:19], v[140:143]
  s_waitcnt lgkmcnt(2)
  v_mfma_f32_16x16x32_bf16 v[144:147], v[64:67], v[20:23], v[144:147]
  ds_read_b128 v[16:19], v1 offset:12288
  v_mfma_f32_16x16x32_bf16 v[148:151], v[68:71], v[20:23], v[148:151]
  s_add_u32 m0, s56, 4096
  s_add_u32 s48, s53, 131072
  buffer_load_dwordx4 v3, s[32:35], s48 offen offset:0  lds
  s_add_u32 s48, s53, 162816
  buffer_load_dwordx4 v4, s[32:35], s48 offen offset:1024  lds
  s_add_u32 s48, s53, 194560
  buffer_load_dwordx4 v3, s[32:35], s48 offen offset:2048  lds
  s_add_u32 s48, s53, 226304
  buffer_load_dwordx4 v4, s[32:35], s48 offen offset:3072  lds
  s_add_u32 s53, s53, 128
  v_mfma_f32_16x16x32_bf16 v[152:155], v[72:75], v[20:23], v[152:155]
  v_mfma_f32_16x16x32_bf16 v[156:159], v[76:79], v[20:23], v[156:159]
  v_mfma_f32_16x16x32_bf16 v[160:163], v[80:83], v[20:23], v[160:163]
gpspin_32:
  ds_read_b32 v165, v164
  s_waitcnt lgkmcnt(0)
  v_readfirstlane_b32 s48, v165
  s_cmp_ge_i32 s48, s57
  s_cbranch_scc1 gpok_31
  s_branch gpspin_32
gpok_31:
  s_add_u32 s57, s57, 8
  s_min_i32 s57, s57, 72
  s_waitcnt vmcnt(13)
  s_waitcnt lgkmcnt(2)
  v_mfma_f32_16x16x32_bf16 v[84:87], v[24:27], v[8:11], v[84:87]
  ds_read_b128 v[20:23], v1 offset:14336
  v_mfma_f32_16x16x32_bf16 v[88:91], v[28:31], v[8:11], v[88:91]
  buffer_load_dwordx4 v[64:67], v5, s[36:39], s54 offen offset:0
  buffer_load_dwordx4 v[68:71], v5, s[36:39], s54 offen offset:1024
  buffer_load_dwordx4 v[72:75], v5, s[36:39], s54 offen offset:2048
  buffer_load_dwordx4 v[76:79], v5, s[36:39], s54 offen offset:3072
  buffer_load_dwordx4 v[80:83], v6, s[36:39], s54 offen offset:0
  s_add_u32 s54, s54, 5120
  v_mfma_f32_16x16x32_bf16 v[92:95], v[32:35], v[8:11], v[92:95]
  v_mfma_f32_16x16x32_bf16 v[96:99], v[36:39], v[8:11], v[96:99]
  v_mfma_f32_16x16x32_bf16 v[100:103], v[40:43], v[8:11], v[100:103]
  s_waitcnt lgkmcnt(2)
  v_mfma_f32_16x16x32_bf16 v[104:107], v[24:27], v[12:15], v[104:107]
  ds_read_b128 v[8:11], v0 offset:16384
  v_mfma_f32_16x16x32_bf16 v[108:111], v[28:31], v[12:15], v[108:111]
  v_mfma_f32_16x16x32_bf16 v[112:115], v[32:35], v[12:15], v[112:115]
  v_mfma_f32_16x16x32_bf16 v[116:119], v[36:39], v[12:15], v[116:119]
  v_mfma_f32_16x16x32_bf16 v[120:123], v[40:43], v[12:15], v[120:123]
  s_waitcnt lgkmcnt(2)
  v_mfma_f32_16x16x32_bf16 v[124:127], v[24:27], v[16:19], v[124:127]
  ds_read_b128 v[12:15], v0 offset:18432
  v_mfma_f32_16x16x32_bf16 v[128:131], v[28:31], v[16:19], v[128:131]
  v_mfma_f32_16x16x32_bf16 v[132:135], v[32:35], v[16:19], v[132:135]
  v_mfma_f32_16x16x32_bf16 v[136:139], v[36:39], v[16:19], v[136:139]
  v_mfma_f32_16x16x32_bf16 v[140:143], v[40:43], v[16:19], v[140:143]
  s_waitcnt lgkmcnt(2)
  v_mfma_f32_16x16x32_bf16 v[144:147], v[24:27], v[20:23], v[144:147]
  ds_read_b128 v[16:19], v0 offset:20480
  v_mfma_f32_16x16x32_bf16 v[148:151], v[28:31], v[20:23], v[148:151]
  s_add_u32 m0, s56, 8192
  s_add_u32 s48, s53, 0
  buffer_load_dwordx4 v3, s[32:35], s48 offen offset:0  lds
  s_add_u32 s48, s53, 31744
  buffer_load_dwordx4 v4, s[32:35], s48 offen offset:1024  lds
  s_add_u32 s48, s53, 63488
  buffer_load_dwordx4 v3, s[32:35], s48 offen offset:2048  lds
  s_add_u32 s48, s53, 95232
  buffer_load_dwordx4 v4, s[32:35], s48 offen offset:3072  lds
  v_mfma_f32_16x16x32_bf16 v[152:155], v[32:35], v[20:23], v[152:155]
  v_mfma_f32_16x16x32_bf16 v[156:159], v[36:39], v[20:23], v[156:159]
  v_mfma_f32_16x16x32_bf16 v[160:163], v[40:43], v[20:23], v[160:163]
  s_waitcnt vmcnt(13)
  s_waitcnt lgkmcnt(2)
  v_mfma_f32_16x16x32_bf16 v[84:87], v[44:47], v[8:11], v[84:87]
  ds_read_b128 v[20:23], v0 offset:22528
  v_mfma_f32_16x16x32_bf16 v[88:91], v[48:51], v[8:11], v[88:91]
  buffer_load_dwordx4 v[24:27], v5, s[36:39], s54 offen offset:0
  buffer_load_dwordx4 v[28:31], v5, s[36:39], s54 offen offset:1024
  buffer_load_dwordx4 v[32:35], v5, s[36:39], s54 offen offset:2048
  buffer_load_dwordx4 v[36:39], v5, s[36:39], s54 offen offset:3072
  buffer_load_dwordx4 v[40:43], v6, s[36:39], s54 offen offset:0
  s_add_u32 s54, s54, 5120
  v_mfma_f32_16x16x32_bf16 v[92:95], v[52:55], v[8:11], v[92:95]
  v_mfma_f32_16x16x32_bf16 v[96:99], v[56:59], v[8:11], v[96:99]
  v_mfma_f32_16x16x32_bf16 v[100:103], v[60:63], v[8:11], v[100:103]
  s_waitcnt lgkmcnt(2)
  v_mfma_f32_16x16x32_bf16 v[104:107], v[44:47], v[12:15], v[104:107]
  ds_read_b128 v[8:11], v1 offset:16384
  v_mfma_f32_16x16x32_bf16 v[108:111], v[48:51], v[12:15], v[108:111]
  v_mfma_f32_16x16x32_bf16 v[112:115], v[52:55], v[12:15], v[112:115]
  v_mfma_f32_16x16x32_bf16 v[116:119], v[56:59], v[12:15], v[116:119]
  v_mfma_f32_16x16x32_bf16 v[120:123], v[60:63], v[12:15], v[120:123]
  s_waitcnt lgkmcnt(2)
  v_mfma_f32_16x16x32_bf16 v[124:127], v[44:47], v[16:19], v[124:127]
  ds_read_b128 v[12:15], v1 offset:18432
  v_mfma_f32_16x16x32_bf16 v[128:131], v[48:51], v[16:19], v[128:131]
  v_mfma_f32_16x16x32_bf16 v[132:135], v[52:55], v[16:19], v[132:135]
  v_mfma_f32_16x16x32_bf16 v[136:139], v[56:59], v[16:19], v[136:139]
  v_mfma_f32_16x16x32_bf16 v[140:143], v[60:63], v[16:19], v[140:143]
  s_waitcnt lgkmcnt(2)
  v_mfma_f32_16x16x32_bf16 v[144:147], v[44:47], v[20:23], v[144:147]
  ds_read_b128 v[16:19], v1 offset:20480
  v_mfma_f32_16x16x32_bf16 v[148:151], v[48:51], v[20:23], v[148:151]
  s_add_u32 m0, s56, 12288
  s_add_u32 s48, s53, 131072
  buffer_load_dwordx4 v3, s[32:35], s48 offen offset:0  lds
  s_add_u32 s48, s53, 162816
  buffer_load_dwordx4 v4, s[32:35], s48 offen offset:1024  lds
  s_add_u32 s48, s53, 194560
  buffer_load_dwordx4 v3, s[32:35], s48 offen offset:2048  lds
  s_add_u32 s48, s53, 226304
  buffer_load_dwordx4 v4, s[32:35], s48 offen offset:3072  lds
  s_add_u32 s53, s53, 128
  v_mfma_f32_16x16x32_bf16 v[152:155], v[52:55], v[20:23], v[152:155]
  v_mfma_f32_16x16x32_bf16 v[156:159], v[56:59], v[20:23], v[156:159]
  v_mfma_f32_16x16x32_bf16 v[160:163], v[60:63], v[20:23], v[160:163]
  s_waitcnt vmcnt(13)
  s_waitcnt lgkmcnt(2)
  v_mfma_f32_16x16x32_bf16 v[84:87], v[64:67], v[8:11], v[84:87]
  ds_read_b128 v[20:23], v1 offset:22528
  v_mfma_f32_16x16x32_bf16 v[88:91], v[68:71], v[8:11], v[88:91]
  buffer_load_dwordx4 v[44:47], v5, s[36:39], s54 offen offset:0
  buffer_load_dwordx4 v[48:51], v5, s[36:39], s54 offen offset:1024
  buffer_load_dwordx4 v[52:55], v5, s[36:39], s54 offen offset:2048
  buffer_load_dwordx4 v[56:59], v5, s[36:39], s54 offen offset:3072
  buffer_load_dwordx4 v[60:63], v6, s[36:39], s54 offen offset:0
  s_add_u32 s54, s54, 5120
  v_mfma_f32_16x16x32_bf16 v[92:95], v[72:75], v[8:11], v[92:95]
  v_mfma_f32_16x16x32_bf16 v[96:99], v[76:79], v[8:11], v[96:99]
  v_mfma_f32_16x16x32_bf16 v[100:103], v[80:83], v[8:11], v[100:103]
  s_waitcnt lgkmcnt(2)
  v_mfma_f32_16x16x32_bf16 v[104:107], v[64:67], v[12:15], v[104:107]
  ds_read_b128 v[8:11], v0 offset:0
  v_mfma_f32_16x16x32_bf16 v[108:111], v[68:71], v[12:15], v[108:111]
  v_mfma_f32_16x16x32_bf16 v[112:115], v[72:75], v[12:15], v[112:115]
  v_mfma_f32_16x16x32_bf16 v[116:119], v[76:79], v[12:15], v[116:119]
  v_mfma_f32_16x16x32_bf16 v[120:123], v[80:83], v[12:15], v[120:123]
  s_waitcnt lgkmcnt(2)
  v_mfma_f32_16x16x32_bf16 v[124:127], v[64:67], v[16:19], v[124:127]
  ds_read_b128 v[12:15], v0 offset:2048
  v_mfma_f32_16x16x32_bf16 v[128:131], v[68:71], v[16:19], v[128:131]
  v_mfma_f32_16x16x32_bf16 v[132:135], v[72:75], v[16:19], v[132:135]
  v_mfma_f32_16x16x32_bf16 v[136:139], v[76:79], v[16:19], v[136:139]
  v_mfma_f32_16x16x32_bf16 v[140:143], v[80:83], v[16:19], v[140:143]
  s_waitcnt lgkmcnt(2)
  v_mfma_f32_16x16x32_bf16 v[144:147], v[64:67], v[20:23], v[144:147]
  ds_read_b128 v[16:19], v0 offset:4096
  v_mfma_f32_16x16x32_bf16 v[148:151], v[68:71], v[20:23], v[148:151]
  s_add_u32 m0, s56, 16384
  s_add_u32 s48, s53, 0
  buffer_load_dwordx4 v3, s[32:35], s48 offen offset:0  lds
  s_add_u32 s48, s53, 31744
  buffer_load_dwordx4 v4, s[32:35], s48 offen offset:1024  lds
  s_add_u32 s48, s53, 63488
  buffer_load_dwordx4 v3, s[32:35], s48 offen offset:2048  lds
  s_add_u32 s48, s53, 95232
  buffer_load_dwordx4 v4, s[32:35], s48 offen offset:3072  lds
  v_mfma_f32_16x16x32_bf16 v[152:155], v[72:75], v[20:23], v[152:155]
  v_mfma_f32_16x16x32_bf16 v[156:159], v[76:79], v[20:23], v[156:159]
  v_mfma_f32_16x16x32_bf16 v[160:163], v[80:83], v[20:23], v[160:163]
  s_sub_u32 s52, s52, 1
  s_cmp_lg_u32 s52, 0
  s_cbranch_scc1 attn_kernel_g_loop_28
gpspin_34:
  ds_read_b32 v165, v164
  s_waitcnt lgkmcnt(0)
  v_readfirstlane_b32 s48, v165
  s_cmp_ge_i32 s48, s57
  s_cbranch_scc1 gpok_33
  s_branch gpspin_34
gpok_33:
  s_add_u32 s57, s57, 8
  s_min_i32 s57, s57, 72
  s_waitcnt vmcnt(13)
  s_waitcnt lgkmcnt(2)
  v_mfma_f32_16x16x32_bf16 v[84:87], v[24:27], v[8:11], v[84:87]
  ds_read_b128 v[20:23], v0 offset:6144
  v_mfma_f32_16x16x32_bf16 v[88:91], v[28:31], v[8:11], v[88:91]
  buffer_load_dwordx4 v[64:67], v5, s[36:39], s54 offen offset:0
  buffer_load_dwordx4 v[68:71], v5, s[36:39], s54 offen offset:1024
  buffer_load_dwordx4 v[72:75], v5, s[36:39], s54 offen offset:2048
  buffer_load_dwordx4 v[76:79], v5, s[36:39], s54 offen offset:3072
  buffer_load_dwordx4 v[80:83], v6, s[36:39], s54 offen offset:0
  s_add_u32 s54, s54, 5120
  v_mfma_f32_16x16x32_bf16 v[92:95], v[32:35], v[8:11], v[92:95]
  v_mfma_f32_16x16x32_bf16 v[96:99], v[36:39], v[8:11], v[96:99]
  v_mfma_f32_16x16x32_bf16 v[100:103], v[40:43], v[8:11], v[100:103]
  s_waitcnt lgkmcnt(2)
  v_mfma_f32_16x16x32_bf16 v[104:107], v[24:27], v[12:15], v[104:107]
  ds_read_b128 v[8:11], v1 offset:0
  v_mfma_f32_16x16x32_bf16 v[108:111], v[28:31], v[12:15], v[108:111]
  v_mfma_f32_16x16x32_bf16 v[112:115], v[32:35], v[12:15], v[112:115]
  v_mfma_f32_16x16x32_bf16 v[116:119], v[36:39], v[12:15], v[116:119]
  v_mfma_f32_16x16x32_bf16 v[120:123], v[40:43], v[12:15], v[120:123]
  s_waitcnt lgkmcnt(2)
  v_mfma_f32_16x16x32_bf16 v[124:127], v[24:27], v[16:19], v[124:127]
  ds_read_b128 v[12:15], v1 offset:2048
  v_mfma_f32_16x16x32_bf16 v[128:131], v[28:31], v[16:19], v[128:131]
  v_mfma_f32_16x16x32_bf16 v[132:135], v[32:35], v[16:19], v[132:135]
  v_mfma_f32_16x16x32_bf16 v[136:139], v[36:39], v[16:19], v[136:139]
  v_mfma_f32_16x16x32_bf16 v[140:143], v[40:43], v[16:19], v[140:143]
  s_waitcnt lgkmcnt(2)
  v_mfma_f32_16x16x32_bf16 v[144:147], v[24:27], v[20:23], v[144:147]
  ds_read_b128 v[16:19], v1 offset:4096
  v_mfma_f32_16x16x32_bf16 v[148:151], v[28:31], v[20:23], v[148:151]
  s_add_u32 m0, s56, 20480
  s_add_u32 s48, s53, 131072
  buffer_load_dwordx4 v3, s[32:35], s48 offen offset:0  lds
  s_add_u32 s48, s53, 162816
  buffer_load_dwordx4 v4, s[32:35], s48 offen offset:1024  lds
  s_add_u32 s48, s53, 194560
  buffer_load_dwordx4 v3, s[32:35], s48 offen offset:2048  lds
  s_add_u32 s48, s53, 226304
  buffer_load_dwordx4 v4, s[32:35], s48 offen offset:3072  lds
  s_add_u32 s53, s53, 128
  v_mfma_f32_16x16x32_bf16 v[152:155], v[32:35], v[20:23], v[152:155]
  v_mfma_f32_16x16x32_bf16 v[156:159], v[36:39], v[20:23], v[156:159]
  v_mfma_f32_16x16x32_bf16 v[160:163], v[40:43], v[20:23], v[160:163]
  s_waitcnt vmcnt(13)
  s_waitcnt lgkmcnt(2)
  v_mfma_f32_16x16x32_bf16 v[84:87], v[44:47], v[8:11], v[84:87]
  ds_read_b128 v[20:23], v1 offset:6144
  v_mfma_f32_16x16x32_bf16 v[88:91], v[48:51], v[8:11], v[88:91]
  buffer_load_dwordx4 v[24:27], v5, s[36:39], s54 offen offset:0
  buffer_load_dwordx4 v[28:31], v5, s[36:39], s54 offen offset:1024
  buffer_load_dwordx4 v[32:35], v5, s[36:39], s54 offen offset:2048
  buffer_load_dwordx4 v[36:39], v5, s[36:39], s54 offen offset:3072
  buffer_load_dwordx4 v[40:43], v6, s[36:39], s54 offen offset:0
  s_add_u32 s54, s54, 5120
  v_mfma_f32_16x16x32_bf16 v[92:95], v[52:55], v[8:11], v[92:95]
  v_mfma_f32_16x16x32_bf16 v[96:99], v[56:59], v[8:11], v[96:99]
  v_mfma_f32_16x16x32_bf16 v[100:103], v[60:63], v[8:11], v[100:103]
  s_waitcnt lgkmcnt(2)
  v_mfma_f32_16x16x32_bf16 v[104:107], v[44:47], v[12:15], v[104:107]
  ds_read_b128 v[8:11], v0 offset:8192
  v_mfma_f32_16x16x32_bf16 v[108:111], v[48:51], v[12:15], v[108:111]
  v_mfma_f32_16x16x32_bf16 v[112:115], v[52:55], v[12:15], v[112:115]
  v_mfma_f32_16x16x32_bf16 v[116:119], v[56:59], v[12:15], v[116:119]
  v_mfma_f32_16x16x32_bf16 v[120:123], v[60:63], v[12:15], v[120:123]
  s_waitcnt lgkmcnt(2)
  v_mfma_f32_16x16x32_bf16 v[124:127], v[44:47], v[16:19], v[124:127]
  ds_read_b128 v[12:15], v0 offset:10240
  v_mfma_f32_16x16x32_bf16 v[128:131], v[48:51], v[16:19], v[128:131]
  v_mfma_f32_16x16x32_bf16 v[132:135], v[52:55], v[16:19], v[132:135]
  v_mfma_f32_16x16x32_bf16 v[136:139], v[56:59], v[16:19], v[136:139]
  v_mfma_f32_16x16x32_bf16 v[140:143], v[60:63], v[16:19], v[140:143]
  s_waitcnt lgkmcnt(2)
  v_mfma_f32_16x16x32_bf16 v[144:147], v[44:47], v[20:23], v[144:147]
  ds_read_b128 v[16:19], v0 offset:12288
  v_mfma_f32_16x16x32_bf16 v[148:151], v[48:51], v[20:23], v[148:151]
  s_add_u32 m0, s56, 0
  s_add_u32 s48, s53, 0
  buffer_load_dwordx4 v3, s[32:35], s48 offen offset:0  lds
  s_add_u32 s48, s53, 31744
  buffer_load_dwordx4 v4, s[32:35], s48 offen offset:1024  lds
  s_add_u32 s48, s53, 63488
  buffer_load_dwordx4 v3, s[32:35], s48 offen offset:2048  lds
  s_add_u32 s48, s53, 95232
  buffer_load_dwordx4 v4, s[32:35], s48 offen offset:3072  lds
  v_mfma_f32_16x16x32_bf16 v[152:155], v[52:55], v[20:23], v[152:155]
  v_mfma_f32_16x16x32_bf16 v[156:159], v[56:59], v[20:23], v[156:159]
  v_mfma_f32_16x16x32_bf16 v[160:163], v[60:63], v[20:23], v[160:163]
  s_waitcnt vmcnt(13)
  s_waitcnt lgkmcnt(2)
  v_mfma_f32_16x16x32_bf16 v[84:87], v[64:67], v[8:11], v[84:87]
  ds_read_b128 v[20:23], v0 offset:14336
  v_mfma_f32_16x16x32_bf16 v[88:91], v[68:71], v[8:11], v[88:91]
  buffer_load_dwordx4 v[44:47], v5, s[36:39], s54 offen offset:0
  buffer_load_dwordx4 v[48:51], v5, s[36:39], s54 offen offset:1024
  buffer_load_dwordx4 v[52:55], v5, s[36:39], s54 offen offset:2048
  buffer_load_dwordx4 v[56:59], v5, s[36:39], s54 offen offset:3072
  buffer_load_dwordx4 v[60:63], v6, s[36:39], s54 offen offset:0
  s_add_u32 s54, s54, 5120
  v_mfma_f32_16x16x32_bf16 v[92:95], v[72:75], v[8:11], v[92:95]
  v_mfma_f32_16x16x32_bf16 v[96:99], v[76:79], v[8:11], v[96:99]
  v_mfma_f32_16x16x32_bf16 v[100:103], v[80:83], v[8:11], v[100:103]
  s_waitcnt lgkmcnt(2)
  v_mfma_f32_16x16x32_bf16 v[104:107], v[64:67], v[12:15], v[104:107]
  ds_read_b128 v[8:11], v1 offset:8192
  v_mfma_f32_16x16x32_bf16 v[108:111], v[68:71], v[12:15], v[108:111]
  v_mfma_f32_16x16x32_bf16 v[112:115], v[72:75], v[12:15], v[112:115]
  v_mfma_f32_16x16x32_bf16 v[116:119], v[76:79], v[12:15], v[116:119]
  v_mfma_f32_16x16x32_bf16 v[120:123], v[80:83], v[12:15], v[120:123]
  s_waitcnt lgkmcnt(2)
  v_mfma_f32_16x16x32_bf16 v[124:127], v[64:67], v[16:19], v[124:127]
  ds_read_b128 v[12:15], v1 offset:10240
  v_mfma_f32_16x16x32_bf16 v[128:131], v[68:71], v[16:19], v[128:131]
  v_mfma_f32_16x16x32_bf16 v[132:135], v[72:75], v[16:19], v[132:135]
  v_mfma_f32_16x16x32_bf16 v[136:139], v[76:79], v[16:19], v[136:139]
  v_mfma_f32_16x16x32_bf16 v[140:143], v[80:83], v[16:19], v[140:143]
  s_waitcnt lgkmcnt(2)
  v_mfma_f32_16x16x32_bf16 v[144:147], v[64:67], v[20:23], v[144:147]
  ds_read_b128 v[16:19], v1 offset:12288
  v_mfma_f32_16x16x32_bf16 v[148:151], v[68:71], v[20:23], v[148:151]
  s_add_u32 m0, s56, 4096
  s_add_u32 s48, s53, 131072
  buffer_load_dwordx4 v3, s[32:35], s48 offen offset:0  lds
  s_add_u32 s48, s53, 162816
  buffer_load_dwordx4 v4, s[32:35], s48 offen offset:1024  lds
  s_add_u32 s48, s53, 194560
  buffer_load_dwordx4 v3, s[32:35], s48 offen offset:2048  lds
  s_add_u32 s48, s53, 226304
  buffer_load_dwordx4 v4, s[32:35], s48 offen offset:3072  lds
  s_add_u32 s53, s53, 128
  v_mfma_f32_16x16x32_bf16 v[152:155], v[72:75], v[20:23], v[152:155]
  v_mfma_f32_16x16x32_bf16 v[156:159], v[76:79], v[20:23], v[156:159]
  v_mfma_f32_16x16x32_bf16 v[160:163], v[80:83], v[20:23], v[160:163]
gpspin_36:
  ds_read_b32 v165, v164
  s_waitcnt lgkmcnt(0)
  v_readfirstlane_b32 s48, v165
  s_cmp_ge_i32 s48, s57
  s_cbranch_scc1 gpok_35
  s_branch gpspin_36
gpok_35:
  s_add_u32 s57, s57, 8
  s_min_i32 s57, s57, 72
  s_waitcnt vmcnt(13)
  s_waitcnt lgkmcnt(2)
  v_mfma_f32_16x16x32_bf16 v[84:87], v[24:27], v[8:11], v[84:87]
  ds_read_b128 v[20:23], v1 offset:14336
  v_mfma_f32_16x16x32_bf16 v[88:91], v[28:31], v[8:11], v[88:91]
  buffer_load_dwordx4 v[64:67], v5, s[36:39], s54 offen offset:0
  buffer_load_dwordx4 v[68:71], v5, s[36:39], s54 offen offset:1024
  buffer_load_dwordx4 v[72:75], v5, s[36:39], s54 offen offset:2048
  buffer_load_dwordx4 v[76:79], v5, s[36:39], s54 offen offset:3072
  buffer_load_dwordx4 v[80:83], v6, s[36:39], s54 offen offset:0
  s_add_u32 s54, s54, 5120
  v_mfma_f32_16x16x32_bf16 v[92:95], v[32:35], v[8:11], v[92:95]
  v_mfma_f32_16x16x32_bf16 v[96:99], v[36:39], v[8:11], v[96:99]
  v_mfma_f32_16x16x32_bf16 v[100:103], v[40:43], v[8:11], v[100:103]
  s_waitcnt lgkmcnt(2)
  v_mfma_f32_16x16x32_bf16 v[104:107], v[24:27], v[12:15], v[104:107]
  ds_read_b128 v[8:11], v0 offset:16384
  v_mfma_f32_16x16x32_bf16 v[108:111], v[28:31], v[12:15], v[108:111]
  v_mfma_f32_16x16x32_bf16 v[112:115], v[32:35], v[12:15], v[112:115]
  v_mfma_f32_16x16x32_bf16 v[116:119], v[36:39], v[12:15], v[116:119]
  v_mfma_f32_16x16x32_bf16 v[120:123], v[40:43], v[12:15], v[120:123]
  s_waitcnt lgkmcnt(2)
  v_mfma_f32_16x16x32_bf16 v[124:127], v[24:27], v[16:19], v[124:127]
  ds_read_b128 v[12:15], v0 offset:18432
  v_mfma_f32_16x16x32_bf16 v[128:131], v[28:31], v[16:19], v[128:131]
  v_mfma_f32_16x16x32_bf16 v[132:135], v[32:35], v[16:19], v[132:135]
  v_mfma_f32_16x16x32_bf16 v[136:139], v[36:39], v[16:19], v[136:139]
  v_mfma_f32_16x16x32_bf16 v[140:143], v[40:43], v[16:19], v[140:143]
  s_waitcnt lgkmcnt(2)
  v_mfma_f32_16x16x32_bf16 v[144:147], v[24:27], v[20:23], v[144:147]
  ds_read_b128 v[16:19], v0 offset:20480
  v_mfma_f32_16x16x32_bf16 v[148:151], v[28:31], v[20:23], v[148:151]
  v_mfma_f32_16x16x32_bf16 v[152:155], v[32:35], v[20:23], v[152:155]
  v_mfma_f32_16x16x32_bf16 v[156:159], v[36:39], v[20:23], v[156:159]
  v_mfma_f32_16x16x32_bf16 v[160:163], v[40:43], v[20:23], v[160:163]
  s_waitcnt vmcnt(9)
  s_waitcnt lgkmcnt(2)
  v_mfma_f32_16x16x32_bf16 v[84:87], v[44:47], v[8:11], v[84:87]
  ds_read_b128 v[20:23], v0 offset:22528
  v_mfma_f32_16x16x32_bf16 v[88:91], v[48:51], v[8:11], v[88:91]
  buffer_load_dwordx4 v[24:27], v5, s[36:39], s54 offen offset:0
  buffer_load_dwordx4 v[28:31], v5, s[36:39], s54 offen offset:1024
  buffer_load_dwordx4 v[32:35], v5, s[36:39], s54 offen offset:2048
  buffer_load_dwordx4 v[36:39], v5, s[36:39], s54 offen offset:3072
  buffer_load_dwordx4 v[40:43], v6, s[36:39], s54 offen offset:0
  s_add_u32 s54, s54, 5120
  v_mfma_f32_16x16x32_bf16 v[92:95], v[52:55], v[8:11], v[92:95]
  v_mfma_f32_16x16x32_bf16 v[96:99], v[56:59], v[8:11], v[96:99]
  v_mfma_f32_16x16x32_bf16 v[100:103], v[60:63], v[8:11], v[100:103]
  s_waitcnt lgkmcnt(2)
  v_mfma_f32_16x16x32_bf16 v[104:107], v[44:47], v[12:15], v[104:107]
  ds_read_b128 v[8:11], v1 offset:16384
  v_mfma_f32_16x16x32_bf16 v[108:111], v[48:51], v[12:15], v[108:111]
  v_mfma_f32_16x16x32_bf16 v[112:115], v[52:55], v[12:15], v[112:115]
  v_mfma_f32_16x16x32_bf16 v[116:119], v[56:59], v[12:15], v[116:119]
  v_mfma_f32_16x16x32_bf16 v[120:123], v[60:63], v[12:15], v[120:123]
  s_waitcnt lgkmcnt(2)
  v_mfma_f32_16x16x32_bf16 v[124:127], v[44:47], v[16:19], v[124:127]
  ds_read_b128 v[12:15], v1 offset:18432
  v_mfma_f32_16x16x32_bf16 v[128:131], v[48:51], v[16:19], v[128:131]
  v_mfma_f32_16x16x32_bf16 v[132:135], v[52:55], v[16:19], v[132:135]
  v_mfma_f32_16x16x32_bf16 v[136:139], v[56:59], v[16:19], v[136:139]
  v_mfma_f32_16x16x32_bf16 v[140:143], v[60:63], v[16:19], v[140:143]
  s_waitcnt lgkmcnt(2)
  v_mfma_f32_16x16x32_bf16 v[144:147], v[44:47], v[20:23], v[144:147]
  ds_read_b128 v[16:19], v1 offset:20480
  v_mfma_f32_16x16x32_bf16 v[148:151], v[48:51], v[20:23], v[148:151]
  v_mfma_f32_16x16x32_bf16 v[152:155], v[52:55], v[20:23], v[152:155]
  v_mfma_f32_16x16x32_bf16 v[156:159], v[56:59], v[20:23], v[156:159]
  v_mfma_f32_16x16x32_bf16 v[160:163], v[60:63], v[20:23], v[160:163]
  s_lshl_b32 s48, s41, 8
  s_add_u32 s48, s48, 19169280
  buffer_load_dword v164, v7, s[36:39], s48 offen offset:0
  buffer_load_dword v165, v7, s[36:39], s48 offen offset:64
  buffer_load_dword v166, v7, s[36:39], s48 offen offset:128
  buffer_load_dword v167, v7, s[36:39], s48 offen offset:192
  s_waitcnt vmcnt(9)
  s_waitcnt lgkmcnt(2)
  v_mfma_f32_16x16x32_bf16 v[84:87], v[64:67], v[8:11], v[84:87]
  ds_read_b128 v[20:23], v1 offset:22528
  v_mfma_f32_16x16x32_bf16 v[88:91], v[68:71], v[8:11], v[88:91]
  buffer_load_dwordx4 v[44:47], v5, s[36:39], s54 offen offset:0
  buffer_load_dwordx4 v[48:51], v5, s[36:39], s54 offen offset:1024
  buffer_load_dwordx4 v[52:55], v5, s[36:39], s54 offen offset:2048
  buffer_load_dwordx4 v[56:59], v5, s[36:39], s54 offen offset:3072
  buffer_load_dwordx4 v[60:63], v6, s[36:39], s54 offen offset:0
  s_add_u32 s54, s54, 5120
  v_mfma_f32_16x16x32_bf16 v[92:95], v[72:75], v[8:11], v[92:95]
  v_mfma_f32_16x16x32_bf16 v[96:99], v[76:79], v[8:11], v[96:99]
  v_mfma_f32_16x16x32_bf16 v[100:103], v[80:83], v[8:11], v[100:103]
  s_waitcnt lgkmcnt(2)
  v_mfma_f32_16x16x32_bf16 v[104:107], v[64:67], v[12:15], v[104:107]
  ds_read_b128 v[8:11], v0 offset:0
  v_mfma_f32_16x16x32_bf16 v[108:111], v[68:71], v[12:15], v[108:111]
  v_mfma_f32_16x16x32_bf16 v[112:115], v[72:75], v[12:15], v[112:115]
  v_mfma_f32_16x16x32_bf16 v[116:119], v[76:79], v[12:15], v[116:119]
  v_mfma_f32_16x16x32_bf16 v[120:123], v[80:83], v[12:15], v[120:123]
  s_waitcnt lgkmcnt(2)
  v_mfma_f32_16x16x32_bf16 v[124:127], v[64:67], v[16:19], v[124:127]
  ds_read_b128 v[12:15], v0 offset:2048
  v_mfma_f32_16x16x32_bf16 v[128:131], v[68:71], v[16:19], v[128:131]
  v_mfma_f32_16x16x32_bf16 v[132:135], v[72:75], v[16:19], v[132:135]
  v_mfma_f32_16x16x32_bf16 v[136:139], v[76:79], v[16:19], v[136:139]
  v_mfma_f32_16x16x32_bf16 v[140:143], v[80:83], v[16:19], v[140:143]
  s_waitcnt lgkmcnt(2)
  v_mfma_f32_16x16x32_bf16 v[144:147], v[64:67], v[20:23], v[144:147]
  ds_read_b128 v[16:19], v0 offset:4096
  v_mfma_f32_16x16x32_bf16 v[148:151], v[68:71], v[20:23], v[148:151]
  v_mfma_f32_16x16x32_bf16 v[152:155], v[72:75], v[20:23], v[152:155]
  v_mfma_f32_16x16x32_bf16 v[156:159], v[76:79], v[20:23], v[156:159]
  v_mfma_f32_16x16x32_bf16 v[160:163], v[80:83], v[20:23], v[160:163]
  s_waitcnt vmcnt(9)
  s_waitcnt lgkmcnt(2)
  v_mfma_f32_16x16x32_bf16 v[84:87], v[24:27], v[8:11], v[84:87]
  ds_read_b128 v[20:23], v0 offset:6144
  v_mfma_f32_16x16x32_bf16 v[88:91], v[28:31], v[8:11], v[88:91]
  buffer_load_dwordx4 v[64:67], v5, s[36:39], s64 offen offset:0
  buffer_load_dwordx4 v[68:71], v5, s[36:39], s65 offen offset:0
  buffer_load_dwordx4 v[72:75], v5, s[36:39], s66 offen offset:0
  buffer_load_dwordx4 v[76:79], v5, s[36:39], s67 offen offset:0
  buffer_load_dwordx4 v[80:83], v5, s[36:39], s68 offen offset:0
  v_mfma_f32_16x16x32_bf16 v[92:95], v[32:35], v[8:11], v[92:95]
  v_mfma_f32_16x16x32_bf16 v[96:99], v[36:39], v[8:11], v[96:99]
  v_mfma_f32_16x16x32_bf16 v[100:103], v[40:43], v[8:11], v[100:103]
  s_waitcnt lgkmcnt(2)
  v_mfma_f32_16x16x32_bf16 v[104:107], v[24:27], v[12:15], v[104:107]
  ds_read_b128 v[8:11], v1 offset:0
  v_mfma_f32_16x16x32_bf16 v[108:111], v[28:31], v[12:15], v[108:111]
  v_mfma_f32_16x16x32_bf16 v[112:115], v[32:35], v[12:15], v[112:115]
  v_mfma_f32_16x16x32_bf16 v[116:119], v[36:39], v[12:15], v[116:119]
  v_mfma_f32_16x16x32_bf16 v[120:123], v[40:43], v[12:15], v[120:123]
  s_waitcnt lgkmcnt(2)
  v_mfma_f32_16x16x32_bf16 v[124:127], v[24:27], v[16:19], v[124:127]
  ds_read_b128 v[12:15], v1 offset:2048
  v_mfma_f32_16x16x32_bf16 v[128:131], v[28:31], v[16:19], v[128:131]
  v_mfma_f32_16x16x32_bf16 v[132:135], v[32:35], v[16:19], v[132:135]
  v_mfma_f32_16x16x32_bf16 v[136:139], v[36:39], v[16:19], v[136:139]
  v_mfma_f32_16x16x32_bf16 v[140:143], v[40:43], v[16:19], v[140:143]
  s_waitcnt lgkmcnt(2)
  v_mfma_f32_16x16x32_bf16 v[144:147], v[24:27], v[20:23], v[144:147]
  ds_read_b128 v[16:19], v1 offset:4096
  v_mfma_f32_16x16x32_bf16 v[148:151], v[28:31], v[20:23], v[148:151]
  v_mfma_f32_16x16x32_bf16 v[152:155], v[32:35], v[20:23], v[152:155]
  v_mfma_f32_16x16x32_bf16 v[156:159], v[36:39], v[20:23], v[156:159]
  v_mfma_f32_16x16x32_bf16 v[160:163], v[40:43], v[20:23], v[160:163]
  s_waitcnt vmcnt(5)
  s_waitcnt lgkmcnt(2)
  v_mfma_f32_16x16x32_bf16 v[84:87], v[44:47], v[8:11], v[84:87]
  ds_read_b128 v[20:23], v1 offset:6144
  v_mfma_f32_16x16x32_bf16 v[88:91], v[48:51], v[8:11], v[88:91]
  buffer_load_dwordx4 v[24:27], v5, s[36:39], s64 offen offset:1024
  buffer_load_dwordx4 v[28:31], v5, s[36:39], s65 offen offset:1024
  buffer_load_dwordx4 v[32:35], v5, s[36:39], s66 offen offset:1024
  buffer_load_dwordx4 v[36:39], v5, s[36:39], s67 offen offset:1024
  buffer_load_dwordx4 v[40:43], v5, s[36:39], s68 offen offset:1024
  v_mfma_f32_16x16x32_bf16 v[92:95], v[52:55], v[8:11], v[92:95]
  v_mfma_f32_16x16x32_bf16 v[96:99], v[56:59], v[8:11], v[96:99]
  v_mfma_f32_16x16x32_bf16 v[100:103], v[60:63], v[8:11], v[100:103]
  s_waitcnt lgkmcnt(2)
  v_mfma_f32_16x16x32_bf16 v[104:107], v[44:47], v[12:15], v[104:107]
  v_mfma_f32_16x16x32_bf16 v[108:111], v[48:51], v[12:15], v[108:111]
  v_mfma_f32_16x16x32_bf16 v[112:115], v[52:55], v[12:15], v[112:115]
  v_mfma_f32_16x16x32_bf16 v[116:119], v[56:59], v[12:15], v[116:119]
  v_mfma_f32_16x16x32_bf16 v[120:123], v[60:63], v[12:15], v[120:123]
  s_waitcnt lgkmcnt(1)
  v_mfma_f32_16x16x32_bf16 v[124:127], v[44:47], v[16:19], v[124:127]
  v_mfma_f32_16x16x32_bf16 v[128:131], v[48:51], v[16:19], v[128:131]
  v_mfma_f32_16x16x32_bf16 v[132:135], v[52:55], v[16:19], v[132:135]
  v_mfma_f32_16x16x32_bf16 v[136:139], v[56:59], v[16:19], v[136:139]
  v_mfma_f32_16x16x32_bf16 v[140:143], v[60:63], v[16:19], v[140:143]
  s_waitcnt lgkmcnt(0)
  v_mfma_f32_16x16x32_bf16 v[144:147], v[44:47], v[20:23], v[144:147]
  v_mfma_f32_16x16x32_bf16 v[148:151], v[48:51], v[20:23], v[148:151]
  v_mfma_f32_16x16x32_bf16 v[152:155], v[52:55], v[20:23], v[152:155]
  v_mfma_f32_16x16x32_bf16 v[156:159], v[56:59], v[20:23], v[156:159]
  v_mfma_f32_16x16x32_bf16 v[160:163], v[60:63], v[20:23], v[160:163]
  v_and_b32 v0, 31, v2
  v_lshlrev_b32 v0, 7, v0
  s_lshr_b32 s48, s41, 2
  s_lshl_b32 s48, s48, 12
  s_add_u32 s48, s48, 19177472
  s_mov_b32 s74, 0x40000
  s_setprio 3
  buffer_load_dword v1, v0, s[36:39], s48 offen sc1
  buffer_load_dwordx4 v[44:47], v5, s[36:39], s64 offen offset:2048
  buffer_load_dwordx4 v[48:51], v5, s[36:39], s65 offen offset:2048
  buffer_load_dwordx4 v[52:55], v5, s[36:39], s66 offen offset:2048
  buffer_load_dwordx4 v[56:59], v5, s[36:39], s67 offen offset:2048
  buffer_load_dwordx4 v[60:63], v5, s[36:39], s68 offen offset:2048
  s_waitcnt vmcnt(5)
  s_cmp_lt_u32 s59, 2
  s_cselect_b32 s49, 1.0, -1.0
  v_mul_f32 v164, s49, v164
  v_mul_f32 v165, s49, v165
  v_mul_f32 v166, s49, v166
  v_mul_f32 v167, s49, v167
  v_mul_f32 v84, v84, v164
  v_mul_f32 v85, v85, v164
  v_mul_f32 v86, v86, v164
  v_mul_f32 v87, v87, v164
  v_mul_f32 v88, v88, v164
  v_mul_f32 v89, v89, v164
  v_mul_f32 v90, v90, v164
  v_mul_f32 v91, v91, v164
  v_mul_f32 v92, v92, v164
  v_mul_f32 v93, v93, v164
  v_mul_f32 v94, v94, v164
  v_mul_f32 v95, v95, v164
  v_mul_f32 v96, v96, v164
  v_mul_f32 v97, v97, v164
  v_mul_f32 v98, v98, v164
  v_mul_f32 v99, v99, v164
  v_mul_f32 v100, v100, v164
  v_mul_f32 v101, v101, v164
  v_mul_f32 v102, v102, v164
  v_mul_f32 v103, v103, v164
  v_mul_f32 v104, v104, v165
  v_mul_f32 v105, v105, v165
  v_mul_f32 v106, v106, v165
  v_mul_f32 v107, v107, v165
  v_mul_f32 v108, v108, v165
  v_mul_f32 v109, v109, v165
  v_mul_f32 v110, v110, v165
  v_mul_f32 v111, v111, v165
  v_mul_f32 v112, v112, v165
  v_mul_f32 v113, v113, v165
  v_mul_f32 v114, v114, v165
  v_mul_f32 v115, v115, v165
  v_mul_f32 v116, v116, v165
  v_mul_f32 v117, v117, v165
  v_mul_f32 v118, v118, v165
  v_mul_f32 v119, v119, v165
  v_mul_f32 v120, v120, v165
  v_mul_f32 v121, v121, v165
  v_mul_f32 v122, v122, v165
  v_mul_f32 v123, v123, v165
  v_mul_f32 v124, v124, v166
  v_mul_f32 v125, v125, v166
  v_mul_f32 v126, v126, v166
  v_mul_f32 v127, v127, v166
  v_mul_f32 v128, v128, v166
  v_mul_f32 v129, v129, v166
  v_mul_f32 v130, v130, v166
  v_mul_f32 v131, v131, v166
  v_mul_f32 v132, v132, v166
  v_mul_f32 v133, v133, v166
  v_mul_f32 v134, v134, v166
  v_mul_f32 v135, v135, v166
  v_mul_f32 v136, v136, v166
  v_mul_f32 v137, v137, v166
  v_mul_f32 v138, v138, v166
  v_mul_f32 v139, v139, v166
  v_mul_f32 v140, v140, v166
  v_mul_f32 v141, v141, v166
  v_mul_f32 v142, v142, v166
  v_mul_f32 v143, v143, v166
  v_mul_f32 v144, v144, v167
  v_mul_f32 v145, v145, v167
  v_mul_f32 v146, v146, v167
  v_mul_f32 v147, v147, v167
  v_mul_f32 v148, v148, v167
  v_mul_f32 v149, v149, v167
  v_mul_f32 v150, v150, v167
  v_mul_f32 v151, v151, v167
  v_mul_f32 v152, v152, v167
  v_mul_f32 v153, v153, v167
  v_mul_f32 v154, v154, v167
  v_mul_f32 v155, v155, v167
  v_mul_f32 v156, v156, v167
  v_mul_f32 v157, v157, v167
  v_mul_f32 v158, v158, v167
  v_mul_f32 v159, v159, v167
  v_mul_f32 v160, v160, v167
  v_mul_f32 v161, v161, v167
  v_mul_f32 v162, v162, v167
  v_mul_f32 v163, v163, v167
gspin_37:
  v_cmp_eq_u32 vcc, 1, v1
  s_cmp_eq_u64 vcc, -1
  s_cbranch_scc1 gok_38
  s_sub_u32 s74, s74, 1
  s_cmp_eq_u32 s74, 0
  s_cbranch_scc1 gok_38
  buffer_load_dword v1, v0, s[36:39], s48 offen sc1
  s_waitcnt vmcnt(0)
  s_branch gspin_37
gok_38:
  s_add_u32 m0, s56, 0
  s_add_u32 s48, s73, 0
  buffer_load_dwordx4 v5, s[36:39], s48 offen sc1 lds
  s_add_u32 m0, s56, 1024
  s_add_u32 s48, s73, 20480
  buffer_load_dwordx4 v5, s[36:39], s48 offen sc1 lds
  s_add_u32 m0, s56, 2048
  s_add_u32 s48, s73, 40960
  buffer_load_dwordx4 v5, s[36:39], s48 offen sc1 lds
  s_add_u32 m0, s56, 3072
  s_add_u32 s48, s73, 61440
  buffer_load_dwordx4 v5, s[36:39], s48 offen sc1 lds
  s_add_u32 m0, s56, 4096
  s_add_u32 s48, s73, 1024
  buffer_load_dwordx4 v5, s[36:39], s48 offen sc1 lds
  s_add_u32 m0, s56, 5120
  s_add_u32 s48, s73, 21504
  buffer_load_dwordx4 v5, s[36:39], s48 offen sc1 lds
  s_add_u32 m0, s56, 6144
  s_add_u32 s48, s73, 41984
  buffer_load_dwordx4 v5, s[36:39], s48 offen sc1 lds
  s_add_u32 m0, s56, 7168
  s_add_u32 s48, s73, 62464
  buffer_load_dwordx4 v5, s[36:39], s48 offen sc1 lds
  s_add_u32 m0, s56, 8192
  s_add_u32 s48, s73, 2048
  buffer_load_dwordx4 v5, s[36:39], s48 offen sc1 lds
  s_add_u32 m0, s56, 9216
  s_add_u32 s48, s73, 22528
  buffer_load_dwordx4 v5, s[36:39], s48 offen sc1 lds
  s_add_u32 m0, s56, 10240
  s_add_u32 s48, s73, 43008
  buffer_load_dwordx4 v5, s[36:39], s48 offen sc1 lds
  s_add_u32 m0, s56, 11264
  s_add_u32 s48, s73, 63488
  buffer_load_dwordx4 v5, s[36:39], s48 offen sc1 lds
  s_add_u32 m0, s56, 12288
  s_add_u32 s48, s73, 3072
  buffer_load_dwordx4 v5, s[36:39], s48 offen sc1 lds
  s_add_u32 m0, s56, 13312
  s_add_u32 s48, s73, 23552
  buffer_load_dwordx4 v5, s[36:39], s48 offen sc1 lds
  s_add_u32 m0, s56, 14336
  s_add_u32 s48, s73, 44032
  buffer_load_dwordx4 v5, s[36:39], s48 offen sc1 lds
  s_add_u32 m0, s56, 15360
  s_add_u32 s48, s73, 64512
  buffer_load_dwordx4 v5, s[36:39], s48 offen sc1 lds
  s_add_u32 m0, s56, 16384
  s_add_u32 s48, s73, 4096
  buffer_load_dwordx4 v5, s[36:39], s48 offen sc1 lds
  s_add_u32 m0, s56, 17408
  s_add_u32 s48, s73, 24576
  buffer_load_dwordx4 v5, s[36:39], s48 offen sc1 lds
  s_add_u32 m0, s56, 18432
  s_add_u32 s48, s73, 45056
  buffer_load_dwordx4 v5, s[36:39], s48 offen sc1 lds
  s_add_u32 m0, s56, 19456
  s_add_u32 s48, s73, 65536
  buffer_load_dwordx4 v5, s[36:39], s48 offen sc1 lds
  v_add_u32 v0, s56, v5
  s_waitcnt vmcnt(16)
  ds_read_b128 v[8:11], v0 offset:0
  ds_read_b128 v[12:15], v0 offset:1024
  ds_read_b128 v[16:19], v0 offset:2048
  s_waitcnt vmcnt(12)
  s_waitcnt lgkmcnt(2)
  v_mfma_f32_16x16x32_bf16 v[84:87], v[64:67], v[8:11], v[84:87]
  ds_read_b128 v[20:23], v0 offset:3072
  v_mfma_f32_16x16x32_bf16 v[88:91], v[68:71], v[8:11], v[88:91]
  v_mfma_f32_16x16x32_bf16 v[92:95], v[72:75], v[8:11], v[92:95]
  v_mfma_f32_16x16x32_bf16 v[96:99], v[76:79], v[8:11], v[96:99]
  v_mfma_f32_16x16x32_bf16 v[100:103], v[80:83], v[8:11], v[100:103]
  s_waitcnt lgkmcnt(2)
  v_mfma_f32_16x16x32_bf16 v[104:107], v[64:67], v[12:15], v[104:107]
  ds_read_b128 v[8:11], v0 offset:4096
  v_mfma_f32_16x16x32_bf16 v[108:111], v[68:71], v[12:15], v[108:111]
  v_mfma_f32_16x16x32_bf16 v[112:115], v[72:75], v[12:15], v[112:115]
  v_mfma_f32_16x16x32_bf16 v[116:119], v[76:79], v[12:15], v[116:119]
  v_mfma_f32_16x16x32_bf16 v[120:123], v[80:83], v[12:15], v[120:123]
  s_waitcnt lgkmcnt(2)
  v_mfma_f32_16x16x32_bf16 v[124:127], v[64:67], v[16:19], v[124:127]
  ds_read_b128 v[12:15], v0 offset:5120
  v_mfma_f32_16x16x32_bf16 v[128:131], v[68:71], v[16:19], v[128:131]
  v_mfma_f32_16x16x32_bf16 v[132:135], v[72:75], v[16:19], v[132:135]
  v_mfma_f32_16x16x32_bf16 v[136:139], v[76:79], v[16:19], v[136:139]
  v_mfma_f32_16x16x32_bf16 v[140:143], v[80:83], v[16:19], v[140:143]
  s_waitcnt lgkmcnt(2)
  v_mfma_f32_16x16x32_bf16 v[144:147], v[64:67], v[20:23], v[144:147]
  ds_read_b128 v[16:19], v0 offset:6144
  v_mfma_f32_16x16x32_bf16 v[148:151], v[68:71], v[20:23], v[148:151]
  v_mfma_f32_16x16x32_bf16 v[152:155], v[72:75], v[20:23], v[152:155]
  v_mfma_f32_16x16x32_bf16 v[156:159], v[76:79], v[20:23], v[156:159]
  v_mfma_f32_16x16x32_bf16 v[160:163], v[80:83], v[20:23], v[160:163]
  s_waitcnt vmcnt(8)
  s_waitcnt lgkmcnt(2)
  v_mfma_f32_16x16x32_bf16 v[84:87], v[24:27], v[8:11], v[84:87]
  ds_read_b128 v[20:23], v0 offset:7168
  v_mfma_f32_16x16x32_bf16 v[88:91], v[28:31], v[8:11], v[88:91]
  buffer_load_dwordx4 v[64:67], v5, s[36:39], s64 offen offset:3072
  buffer_load_dwordx4 v[68:71], v5, s[36:39], s65 offen offset:3072
  buffer_load_dwordx4 v[72:75], v5, s[36:39], s66 offen offset:3072
  buffer_load_dwordx4 v[76:79], v5, s[36:39], s67 offen offset:3072
  buffer_load_dwordx4 v[80:83], v5, s[36:39], s68 offen offset:3072
  v_mfma_f32_16x16x32_bf16 v[92:95], v[32:35], v[8:11], v[92:95]
  v_mfma_f32_16x16x32_bf16 v[96:99], v[36:39], v[8:11], v[96:99]
  v_mfma_f32_16x16x32_bf16 v[100:103], v[40:43], v[8:11], v[100:103]
  s_waitcnt lgkmcnt(2)
  v_mfma_f32_16x16x32_bf16 v[104:107], v[24:27], v[12:15], v[104:107]
  ds_read_b128 v[8:11], v0 offset:8192
  v_mfma_f32_16x16x32_bf16 v[108:111], v[28:31], v[12:15], v[108:111]
  v_mfma_f32_16x16x32_bf16 v[112:115], v[32:35], v[12:15], v[112:115]
  v_mfma_f32_16x16x32_bf16 v[116:119], v[36:39], v[12:15], v[116:119]
  v_mfma_f32_16x16x32_bf16 v[120:123], v[40:43], v[12:15], v[120:123]
  s_waitcnt lgkmcnt(2)
  v_mfma_f32_16x16x32_bf16 v[124:127], v[24:27], v[16:19], v[124:127]
  ds_read_b128 v[12:15], v0 offset:9216
  v_mfma_f32_16x16x32_bf16 v[128:131], v[28:31], v[16:19], v[128:131]
  v_mfma_f32_16x16x32_bf16 v[132:135], v[32:35], v[16:19], v[132:135]
  v_mfma_f32_16x16x32_bf16 v[136:139], v[36:39], v[16:19], v[136:139]
  v_mfma_f32_16x16x32_bf16 v[140:143], v[40:43], v[16:19], v[140:143]
  s_waitcnt lgkmcnt(2)
  v_mfma_f32_16x16x32_bf16 v[144:147], v[24:27], v[20:23], v[144:147]
  ds_read_b128 v[16:19], v0 offset:10240
  v_mfma_f32_16x16x32_bf16 v[148:151], v[28:31], v[20:23], v[148:151]
  v_mfma_f32_16x16x32_bf16 v[152:155], v[32:35], v[20:23], v[152:155]
  v_mfma_f32_16x16x32_bf16 v[156:159], v[36:39], v[20:23], v[156:159]
  v_mfma_f32_16x16x32_bf16 v[160:163], v[40:43], v[20:23], v[160:163]
  s_waitcnt vmcnt(9)
  s_waitcnt lgkmcnt(2)
  v_mfma_f32_16x16x32_bf16 v[84:87], v[44:47], v[8:11], v[84:87]
  ds_read_b128 v[20:23], v0 offset:11264
  v_mfma_f32_16x16x32_bf16 v[88:91], v[48:51], v[8:11], v[88:91]
  buffer_load_dwordx4 v[24:27], v6, s[36:39], s64 offen offset:0
  buffer_load_dwordx4 v[28:31], v6, s[36:39], s65 offen offset:0
  buffer_load_dwordx4 v[32:35], v6, s[36:39], s66 offen offset:0
  buffer_load_dwordx4 v[36:39], v6, s[36:39], s67 offen offset:0
  buffer_load_dwordx4 v[40:43], v6, s[36:39], s68 offen offset:0
  v_mfma_f32_16x16x32_bf16 v[92:95], v[52:55], v[8:11], v[92:95]
  v_mfma_f32_16x16x32_bf16 v[96:99], v[56:59], v[8:11], v[96:99]
  v_mfma_f32_16x16x32_bf16 v[100:103], v[60:63], v[8:11], v[100:103]
  s_waitcnt lgkmcnt(2)
  v_mfma_f32_16x16x32_bf16 v[104:107], v[44:47], v[12:15], v[104:107]
  ds_read_b128 v[8:11], v0 offset:12288
  v_mfma_f32_16x16x32_bf16 v[108:111], v[48:51], v[12:15], v[108:111]
  v_mfma_f32_16x16x32_bf16 v[112:115], v[52:55], v[12:15], v[112:115]
  v_mfma_f32_16x16x32_bf16 v[116:119], v[56:59], v[12:15], v[116:119]
  v_mfma_f32_16x16x32_bf16 v[120:123], v[60:63], v[12:15], v[120:123]
  s_waitcnt lgkmcnt(2)
  v_mfma_f32_16x16x32_bf16 v[124:127], v[44:47], v[16:19], v[124:127]
  ds_read_b128 v[12:15], v0 offset:13312
  v_mfma_f32_16x16x32_bf16 v[128:131], v[48:51], v[16:19], v[128:131]
  v_mfma_f32_16x16x32_bf16 v[132:135], v[52:55], v[16:19], v[132:135]
  v_mfma_f32_16x16x32_bf16 v[136:139], v[56:59], v[16:19], v[136:139]
  v_mfma_f32_16x16x32_bf16 v[140:143], v[60:63], v[16:19], v[140:143]
  s_waitcnt lgkmcnt(2)
  v_mfma_f32_16x16x32_bf16 v[144:147], v[44:47], v[20:23], v[144:147]
  ds_read_b128 v[16:19], v0 offset:14336
  v_mfma_f32_16x16x32_bf16 v[148:151], v[48:51], v[20:23], v[148:151]
  v_mfma_f32_16x16x32_bf16 v[152:155], v[52:55], v[20:23], v[152:155]
  v_mfma_f32_16x16x32_bf16 v[156:159], v[56:59], v[20:23], v[156:159]
  v_mfma_f32_16x16x32_bf16 v[160:163], v[60:63], v[20:23], v[160:163]
  s_waitcnt vmcnt(5)
  s_waitcnt lgkmcnt(2)
  v_mfma_f32_16x16x32_bf16 v[84:87], v[64:67], v[8:11], v[84:87]
  ds_read_b128 v[20:23], v0 offset:15360
  v_mfma_f32_16x16x32_bf16 v[88:91], v[68:71], v[8:11], v[88:91]
  v_mfma_f32_16x16x32_bf16 v[92:95], v[72:75], v[8:11], v[92:95]
  v_mfma_f32_16x16x32_bf16 v[96:99], v[76:79], v[8:11], v[96:99]
  v_mfma_f32_16x16x32_bf16 v[100:103], v[80:83], v[8:11], v[100:103]
  s_waitcnt lgkmcnt(2)
  v_mfma_f32_16x16x32_bf16 v[104:107], v[64:67], v[12:15], v[104:107]
  ds_read_b128 v[8:11], v0 offset:16384
  v_mfma_f32_16x16x32_bf16 v[108:111], v[68:71], v[12:15], v[108:111]
  v_mfma_f32_16x16x32_bf16 v[112:115], v[72:75], v[12:15], v[112:115]
  v_mfma_f32_16x16x32_bf16 v[116:119], v[76:79], v[12:15], v[116:119]
  v_mfma_f32_16x16x32_bf16 v[120:123], v[80:83], v[12:15], v[120:123]
  s_waitcnt lgkmcnt(2)
  v_mfma_f32_16x16x32_bf16 v[124:127], v[64:67], v[16:19], v[124:127]
  ds_read_b128 v[12:15], v0 offset:17408
  v_mfma_f32_16x16x32_bf16 v[128:131], v[68:71], v[16:19], v[128:131]
  v_mfma_f32_16x16x32_bf16 v[132:135], v[72:75], v[16:19], v[132:135]
  v_mfma_f32_16x16x32_bf16 v[136:139], v[76:79], v[16:19], v[136:139]
  v_mfma_f32_16x16x32_bf16 v[140:143], v[80:83], v[16:19], v[140:143]
  s_waitcnt lgkmcnt(2)
  v_mfma_f32_16x16x32_bf16 v[144:147], v[64:67], v[20:23], v[144:147]
  ds_read_b128 v[16:19], v0 offset:18432
  v_mfma_f32_16x16x32_bf16 v[148:151], v[68:71], v[20:23], v[148:151]
  v_mfma_f32_16x16x32_bf16 v[152:155], v[72:75], v[20:23], v[152:155]
  v_mfma_f32_16x16x32_bf16 v[156:159], v[76:79], v[20:23], v[156:159]
  v_mfma_f32_16x16x32_bf16 v[160:163], v[80:83], v[20:23], v[160:163]
  s_waitcnt vmcnt(0)
  s_waitcnt lgkmcnt(2)
  v_mfma_f32_16x16x32_bf16 v[84:87], v[24:27], v[8:11], v[84:87]
  ds_read_b128 v[20:23], v0 offset:19456
  v_mfma_f32_16x16x32_bf16 v[88:91], v[28:31], v[8:11], v[88:91]
  v_mfma_f32_16x16x32_bf16 v[92:95], v[32:35], v[8:11], v[92:95]
  v_mfma_f32_16x16x32_bf16 v[96:99], v[36:39], v[8:11], v[96:99]
  v_mfma_f32_16x16x32_bf16 v[100:103], v[40:43], v[8:11], v[100:103]
  s_waitcnt lgkmcnt(2)
  v_mfma_f32_16x16x32_bf16 v[104:107], v[24:27], v[12:15], v[104:107]
  v_mfma_f32_16x16x32_bf16 v[108:111], v[28:31], v[12:15], v[108:111]
  v_mfma_f32_16x16x32_bf16 v[112:115], v[32:35], v[12:15], v[112:115]
  v_mfma_f32_16x16x32_bf16 v[116:119], v[36:39], v[12:15], v[116:119]
  v_mfma_f32_16x16x32_bf16 v[120:123], v[40:43], v[12:15], v[120:123]
  s_waitcnt lgkmcnt(1)
  v_mfma_f32_16x16x32_bf16 v[124:127], v[24:27], v[16:19], v[124:127]
  ds_write_b128 v0, v[84:87] offset:0
  v_mfma_f32_16x16x32_bf16 v[128:131], v[28:31], v[16:19], v[128:131]
  ds_write_b128 v0, v[88:91] offset:1024
  v_mfma_f32_16x16x32_bf16 v[132:135], v[32:35], v[16:19], v[132:135]
  ds_write_b128 v0, v[92:95] offset:2048
  v_mfma_f32_16x16x32_bf16 v[136:139], v[36:39], v[16:19], v[136:139]
  ds_write_b128 v0, v[96:99] offset:3072
  v_mfma_f32_16x16x32_bf16 v[140:143], v[40:43], v[16:19], v[140:143]
  ds_write_b128 v0, v[100:103] offset:4096
  s_waitcnt lgkmcnt(5)
  v_mfma_f32_16x16x32_bf16 v[144:147], v[24:27], v[20:23], v[144:147]
  ds_write_b128 v0, v[104:107] offset:5120
  v_mfma_f32_16x16x32_bf16 v[148:151], v[28:31], v[20:23], v[148:151]
  ds_write_b128 v0, v[108:111] offset:6144
  v_mfma_f32_16x16x32_bf16 v[152:155], v[32:35], v[20:23], v[152:155]
  ds_write_b128 v0, v[112:115] offset:7168
  v_mfma_f32_16x16x32_bf16 v[156:159], v[36:39], v[20:23], v[156:159]
  ds_write_b128 v0, v[116:119] offset:8192
  v_mfma_f32_16x16x32_bf16 v[160:163], v[40:43], v[20:23], v[160:163]
  ds_write_b128 v0, v[120:123] offset:9216
  s_mul_i32 s48, s59, 5120
  v_add_u32 v1, s48, v5
  v_add_u32 v3, 49152, v1
  ds_write_b128 v0, v[124:127] offset:10240
  ds_write_b128 v0, v[128:131] offset:11264
  ds_write_b128 v0, v[132:135] offset:12288
  ds_write_b128 v0, v[136:139] offset:13312
  ds_write_b128 v0, v[140:143] offset:14336
  ds_write_b128 v0, v[144:147] offset:15360
  ds_write_b128 v0, v[148:151] offset:16384
  ds_write_b128 v0, v[152:155] offset:17408
  ds_write_b128 v0, v[156:159] offset:18432
  ds_write_b128 v0, v[160:163] offset:19456
  s_mov_b32 s28, s22
  s_and_b32 s29, s23, 0xffff
  s_mov_b32 s30, 2621440
  s_mov_b32 s31, 0x20000
  s_lshl_b32 s48, s41, 2
  s_add_u32 s48, s48, s59
  s_mul_i32 s48, s48, 20480
  s_mul_i32 s49, s42, 160
  s_add_u32 s48, s48, s49
  v_mul_u32_u24 v4, 320, v7
  v_lshrrev_b32 v6, 4, v2
  v_lshl_add_u32 v4, v6, 3, v4
  s_waitcnt lgkmcnt(0)
  s_barrier
  ds_read_b128 v[8:11], v1 offset:0
  ds_read_b128 v[12:15], v1 offset:24576
  ds_read_b128 v[16:19], v3 offset:0
  ds_read_b128 v[20:23], v3 offset:24576
  ds_read_b128 v[24:27], v1 offset:1024
  ds_read_b128 v[28:31], v1 offset:25600
  ds_read_b128 v[32:35], v3 offset:1024
  ds_read_b128 v[36:39], v3 offset:25600
  ds_read_b128 v[40:43], v1 offset:2048
  ds_read_b128 v[44:47], v1 offset:26624
  ds_read_b128 v[48:51], v3 offset:2048
  ds_read_b128 v[52:55], v3 offset:26624
  ds_read_b128 v[56:59], v1 offset:3072
  ds_read_b128 v[60:63], v1 offset:27648
  ds_read_b128 v[64:67], v3 offset:3072
  ds_read_b128 v[68:71], v3 offset:27648
  ds_read_b128 v[72:75], v1 offset:4096
  ds_read_b128 v[76:79], v1 offset:28672
  ds_read_b128 v[80:83], v3 offset:4096
  ds_read_b128 v[84:87], v3 offset:28672
  s_waitcnt lgkmcnt(15)
  v_pk_add_f32 v[8:9], v[8:9], v[12:13]
  v_pk_add_f32 v[16:17], v[16:17], v[20:21]
  v_pk_add_f32 v[10:11], v[10:11], v[14:15]
  v_pk_add_f32 v[18:19], v[18:19], v[22:23]
  v_pk_add_f32 v[8:9], v[8:9], v[16:17]
  v_pk_add_f32 v[10:11], v[10:11], v[18:19]
  v_cvt_pk_bf16_f32 v8, v8, v9
  v_cvt_pk_bf16_f32 v9, v10, v11
  buffer_store_dwordx2 v[8:9], v4, s[28:31], s48 offen offset:0
  s_waitcnt lgkmcnt(12)
  v_pk_add_f32 v[24:25], v[24:25], v[28:29]
  v_pk_add_f32 v[32:33], v[32:33], v[36:37]
  v_pk_add_f32 v[26:27], v[26:27], v[30:31]
  v_pk_add_f32 v[34:35], v[34:35], v[38:39]
  v_pk_add_f32 v[24:25], v[24:25], v[32:33]
  v_pk_add_f32 v[26:27], v[26:27], v[34:35]
  v_cvt_pk_bf16_f32 v24, v24, v25
  v_cvt_pk_bf16_f32 v25, v26, v27
  buffer_store_dwordx2 v[24:25], v4, s[28:31], s48 offen offset:32
  s_waitcnt lgkmcnt(8)
  v_pk_add_f32 v[40:41], v[40:41], v[44:45]
  v_pk_add_f32 v[48:49], v[48:49], v[52:53]
  v_pk_add_f32 v[42:43], v[42:43], v[46:47]
  v_pk_add_f32 v[50:51], v[50:51], v[54:55]
  v_pk_add_f32 v[40:41], v[40:41], v[48:49]
  v_pk_add_f32 v[42:43], v[42:43], v[50:51]
  v_cvt_pk_bf16_f32 v40, v40, v41
  v_cvt_pk_bf16_f32 v41, v42, v43
  buffer_store_dwordx2 v[40:41], v4, s[28:31], s48 offen offset:64
  s_waitcnt lgkmcnt(4)
  v_pk_add_f32 v[56:57], v[56:57], v[60:61]
  v_pk_add_f32 v[64:65], v[64:65], v[68:69]
  v_pk_add_f32 v[58:59], v[58:59], v[62:63]
  v_pk_add_f32 v[66:67], v[66:67], v[70:71]
  v_pk_add_f32 v[56:57], v[56:57], v[64:65]
  v_pk_add_f32 v[58:59], v[58:59], v[66:67]
  v_cvt_pk_bf16_f32 v56, v56, v57
  v_cvt_pk_bf16_f32 v57, v58, v59
  buffer_store_dwordx2 v[56:57], v4, s[28:31], s48 offen offset:96
  s_waitcnt lgkmcnt(0)
  v_pk_add_f32 v[72:73], v[72:73], v[76:77]
  v_pk_add_f32 v[80:81], v[80:81], v[84:85]
  v_pk_add_f32 v[74:75], v[74:75], v[78:79]
  v_pk_add_f32 v[82:83], v[82:83], v[86:87]
  v_pk_add_f32 v[72:73], v[72:73], v[80:81]
  v_pk_add_f32 v[74:75], v[74:75], v[82:83]
  v_cvt_pk_bf16_f32 v72, v72, v73
  v_cvt_pk_bf16_f32 v73, v74, v75
  buffer_store_dwordx2 v[72:73], v4, s[28:31], s48 offen offset:128
  s_branch attn_kernel_end
attn_kernel_end:
  s_endpgm
.section .rodata,"a"
.p2align 6
.amdhsa_kernel proj_kernel
  .amdhsa_next_free_vgpr 236
  .amdhsa_next_free_sgpr 100
  .amdhsa_accum_offset 236
  .amdhsa_group_segment_fixed_size 0
  .amdhsa_kernarg_size 96
  .amdhsa_user_sgpr_count 2
  .amdhsa_user_sgpr_kernarg_segment_ptr 1
  .amdhsa_system_sgpr_workgroup_id_x 1
.end_amdhsa_kernel
.p2align 6
.amdhsa_kernel attn_kernel
  .amdhsa_next_free_vgpr 168
  .amdhsa_next_free_sgpr 100
  .amdhsa_accum_offset 168
  .amdhsa_group_segment_fixed_size 0
  .amdhsa_kernarg_size 96
  .amdhsa_user_sgpr_count 2
  .amdhsa_user_sgpr_kernarg_segment_ptr 1
  .amdhsa_system_sgpr_workgroup_id_x 1
.end_amdhsa_kernel
```
